```python
import torch

def _softmax(x, axis=-1):
    return torch.softmax(x, dim=axis)
def _gelu(x):
    return torch.nn.functional.gelu(x, approximate="tanh")
def _silu(x):
    return torch.nn.functional.silu(x)
def _sigmoid(x):
    return torch.sigmoid(x)
def _layernorm(x, axis=-1, eps=1e-5):
    m = x.mean(dim=axis, keepdim=True)
    v = x.var(dim=axis, keepdim=True, unbiased=False)
    return (x - m) / torch.sqrt(v + eps)
def _scatter_add(tgt, idx, src, axis=0):
    return tgt.clone().index_add_(axis, idx, src)
def _segment_sum(src, seg, n):
    out = torch.zeros((n,) + src.shape[1:], dtype=src.dtype)
    return out.index_add_(0, seg, src)
def _pad(x, pw):
    flat = tuple(v for pair in reversed(pw) for v in pair)
    return torch.nn.functional.pad(x, flat)

kernel_name = 'interleave_layers__softmax_full_mha__dense_activation_mish__prompt'

def setup_inputs():

    _w = (lambda a: (lambda t: t.to(torch.bfloat16) if t.is_floating_point() else t)(torch.as_tensor(a)))
    def _A_setup():
        B, S, D = 1, 2048, 512
        return {
            "x": _w((lambda *s: torch.randn(*s, dtype=torch.bfloat16) * 0.05)(B, S, D)),
            "wqkv": _w((lambda *s: torch.randn(*s, dtype=torch.bfloat16) * 0.05)(D, 3 * D)),
            "wo": _w((lambda *s: torch.randn(*s, dtype=torch.bfloat16) * 0.05)(D, D)),
        }
    _A_in = _A_setup()

    def _B_setup():
        B, S, D, F = 1, 2048, 512, 1792
        return {
            "x": _w((lambda *s: torch.randn(*s, dtype=torch.bfloat16) * 0.05)(B, S, D)),
            "w1": _w((lambda *s: torch.randn(*s, dtype=torch.bfloat16) * 1.6)(D, F) * (D ** -0.5)),
            "b1": _w((lambda *s: torch.randn(*s, dtype=torch.bfloat16) * 0.4)(F)),
            "w2": _w((lambda *s: torch.randn(*s, dtype=torch.bfloat16) * 0.2)(F, D) * (F ** -0.5)),
        }
    _B_in = _B_setup()

    return {
        "A_x": _A_in["x"],
        "A_wqkv": _A_in["wqkv"],
        "A_wo": _A_in["wo"],
        "B_x": _B_in["x"],
        "B_w1": _B_in["w1"],
        "B_b1": _B_in["b1"],
        "B_w2": _B_in["w2"],
    }

def reference(A_x, A_wqkv, A_wo, B_x, B_w1, B_b1, B_w2):
    def _A_ref(x, wqkv, wo):
        B, S, D = x.shape
        H = 32; Dh = D // H
        qkv = (lambda x, *d: x.permute(*d))((x @ wqkv).reshape(B, S, 3, H, Dh), 2, 0, 3, 1, 4)
        q, k, v = qkv[0], qkv[1], qkv[2]
        scale = Dh ** -0.5
        scores = torch.einsum("bhqd,bhkd->bhqk", q, k) * scale
        p = _softmax(scores, axis=-1)
        o = torch.einsum("bhqk,bhkd->bhqd", p, v)
        return (lambda x, *d: x.permute(*d))(o, 0, 2, 1, 3).reshape(B, S, D) @ wo

    def _B_ref(x, w1, b1, w2):
        h = torch.einsum("bsd,df->bsf", x, w1) + b1
        sp = torch.log1p(torch.exp(-torch.abs(h))) + torch.where(h > 0, h, torch.zeros_like(h))
        act = h * torch.tanh(sp)
        return torch.einsum("bsf,fd->bsd", act, w2)

    x = A_x
    x = x + _A_ref(_layernorm(x, axis=-1), A_wqkv, A_wo)
    x = x + _B_ref(_layernorm(x, axis=-1), B_w1, B_b1, B_w2)
    x = x + _A_ref(_layernorm(x, axis=-1), A_wqkv, A_wo)
    x = x + _B_ref(_layernorm(x, axis=-1), B_w1, B_b1, B_w2)
    return x
```

```asm
; @launch kernel=prep_kernel grid=(240,1,1) block=(256,1,1) lds=512
; @launch kernel=qkv_kernel grid=(256,1,1) block=(256,1,1) lds=132096
; @launch kernel=attn_kernel grid=(256,1,1) block=(1024,1,1) lds=153600
; @launch kernel=chain1_kernel grid=(256,1,1) block=(256,1,1) lds=132096
; @launch kernel=attn_kernel grid=(256,1,1) block=(1024,1,1) lds=153600
; @launch kernel=chain2_kernel grid=(256,1,1) block=(256,1,1) lds=132096
.amdgcn_target "amdgcn-amd-amdhsa--gfx950"
.text
.globl prep_kernel
.p2align 8
.type prep_kernel,@function
prep_kernel:
    s_cmp_ge_u32 s2, 240
    s_cbranch_scc1 L_prep_kernel_end
    s_load_dwordx2 s[4:5], s[0:1], 72
    s_load_dwordx4 s[8:11], s[0:1], 0
    s_load_dwordx2 s[12:13], s[0:1], 16
    s_load_dwordx4 s[16:19], s[0:1], 32
    s_load_dwordx2 s[20:21], s[0:1], 48
    v_and_b32 v2, 63, v0
    v_lshrrev_b32 v3, 6, v0
    v_lshlrev_b32 v1, 4, v2
    v_readfirstlane_b32 s3, v3
    s_mov_b32 s6, 0x10000000
    s_mov_b32 s7, 0x00020000
    s_waitcnt lgkmcnt(0)
    v_and_b32 v4, 31, v2
    v_lshrrev_b32 v5, 5, v2
    s_mov_b32 s27, 0x00020000
    s_cmp_ge_u32 s2, 176
    s_cbranch_scc1 L_prep_x
    s_lshl_b32 s30, s3, 3
    s_cmp_ge_u32 s2, 48
    s_cbranch_scc1 L_prep_r1
    s_mov_b32 s24, s10
    s_mov_b32 s25, s11
    s_mov_b32 s26, 1572864
    s_mov_b32 s28, 3072
    s_mov_b32 s29, s2
    s_lshl_b32 s31, s29, 5
    s_add_u32 s31, s31, s30
    s_lshl_b32 s31, s31, 10
    s_add_u32 s31, s31, 0
    s_lshl_b32 s32, s29, 7
    s_add_u32 s32, s32, 5767168
    s_mov_b32 s33, 1
    s_branch L_prep_w
L_prep_r1:
    s_cmp_ge_u32 s2, 64
    s_cbranch_scc1 L_prep_r2
    s_mov_b32 s24, s12
    s_mov_b32 s25, s13
    s_mov_b32 s26, 524288
    s_mov_b32 s28, 1024
    s_sub_u32 s29, s2, 48
    s_lshl_b32 s31, s29, 5
    s_add_u32 s31, s31, s30
    s_lshl_b32 s31, s31, 10
    s_add_u32 s31, s31, 1572864
    s_mov_b32 s32, 0
    s_mov_b32 s33, 0
    s_branch L_prep_w
L_prep_r2:
    s_cmp_ge_u32 s2, 120
    s_cbranch_scc1 L_prep_r3
    s_mov_b32 s24, s16
    s_mov_b32 s25, s17
    s_mov_b32 s26, 1835008
    s_mov_b32 s28, 3584
    s_sub_u32 s29, s2, 64
    s_lshl_b32 s31, s29, 5
    s_add_u32 s31, s31, s30
    s_lshl_b32 s31, s31, 10
    s_add_u32 s31, s31, 2097152
    s_lshl_b32 s32, s29, 7
    s_add_u32 s32, s32, 5775360
    s_mov_b32 s33, 2
    s_branch L_prep_w
L_prep_r3:
    s_mov_b32 s24, s20
    s_mov_b32 s25, s21
    s_mov_b32 s26, 1835008
    s_mov_b32 s28, 1024
    s_sub_u32 s34, s2, 120
    s_lshl_b32 s34, s34, 2
    s_add_u32 s34, s34, s3
    s_and_b32 s29, s34, 15
    s_lshr_b32 s30, s34, 4
    s_lshl_b32 s30, s30, 3
    s_mul_i32 s31, s29, 112
    s_add_u32 s31, s31, s30
    s_lshl_b32 s31, s31, 10
    s_add_u32 s31, s31, 3932160
    s_mov_b32 s32, 0
    s_mov_b32 s33, 0
L_prep_w:
    s_lshl_b32 s34, s28, 2
    v_mul_lo_u32 v6, v5, s34
    s_lshl_b32 s35, s29, 5
    v_add_u32 v7, s35, v4
    v_lshl_add_u32 v10, v7, 1, v6
    s_mul_i32 s34, s28, 1
    v_add_u32 v11, s34, v10
    s_mul_i32 s34, s28, 2
    v_add_u32 v12, s34, v10
    s_mul_i32 s34, s28, 3
    v_add_u32 v13, s34, v10
    s_mul_i32 s34, s28, 8
    v_add_u32 v14, s34, v10
    s_mul_i32 s34, s28, 9
    v_add_u32 v15, s34, v10
    s_mul_i32 s34, s28, 10
    v_add_u32 v16, s34, v10
    s_mul_i32 s34, s28, 11
    v_add_u32 v17, s34, v10
    s_lshl_b32 s34, s28, 4
    s_mul_i32 s35, s30, s34
    buffer_load_ushort v64, v10, s[24:27], s35 offen
    buffer_load_ushort v65, v11, s[24:27], s35 offen
    buffer_load_ushort v66, v12, s[24:27], s35 offen
    buffer_load_ushort v67, v13, s[24:27], s35 offen
    buffer_load_ushort v68, v14, s[24:27], s35 offen
    buffer_load_ushort v69, v15, s[24:27], s35 offen
    buffer_load_ushort v70, v16, s[24:27], s35 offen
    buffer_load_ushort v71, v17, s[24:27], s35 offen
    s_add_u32 s35, s35, s34
    buffer_load_ushort v72, v10, s[24:27], s35 offen
    buffer_load_ushort v73, v11, s[24:27], s35 offen
    buffer_load_ushort v74, v12, s[24:27], s35 offen
    buffer_load_ushort v75, v13, s[24:27], s35 offen
    buffer_load_ushort v76, v14, s[24:27], s35 offen
    buffer_load_ushort v77, v15, s[24:27], s35 offen
    buffer_load_ushort v78, v16, s[24:27], s35 offen
    buffer_load_ushort v79, v17, s[24:27], s35 offen
    s_add_u32 s35, s35, s34
    buffer_load_ushort v80, v10, s[24:27], s35 offen
    buffer_load_ushort v81, v11, s[24:27], s35 offen
    buffer_load_ushort v82, v12, s[24:27], s35 offen
    buffer_load_ushort v83, v13, s[24:27], s35 offen
    buffer_load_ushort v84, v14, s[24:27], s35 offen
    buffer_load_ushort v85, v15, s[24:27], s35 offen
    buffer_load_ushort v86, v16, s[24:27], s35 offen
    buffer_load_ushort v87, v17, s[24:27], s35 offen
    s_add_u32 s35, s35, s34
    buffer_load_ushort v88, v10, s[24:27], s35 offen
    buffer_load_ushort v89, v11, s[24:27], s35 offen
    buffer_load_ushort v90, v12, s[24:27], s35 offen
    buffer_load_ushort v91, v13, s[24:27], s35 offen
    buffer_load_ushort v92, v14, s[24:27], s35 offen
    buffer_load_ushort v93, v15, s[24:27], s35 offen
    buffer_load_ushort v94, v16, s[24:27], s35 offen
    buffer_load_ushort v95, v17, s[24:27], s35 offen
    s_add_u32 s35, s35, s34
    buffer_load_ushort v96, v10, s[24:27], s35 offen
    buffer_load_ushort v97, v11, s[24:27], s35 offen
    buffer_load_ushort v98, v12, s[24:27], s35 offen
    buffer_load_ushort v99, v13, s[24:27], s35 offen
    buffer_load_ushort v100, v14, s[24:27], s35 offen
    buffer_load_ushort v101, v15, s[24:27], s35 offen
    buffer_load_ushort v102, v16, s[24:27], s35 offen
    buffer_load_ushort v103, v17, s[24:27], s35 offen
    s_add_u32 s35, s35, s34
    buffer_load_ushort v104, v10, s[24:27], s35 offen
    buffer_load_ushort v105, v11, s[24:27], s35 offen
    buffer_load_ushort v106, v12, s[24:27], s35 offen
    buffer_load_ushort v107, v13, s[24:27], s35 offen
    buffer_load_ushort v108, v14, s[24:27], s35 offen
    buffer_load_ushort v109, v15, s[24:27], s35 offen
    buffer_load_ushort v110, v16, s[24:27], s35 offen
    buffer_load_ushort v111, v17, s[24:27], s35 offen
    s_add_u32 s35, s35, s34
    buffer_load_ushort v112, v10, s[24:27], s35 offen
    buffer_load_ushort v113, v11, s[24:27], s35 offen
    buffer_load_ushort v114, v12, s[24:27], s35 offen
    buffer_load_ushort v115, v13, s[24:27], s35 offen
    buffer_load_ushort v116, v14, s[24:27], s35 offen
    buffer_load_ushort v117, v15, s[24:27], s35 offen
    buffer_load_ushort v118, v16, s[24:27], s35 offen
    buffer_load_ushort v119, v17, s[24:27], s35 offen
    s_add_u32 s35, s35, s34
    buffer_load_ushort v120, v10, s[24:27], s35 offen
    buffer_load_ushort v121, v11, s[24:27], s35 offen
    buffer_load_ushort v122, v12, s[24:27], s35 offen
    buffer_load_ushort v123, v13, s[24:27], s35 offen
    buffer_load_ushort v124, v14, s[24:27], s35 offen
    buffer_load_ushort v125, v15, s[24:27], s35 offen
    buffer_load_ushort v126, v16, s[24:27], s35 offen
    buffer_load_ushort v127, v17, s[24:27], s35 offen
    s_add_u32 s36, s31, 4096
    s_waitcnt vmcnt(56)
    v_lshl_or_b32 v32, v65, 16, v64
    v_lshl_or_b32 v33, v67, 16, v66
    v_lshl_or_b32 v34, v69, 16, v68
    v_lshl_or_b32 v35, v71, 16, v70
    buffer_store_dwordx4 v[32:35], v1, s[4:7], s31 offen offset:0
    s_waitcnt vmcnt(49)
    v_lshl_or_b32 v36, v73, 16, v72
    v_lshl_or_b32 v37, v75, 16, v74
    v_lshl_or_b32 v38, v77, 16, v76
    v_lshl_or_b32 v39, v79, 16, v78
    buffer_store_dwordx4 v[36:39], v1, s[4:7], s31 offen offset:1024
    s_waitcnt vmcnt(42)
    v_lshl_or_b32 v40, v81, 16, v80
    v_lshl_or_b32 v41, v83, 16, v82
    v_lshl_or_b32 v42, v85, 16, v84
    v_lshl_or_b32 v43, v87, 16, v86
    buffer_store_dwordx4 v[40:43], v1, s[4:7], s31 offen offset:2048
    s_waitcnt vmcnt(35)
    v_lshl_or_b32 v44, v89, 16, v88
    v_lshl_or_b32 v45, v91, 16, v90
    v_lshl_or_b32 v46, v93, 16, v92
    v_lshl_or_b32 v47, v95, 16, v94
    buffer_store_dwordx4 v[44:47], v1, s[4:7], s31 offen offset:3072
    s_waitcnt vmcnt(28)
    v_lshl_or_b32 v48, v97, 16, v96
    v_lshl_or_b32 v49, v99, 16, v98
    v_lshl_or_b32 v50, v101, 16, v100
    v_lshl_or_b32 v51, v103, 16, v102
    buffer_store_dwordx4 v[48:51], v1, s[4:7], s36 offen offset:0
    s_waitcnt vmcnt(21)
    v_lshl_or_b32 v52, v105, 16, v104
    v_lshl_or_b32 v53, v107, 16, v106
    v_lshl_or_b32 v54, v109, 16, v108
    v_lshl_or_b32 v55, v111, 16, v110
    buffer_store_dwordx4 v[52:55], v1, s[4:7], s36 offen offset:1024
    s_waitcnt vmcnt(14)
    v_lshl_or_b32 v56, v113, 16, v112
    v_lshl_or_b32 v57, v115, 16, v114
    v_lshl_or_b32 v58, v117, 16, v116
    v_lshl_or_b32 v59, v119, 16, v118
    buffer_store_dwordx4 v[56:59], v1, s[4:7], s36 offen offset:2048
    s_waitcnt vmcnt(7)
    v_lshl_or_b32 v60, v121, 16, v120
    v_lshl_or_b32 v61, v123, 16, v122
    v_lshl_or_b32 v62, v125, 16, v124
    v_lshl_or_b32 v63, v127, 16, v126
    buffer_store_dwordx4 v[60:63], v1, s[4:7], s36 offen offset:3072
    s_cmp_eq_u32 s33, 0
    s_cbranch_scc1 L_prep_kernel_end
    v_lshlrev_b32 v64, 16, v64
    v_lshlrev_b32 v65, 16, v65
    v_lshlrev_b32 v66, 16, v66
    v_lshlrev_b32 v67, 16, v67
    v_lshlrev_b32 v68, 16, v68
    v_lshlrev_b32 v69, 16, v69
    v_lshlrev_b32 v70, 16, v70
    v_lshlrev_b32 v71, 16, v71
    v_lshlrev_b32 v72, 16, v72
    v_lshlrev_b32 v73, 16, v73
    v_lshlrev_b32 v74, 16, v74
    v_lshlrev_b32 v75, 16, v75
    v_lshlrev_b32 v76, 16, v76
    v_lshlrev_b32 v77, 16, v77
    v_lshlrev_b32 v78, 16, v78
    v_lshlrev_b32 v79, 16, v79
    v_lshlrev_b32 v80, 16, v80
    v_lshlrev_b32 v81, 16, v81
    v_lshlrev_b32 v82, 16, v82
    v_lshlrev_b32 v83, 16, v83
    v_lshlrev_b32 v84, 16, v84
    v_lshlrev_b32 v85, 16, v85
    v_lshlrev_b32 v86, 16, v86
    v_lshlrev_b32 v87, 16, v87
    v_lshlrev_b32 v88, 16, v88
    v_lshlrev_b32 v89, 16, v89
    v_lshlrev_b32 v90, 16, v90
    v_lshlrev_b32 v91, 16, v91
    v_lshlrev_b32 v92, 16, v92
    v_lshlrev_b32 v93, 16, v93
    v_lshlrev_b32 v94, 16, v94
    v_lshlrev_b32 v95, 16, v95
    v_lshlrev_b32 v96, 16, v96
    v_lshlrev_b32 v97, 16, v97
    v_lshlrev_b32 v98, 16, v98
    v_lshlrev_b32 v99, 16, v99
    v_lshlrev_b32 v100, 16, v100
    v_lshlrev_b32 v101, 16, v101
    v_lshlrev_b32 v102, 16, v102
    v_lshlrev_b32 v103, 16, v103
    v_lshlrev_b32 v104, 16, v104
    v_lshlrev_b32 v105, 16, v105
    v_lshlrev_b32 v106, 16, v106
    v_lshlrev_b32 v107, 16, v107
    v_lshlrev_b32 v108, 16, v108
    v_lshlrev_b32 v109, 16, v109
    v_lshlrev_b32 v110, 16, v110
    v_lshlrev_b32 v111, 16, v111
    v_lshlrev_b32 v112, 16, v112
    v_lshlrev_b32 v113, 16, v113
    v_lshlrev_b32 v114, 16, v114
    v_lshlrev_b32 v115, 16, v115
    v_lshlrev_b32 v116, 16, v116
    v_lshlrev_b32 v117, 16, v117
    v_lshlrev_b32 v118, 16, v118
    v_lshlrev_b32 v119, 16, v119
    v_lshlrev_b32 v120, 16, v120
    v_lshlrev_b32 v121, 16, v121
    v_lshlrev_b32 v122, 16, v122
    v_lshlrev_b32 v123, 16, v123
    v_lshlrev_b32 v124, 16, v124
    v_lshlrev_b32 v125, 16, v125
    v_lshlrev_b32 v126, 16, v126
    v_lshlrev_b32 v127, 16, v127
    v_add_f32 v20, v64, v65
    v_add_f32 v20, v20, v66
    v_add_f32 v20, v20, v67
    v_add_f32 v20, v20, v68
    v_add_f32 v20, v20, v69
    v_add_f32 v20, v20, v70
    v_add_f32 v20, v20, v71
    v_add_f32 v20, v20, v72
    v_add_f32 v20, v20, v73
    v_add_f32 v20, v20, v74
    v_add_f32 v20, v20, v75
    v_add_f32 v20, v20, v76
    v_add_f32 v20, v20, v77
    v_add_f32 v20, v20, v78
    v_add_f32 v20, v20, v79
    v_add_f32 v20, v20, v80
    v_add_f32 v20, v20, v81
    v_add_f32 v20, v20, v82
    v_add_f32 v20, v20, v83
    v_add_f32 v20, v20, v84
    v_add_f32 v20, v20, v85
    v_add_f32 v20, v20, v86
    v_add_f32 v20, v20, v87
    v_add_f32 v20, v20, v88
    v_add_f32 v20, v20, v89
    v_add_f32 v20, v20, v90
    v_add_f32 v20, v20, v91
    v_add_f32 v20, v20, v92
    v_add_f32 v20, v20, v93
    v_add_f32 v20, v20, v94
    v_add_f32 v20, v20, v95
    v_add_f32 v20, v20, v96
    v_add_f32 v20, v20, v97
    v_add_f32 v20, v20, v98
    v_add_f32 v20, v20, v99
    v_add_f32 v20, v20, v100
    v_add_f32 v20, v20, v101
    v_add_f32 v20, v20, v102
    v_add_f32 v20, v20, v103
    v_add_f32 v20, v20, v104
    v_add_f32 v20, v20, v105
    v_add_f32 v20, v20, v106
    v_add_f32 v20, v20, v107
    v_add_f32 v20, v20, v108
    v_add_f32 v20, v20, v109
    v_add_f32 v20, v20, v110
    v_add_f32 v20, v20, v111
    v_add_f32 v20, v20, v112
    v_add_f32 v20, v20, v113
    v_add_f32 v20, v20, v114
    v_add_f32 v20, v20, v115
    v_add_f32 v20, v20, v116
    v_add_f32 v20, v20, v117
    v_add_f32 v20, v20, v118
    v_add_f32 v20, v20, v119
    v_add_f32 v20, v20, v120
    v_add_f32 v20, v20, v121
    v_add_f32 v20, v20, v122
    v_add_f32 v20, v20, v123
    v_add_f32 v20, v20, v124
    v_add_f32 v20, v20, v125
    v_add_f32 v20, v20, v126
    v_add_f32 v20, v20, v127
    v_mov_b32 v21, v20
    s_nop 1
    v_permlane32_swap_b32 v20, v21
    s_nop 1
    v_add_f32 v20, v20, v21
    s_lshl_b32 s34, s3, 7
    v_lshlrev_b32 v22, 2, v4
    v_add_u32 v22, s34, v22
    ds_write_b32 v22, v20
    s_waitcnt lgkmcnt(0)
    s_barrier
    s_cmp_lg_u32 s3, 0
    s_cbranch_scc1 L_prep_kernel_end
    v_lshlrev_b32 v22, 2, v4
    ds_read_b32 v23, v22
    ds_read_b32 v24, v22 offset:128
    ds_read_b32 v25, v22 offset:256
    ds_read_b32 v26, v22 offset:384
    v_bfe_u32 v27, v4, 2, 1
    v_lshlrev_b32 v27, 4, v27
    v_lshrrev_b32 v28, 3, v4
    v_lshl_add_u32 v27, v28, 2, v27
    v_and_b32 v28, 3, v4
    v_add_u32 v27, v27, v28
    v_lshlrev_b32 v27, 2, v27
    s_waitcnt lgkmcnt(0)
    v_add_f32 v23, v23, v24
    v_add_f32 v25, v25, v26
    v_add_f32 v23, v23, v25
    buffer_store_dword v23, v27, s[4:7], s32 offen
    s_cmp_lg_u32 s33, 2
    s_cbranch_scc1 L_prep_kernel_end
    s_mov_b32 s40, s18
    s_mov_b32 s41, s19
    s_mov_b32 s42, 3584
    s_mov_b32 s43, 0x00020000
    v_lshlrev_b32 v7, 1, v7
    buffer_load_ushort v29, v7, s[40:43], 0 offen
    s_lshl_b32 s34, s29, 7
    s_add_u32 s34, s34, 5783552
    s_waitcnt vmcnt(0)
    v_lshlrev_b32 v29, 16, v29
    buffer_store_dword v29, v27, s[4:7], s34 offen
    s_branch L_prep_kernel_end
L_prep_x:
    s_mov_b32 s24, s8
    s_mov_b32 s25, s9
    s_mov_b32 s26, 2097152
    s_sub_u32 s29, s2, 176
    s_lshl_b32 s34, s29, 5
    v_add_u32 v6, s34, v4
    v_lshlrev_b32 v7, 10, v6
    v_lshl_add_u32 v7, v5, 3, v7
    s_lshl_b32 s35, s3, 8
    buffer_load_dwordx2 v[32:33], v7, s[24:27], s35 offen offset:0
    buffer_load_dwordx2 v[34:35], v7, s[24:27], s35 offen offset:16
    buffer_load_dwordx2 v[36:37], v7, s[24:27], s35 offen offset:32
    buffer_load_dwordx2 v[38:39], v7, s[24:27], s35 offen offset:48
    buffer_load_dwordx2 v[40:41], v7, s[24:27], s35 offen offset:64
    buffer_load_dwordx2 v[42:43], v7, s[24:27], s35 offen offset:80
    buffer_load_dwordx2 v[44:45], v7, s[24:27], s35 offen offset:96
    buffer_load_dwordx2 v[46:47], v7, s[24:27], s35 offen offset:112
    buffer_load_dwordx2 v[48:49], v7, s[24:27], s35 offen offset:128
    buffer_load_dwordx2 v[50:51], v7, s[24:27], s35 offen offset:144
    buffer_load_dwordx2 v[52:53], v7, s[24:27], s35 offen offset:160
    buffer_load_dwordx2 v[54:55], v7, s[24:27], s35 offen offset:176
    buffer_load_dwordx2 v[56:57], v7, s[24:27], s35 offen offset:192
    buffer_load_dwordx2 v[58:59], v7, s[24:27], s35 offen offset:208
    buffer_load_dwordx2 v[60:61], v7, s[24:27], s35 offen offset:224
    buffer_load_dwordx2 v[62:63], v7, s[24:27], s35 offen offset:240
    s_lshl_b32 s31, s29, 5
    s_lshl_b32 s34, s3, 3
    s_add_u32 s31, s31, s34
    s_lshl_b32 s31, s31, 10
    s_add_u32 s31, s31, 5791744
    s_add_u32 s36, s31, 4096
    v_lshlrev_b32 v8, 4, v4
    s_lshl_b32 s37, s29, 3
    s_lshl_b32 s38, s3, 1
    s_add_u32 s37, s37, s38
    s_lshl_b32 s37, s37, 9
    s_add_u32 s37, s37, 7888896
    s_waitcnt vmcnt(0)
    buffer_store_dwordx4 v[32:35], v1, s[4:7], s31 offen offset:0
    buffer_store_dwordx4 v[36:39], v1, s[4:7], s31 offen offset:1024
    buffer_store_dwordx4 v[40:43], v1, s[4:7], s31 offen offset:2048
    buffer_store_dwordx4 v[44:47], v1, s[4:7], s31 offen offset:3072
    buffer_store_dwordx4 v[48:51], v1, s[4:7], s36 offen offset:0
    buffer_store_dwordx4 v[52:55], v1, s[4:7], s36 offen offset:1024
    buffer_store_dwordx4 v[56:59], v1, s[4:7], s36 offen offset:2048
    buffer_store_dwordx4 v[60:63], v1, s[4:7], s36 offen offset:3072
    v_lshlrev_b32 v12, 16, v32
    v_and_b32 v13, 0xffff0000, v32
    v_add_f32 v20, v12, v13
    v_mul_f32 v21, v12, v12
    v_fmac_f32 v21, v13, v13
    v_lshlrev_b32 v12, 16, v33
    v_and_b32 v13, 0xffff0000, v33
    v_add_f32 v20, v20, v12
    v_add_f32 v20, v20, v13
    v_fmac_f32 v21, v12, v12
    v_fmac_f32 v21, v13, v13
    v_lshlrev_b32 v12, 16, v34
    v_and_b32 v13, 0xffff0000, v34
    v_add_f32 v20, v20, v12
    v_add_f32 v20, v20, v13
    v_fmac_f32 v21, v12, v12
    v_fmac_f32 v21, v13, v13
    v_lshlrev_b32 v12, 16, v35
    v_and_b32 v13, 0xffff0000, v35
    v_add_f32 v20, v20, v12
    v_add_f32 v20, v20, v13
    v_fmac_f32 v21, v12, v12
    v_fmac_f32 v21, v13, v13
    v_lshlrev_b32 v12, 16, v36
    v_and_b32 v13, 0xffff0000, v36
    v_add_f32 v20, v20, v12
    v_add_f32 v20, v20, v13
    v_fmac_f32 v21, v12, v12
    v_fmac_f32 v21, v13, v13
    v_lshlrev_b32 v12, 16, v37
    v_and_b32 v13, 0xffff0000, v37
    v_add_f32 v20, v20, v12
    v_add_f32 v20, v20, v13
    v_fmac_f32 v21, v12, v12
    v_fmac_f32 v21, v13, v13
    v_lshlrev_b32 v12, 16, v38
    v_and_b32 v13, 0xffff0000, v38
    v_add_f32 v20, v20, v12
    v_add_f32 v20, v20, v13
    v_fmac_f32 v21, v12, v12
    v_fmac_f32 v21, v13, v13
    v_lshlrev_b32 v12, 16, v39
    v_and_b32 v13, 0xffff0000, v39
    v_add_f32 v20, v20, v12
    v_add_f32 v20, v20, v13
    v_fmac_f32 v21, v12, v12
    v_fmac_f32 v21, v13, v13
    v_mov_b32 v12, v20
    s_nop 1
    v_permlane32_swap_b32 v20, v12
    s_nop 1
    v_add_f32 v20, v20, v12
    v_mov_b32 v12, v21
    s_nop 1
    v_permlane32_swap_b32 v21, v12
    s_nop 1
    v_add_f32 v21, v21, v12
    buffer_store_dwordx2 v[20:21], v8, s[4:7], s37 offen offset:0
    v_lshlrev_b32 v12, 16, v40
    v_and_b32 v13, 0xffff0000, v40
    v_add_f32 v22, v12, v13
    v_mul_f32 v23, v12, v12
    v_fmac_f32 v23, v13, v13
    v_lshlrev_b32 v12, 16, v41
    v_and_b32 v13, 0xffff0000, v41
    v_add_f32 v22, v22, v12
    v_add_f32 v22, v22, v13
    v_fmac_f32 v23, v12, v12
    v_fmac_f32 v23, v13, v13
    v_lshlrev_b32 v12, 16, v42
    v_and_b32 v13, 0xffff0000, v42
    v_add_f32 v22, v22, v12
    v_add_f32 v22, v22, v13
    v_fmac_f32 v23, v12, v12
    v_fmac_f32 v23, v13, v13
    v_lshlrev_b32 v12, 16, v43
    v_and_b32 v13, 0xffff0000, v43
    v_add_f32 v22, v22, v12
    v_add_f32 v22, v22, v13
    v_fmac_f32 v23, v12, v12
    v_fmac_f32 v23, v13, v13
    v_lshlrev_b32 v12, 16, v44
    v_and_b32 v13, 0xffff0000, v44
    v_add_f32 v22, v22, v12
    v_add_f32 v22, v22, v13
    v_fmac_f32 v23, v12, v12
    v_fmac_f32 v23, v13, v13
    v_lshlrev_b32 v12, 16, v45
    v_and_b32 v13, 0xffff0000, v45
    v_add_f32 v22, v22, v12
    v_add_f32 v22, v22, v13
    v_fmac_f32 v23, v12, v12
    v_fmac_f32 v23, v13, v13
    v_lshlrev_b32 v12, 16, v46
    v_and_b32 v13, 0xffff0000, v46
    v_add_f32 v22, v22, v12
    v_add_f32 v22, v22, v13
    v_fmac_f32 v23, v12, v12
    v_fmac_f32 v23, v13, v13
    v_lshlrev_b32 v12, 16, v47
    v_and_b32 v13, 0xffff0000, v47
    v_add_f32 v22, v22, v12
    v_add_f32 v22, v22, v13
    v_fmac_f32 v23, v12, v12
    v_fmac_f32 v23, v13, v13
    v_mov_b32 v12, v22
    s_nop 1
    v_permlane32_swap_b32 v22, v12
    s_nop 1
    v_add_f32 v22, v22, v12
    v_mov_b32 v12, v23
    s_nop 1
    v_permlane32_swap_b32 v23, v12
    s_nop 1
    v_add_f32 v23, v23, v12
    buffer_store_dwordx2 v[22:23], v8, s[4:7], s37 offen offset:8
    v_lshlrev_b32 v12, 16, v48
    v_and_b32 v13, 0xffff0000, v48
    v_add_f32 v24, v12, v13
    v_mul_f32 v25, v12, v12
    v_fmac_f32 v25, v13, v13
    v_lshlrev_b32 v12, 16, v49
    v_and_b32 v13, 0xffff0000, v49
    v_add_f32 v24, v24, v12
    v_add_f32 v24, v24, v13
    v_fmac_f32 v25, v12, v12
    v_fmac_f32 v25, v13, v13
    v_lshlrev_b32 v12, 16, v50
    v_and_b32 v13, 0xffff0000, v50
    v_add_f32 v24, v24, v12
    v_add_f32 v24, v24, v13
    v_fmac_f32 v25, v12, v12
    v_fmac_f32 v25, v13, v13
    v_lshlrev_b32 v12, 16, v51
    v_and_b32 v13, 0xffff0000, v51
    v_add_f32 v24, v24, v12
    v_add_f32 v24, v24, v13
    v_fmac_f32 v25, v12, v12
    v_fmac_f32 v25, v13, v13
    v_lshlrev_b32 v12, 16, v52
    v_and_b32 v13, 0xffff0000, v52
    v_add_f32 v24, v24, v12
    v_add_f32 v24, v24, v13
    v_fmac_f32 v25, v12, v12
    v_fmac_f32 v25, v13, v13
    v_lshlrev_b32 v12, 16, v53
    v_and_b32 v13, 0xffff0000, v53
    v_add_f32 v24, v24, v12
    v_add_f32 v24, v24, v13
    v_fmac_f32 v25, v12, v12
    v_fmac_f32 v25, v13, v13
    v_lshlrev_b32 v12, 16, v54
    v_and_b32 v13, 0xffff0000, v54
    v_add_f32 v24, v24, v12
    v_add_f32 v24, v24, v13
    v_fmac_f32 v25, v12, v12
    v_fmac_f32 v25, v13, v13
    v_lshlrev_b32 v12, 16, v55
    v_and_b32 v13, 0xffff0000, v55
    v_add_f32 v24, v24, v12
    v_add_f32 v24, v24, v13
    v_fmac_f32 v25, v12, v12
    v_fmac_f32 v25, v13, v13
    v_mov_b32 v12, v24
    s_nop 1
    v_permlane32_swap_b32 v24, v12
    s_nop 1
    v_add_f32 v24, v24, v12
    v_mov_b32 v12, v25
    s_nop 1
    v_permlane32_swap_b32 v25, v12
    s_nop 1
    v_add_f32 v25, v25, v12
    buffer_store_dwordx2 v[24:25], v8, s[4:7], s37 offen offset:512
    v_lshlrev_b32 v12, 16, v56
    v_and_b32 v13, 0xffff0000, v56
    v_add_f32 v26, v12, v13
    v_mul_f32 v27, v12, v12
    v_fmac_f32 v27, v13, v13
    v_lshlrev_b32 v12, 16, v57
    v_and_b32 v13, 0xffff0000, v57
    v_add_f32 v26, v26, v12
    v_add_f32 v26, v26, v13
    v_fmac_f32 v27, v12, v12
    v_fmac_f32 v27, v13, v13
    v_lshlrev_b32 v12, 16, v58
    v_and_b32 v13, 0xffff0000, v58
    v_add_f32 v26, v26, v12
    v_add_f32 v26, v26, v13
    v_fmac_f32 v27, v12, v12
    v_fmac_f32 v27, v13, v13
    v_lshlrev_b32 v12, 16, v59
    v_and_b32 v13, 0xffff0000, v59
    v_add_f32 v26, v26, v12
    v_add_f32 v26, v26, v13
    v_fmac_f32 v27, v12, v12
    v_fmac_f32 v27, v13, v13
    v_lshlrev_b32 v12, 16, v60
    v_and_b32 v13, 0xffff0000, v60
    v_add_f32 v26, v26, v12
    v_add_f32 v26, v26, v13
    v_fmac_f32 v27, v12, v12
    v_fmac_f32 v27, v13, v13
    v_lshlrev_b32 v12, 16, v61
    v_and_b32 v13, 0xffff0000, v61
    v_add_f32 v26, v26, v12
    v_add_f32 v26, v26, v13
    v_fmac_f32 v27, v12, v12
    v_fmac_f32 v27, v13, v13
    v_lshlrev_b32 v12, 16, v62
    v_and_b32 v13, 0xffff0000, v62
    v_add_f32 v26, v26, v12
    v_add_f32 v26, v26, v13
    v_fmac_f32 v27, v12, v12
    v_fmac_f32 v27, v13, v13
    v_lshlrev_b32 v12, 16, v63
    v_and_b32 v13, 0xffff0000, v63
    v_add_f32 v26, v26, v12
    v_add_f32 v26, v26, v13
    v_fmac_f32 v27, v12, v12
    v_fmac_f32 v27, v13, v13
    v_mov_b32 v12, v26
    s_nop 1
    v_permlane32_swap_b32 v26, v12
    s_nop 1
    v_add_f32 v26, v26, v12
    v_mov_b32 v12, v27
    s_nop 1
    v_permlane32_swap_b32 v27, v12
    s_nop 1
    v_add_f32 v27, v27, v12
    buffer_store_dwordx2 v[26:27], v8, s[4:7], s37 offen offset:520
L_prep_kernel_fin:
L_prep_kernel_end:
    s_endpgm
.globl qkv_kernel
.p2align 8
.type qkv_kernel,@function
qkv_kernel:
    s_cmp_ge_u32 s2, 256
    s_cbranch_scc1 L_qkv_kernel_end
    s_load_dwordx2 s[4:5], s[0:1], 72
    v_and_b32 v2, 63, v0
    v_lshrrev_b32 v3, 6, v0
    v_lshlrev_b32 v1, 4, v2
    v_readfirstlane_b32 s3, v3
    s_mov_b32 s6, 0x10000000
    s_mov_b32 s7, 0x00020000
    s_waitcnt lgkmcnt(0)
    v_and_b32 v4, 31, v2
    v_lshrrev_b32 v5, 5, v2
    s_and_b32 s61, s2, 7
    s_lshr_b32 s62, s2, 3
    s_lshr_b32 s60, s61, 1
    s_lshl_b32 s60, s60, 2
    s_and_b32 s63, s62, 3
    s_add_u32 s60, s60, s63
    s_lshr_b32 s62, s62, 2
    s_and_b32 s61, s61, 1
    s_cmp_ge_u32 s62, 6
    s_cbranch_scc1 L_qkv_kernel_end
    s_lshl_b32 s8, s60, 2
    s_mul_i32 s9, s61, 6
    s_add_u32 s9, s9, s62
    s_lshl_b32 s9, s9, 2
    s_add_u32 s19, s9, s3
    s_add_u32 s10, s8, s3
    s_lshl_b32 s10, s10, 15
    s_add_u32 s10, s10, 5791744
    s_lshl_b32 s12, s3, 15
    s_mul_i32 s70, s61, 6
    s_add_u32 s70, s70, s62
    s_lshl_b32 s70, s70, 2
    s_add_u32 s70, s70, s3
    s_lshl_b32 s70, s70, 15
    s_add_u32 s70, s70, 0
    s_add_u32 m0, s12, 0
    s_nop 0
    buffer_load_dwordx4 v1, s[4:7], s10 offen offset:0 lds
    buffer_load_dwordx4 v1, s[4:7], s10 offen offset:1024 lds
    buffer_load_dwordx4 v1, s[4:7], s10 offen offset:2048 lds
    buffer_load_dwordx4 v1, s[4:7], s10 offen offset:3072 lds
    s_add_u32 s10, s10, 4096
    buffer_load_dwordx4 a[0:3], v1, s[4:7], s70 offen offset:0
    buffer_load_dwordx4 a[4:7], v1, s[4:7], s70 offen offset:1024
    buffer_load_dwordx4 a[8:11], v1, s[4:7], s70 offen offset:2048
    buffer_load_dwordx4 a[12:15], v1, s[4:7], s70 offen offset:3072
    s_add_u32 s70, s70, 4096
    s_add_u32 m0, s12, 4096
    s_nop 0
    buffer_load_dwordx4 v1, s[4:7], s10 offen offset:0 lds
    buffer_load_dwordx4 v1, s[4:7], s10 offen offset:1024 lds
    buffer_load_dwordx4 v1, s[4:7], s10 offen offset:2048 lds
    buffer_load_dwordx4 v1, s[4:7], s10 offen offset:3072 lds
    s_add_u32 s10, s10, 4096
    buffer_load_dwordx4 a[16:19], v1, s[4:7], s70 offen offset:0
    buffer_load_dwordx4 a[20:23], v1, s[4:7], s70 offen offset:1024
    buffer_load_dwordx4 a[24:27], v1, s[4:7], s70 offen offset:2048
    buffer_load_dwordx4 a[28:31], v1, s[4:7], s70 offen offset:3072
    s_add_u32 s70, s70, 4096
    v_add_u32 v11, 0x10000, v1
    s_lshl_b32 s26, s3, 8
    v_lshlrev_b32 v12, 3, v4
    v_add_u32 v13, 131072, v12
    v_add_u32 v12, s26, v13
    s_cmp_ge_u32 s9, 32
    s_cbranch_scc1 L_qkv_1_v
    s_cmp_lt_u32 s9, 16
    s_cselect_b32 s27, 0x3eb8aa3b, 1.0
    s_mov_b32 s28, 8151040
    s_mov_b32 s29, 8151040
    s_cselect_b32 s28, s28, s29
    s_lshl_b32 s30, s19, 7
    s_add_u32 s30, s30, s8
    s_lshl_b32 s30, s30, 10
    s_add_u32 s30, s30, s28
    s_add_u32 s31, s30, 65536
    s_waitcnt vmcnt(12)
    s_barrier
    ds_read_b128 v[80:83], v1 offset:0
    ds_read_b128 v[84:87], v1 offset:32768
    ds_read_b128 v[88:91], v11 offset:0
    ds_read_b128 v[92:95], v11 offset:32768
    ds_read_b128 v[96:99], v1 offset:1024
    ds_read_b128 v[100:103], v1 offset:33792
    ds_read_b128 v[104:107], v11 offset:1024
    ds_read_b128 v[108:111], v11 offset:33792
    s_waitcnt vmcnt(8)
    s_waitcnt lgkmcnt(7)
    v_mfma_f32_32x32x16_bf16 v[16:31], a[0:3], v[80:83], 0
    s_add_u32 m0, s12, 8192
    s_waitcnt lgkmcnt(6)
    v_mfma_f32_32x32x16_bf16 v[32:47], a[0:3], v[84:87], 0
    s_nop 0
    s_waitcnt lgkmcnt(5)
    v_mfma_f32_32x32x16_bf16 v[48:63], a[0:3], v[88:91], 0
    buffer_load_dwordx4 v1, s[4:7], s10 offen offset:0 lds
    s_waitcnt lgkmcnt(4)
    v_mfma_f32_32x32x16_bf16 v[64:79], a[0:3], v[92:95], 0
    buffer_load_dwordx4 v1, s[4:7], s10 offen offset:1024 lds
    ds_read_b128 v[80:83], v1 offset:2048
    ds_read_b128 v[84:87], v1 offset:34816
    ds_read_b128 v[88:91], v11 offset:2048
    ds_read_b128 v[92:95], v11 offset:34816
    s_waitcnt lgkmcnt(7)
    v_mfma_f32_32x32x16_bf16 v[16:31], a[4:7], v[96:99], v[16:31]
    buffer_load_dwordx4 v1, s[4:7], s10 offen offset:2048 lds
    s_waitcnt lgkmcnt(6)
    v_mfma_f32_32x32x16_bf16 v[32:47], a[4:7], v[100:103], v[32:47]
    buffer_load_dwordx4 v1, s[4:7], s10 offen offset:3072 lds
    s_waitcnt lgkmcnt(5)
    v_mfma_f32_32x32x16_bf16 v[48:63], a[4:7], v[104:107], v[48:63]
    s_add_u32 s10, s10, 4096
    s_waitcnt lgkmcnt(4)
    v_mfma_f32_32x32x16_bf16 v[64:79], a[4:7], v[108:111], v[64:79]
    buffer_load_dwordx4 a[32:35], v1, s[4:7], s70 offen offset:0
    ds_read_b128 v[96:99], v1 offset:3072
    ds_read_b128 v[100:103], v1 offset:35840
    ds_read_b128 v[104:107], v11 offset:3072
    ds_read_b128 v[108:111], v11 offset:35840
    s_waitcnt lgkmcnt(7)
    v_mfma_f32_32x32x16_bf16 v[16:31], a[8:11], v[80:83], v[16:31]
    buffer_load_dwordx4 a[36:39], v1, s[4:7], s70 offen offset:1024
    s_waitcnt lgkmcnt(6)
    v_mfma_f32_32x32x16_bf16 v[32:47], a[8:11], v[84:87], v[32:47]
    buffer_load_dwordx4 a[40:43], v1, s[4:7], s70 offen offset:2048
    s_waitcnt lgkmcnt(5)
    v_mfma_f32_32x32x16_bf16 v[48:63], a[8:11], v[88:91], v[48:63]
    buffer_load_dwordx4 a[44:47], v1, s[4:7], s70 offen offset:3072
    s_waitcnt lgkmcnt(4)
    v_mfma_f32_32x32x16_bf16 v[64:79], a[8:11], v[92:95], v[64:79]
    s_add_u32 s70, s70, 4096
    s_waitcnt vmcnt(12)
    s_barrier
    ds_read_b128 v[80:83], v1 offset:4096
    ds_read_b128 v[84:87], v1 offset:36864
    ds_read_b128 v[88:91], v11 offset:4096
    ds_read_b128 v[92:95], v11 offset:36864
    s_waitcnt lgkmcnt(7)
    v_mfma_f32_32x32x16_bf16 v[16:31], a[12:15], v[96:99], v[16:31]
    s_waitcnt lgkmcnt(6)
    v_mfma_f32_32x32x16_bf16 v[32:47], a[12:15], v[100:103], v[32:47]
    s_waitcnt lgkmcnt(5)
    v_mfma_f32_32x32x16_bf16 v[48:63], a[12:15], v[104:107], v[48:63]
    s_waitcnt lgkmcnt(4)
    v_mfma_f32_32x32x16_bf16 v[64:79], a[12:15], v[108:111], v[64:79]
    ds_read_b128 v[96:99], v1 offset:5120
    ds_read_b128 v[100:103], v1 offset:37888
    ds_read_b128 v[104:107], v11 offset:5120
    ds_read_b128 v[108:111], v11 offset:37888
    s_waitcnt vmcnt(8)
    s_waitcnt lgkmcnt(7)
    v_mfma_f32_32x32x16_bf16 v[16:31], a[16:19], v[80:83], v[16:31]
    s_add_u32 m0, s12, 12288
    s_nop 0
    buffer_load_dwordx4 v1, s[4:7], s10 offen offset:0 lds
    s_waitcnt lgkmcnt(6)
    v_mfma_f32_32x32x16_bf16 v[32:47], a[16:19], v[84:87], v[32:47]
    buffer_load_dwordx4 v1, s[4:7], s10 offen offset:1024 lds
    buffer_load_dwordx4 v1, s[4:7], s10 offen offset:2048 lds
    buffer_load_dwordx4 v1, s[4:7], s10 offen offset:3072 lds
    s_waitcnt lgkmcnt(5)
    v_mfma_f32_32x32x16_bf16 v[48:63], a[16:19], v[88:91], v[48:63]
    s_add_u32 s10, s10, 4096
    buffer_load_dwordx4 a[48:51], v1, s[4:7], s70 offen offset:0
    buffer_load_dwordx4 a[52:55], v1, s[4:7], s70 offen offset:1024
    s_waitcnt lgkmcnt(4)
    v_mfma_f32_32x32x16_bf16 v[64:79], a[16:19], v[92:95], v[64:79]
    buffer_load_dwordx4 a[56:59], v1, s[4:7], s70 offen offset:2048
    buffer_load_dwordx4 a[60:63], v1, s[4:7], s70 offen offset:3072
    s_add_u32 s70, s70, 4096
    ds_read_b128 v[80:83], v1 offset:6144
    ds_read_b128 v[84:87], v1 offset:38912
    ds_read_b128 v[88:91], v11 offset:6144
    ds_read_b128 v[92:95], v11 offset:38912
    s_waitcnt lgkmcnt(7)
    v_mfma_f32_32x32x16_bf16 v[16:31], a[20:23], v[96:99], v[16:31]
    s_add_u32 s21, s8, s3
    s_lshl_b32 s21, s21, 12
    s_add_u32 s21, s21, 7888896
    s_waitcnt lgkmcnt(6)
    v_mfma_f32_32x32x16_bf16 v[32:47], a[20:23], v[100:103], v[32:47]
    buffer_load_dwordx4 v[168:171], v1, s[4:7], s21 offen offset:0
    buffer_load_dwordx4 v[172:175], v1, s[4:7], s21 offen offset:1024
    buffer_load_dwordx4 v[176:179], v1, s[4:7], s21 offen offset:2048
    s_waitcnt lgkmcnt(5)
    v_mfma_f32_32x32x16_bf16 v[48:63], a[20:23], v[104:107], v[48:63]
    buffer_load_dwordx4 v[180:183], v1, s[4:7], s21 offen offset:3072
    v_lshlrev_b32 v14, 6, v5
    s_waitcnt lgkmcnt(4)
    v_mfma_f32_32x32x16_bf16 v[64:79], a[20:23], v[108:111], v[64:79]
    s_lshl_b32 s22, s19, 7
    s_add_u32 s22, s22, 5767168
    ds_read_b128 v[96:99], v1 offset:7168
    ds_read_b128 v[100:103], v1 offset:39936
    ds_read_b128 v[104:107], v11 offset:7168
    ds_read_b128 v[108:111], v11 offset:39936
    s_waitcnt lgkmcnt(7)
    v_mfma_f32_32x32x16_bf16 v[16:31], a[24:27], v[80:83], v[16:31]
    buffer_load_dwordx4 v[112:115], v14, s[4:7], s22 offen offset:0
    buffer_load_dwordx4 v[116:119], v14, s[4:7], s22 offen offset:16
    s_waitcnt lgkmcnt(6)
    v_mfma_f32_32x32x16_bf16 v[32:47], a[24:27], v[84:87], v[32:47]
    buffer_load_dwordx4 v[120:123], v14, s[4:7], s22 offen offset:32
    buffer_load_dwordx4 v[124:127], v14, s[4:7], s22 offen offset:48
    s_waitcnt lgkmcnt(5)
    v_mfma_f32_32x32x16_bf16 v[48:63], a[24:27], v[88:91], v[48:63]
    v_bfe_u32 v15, v4, 2, 1
    v_lshlrev_b32 v15, 4, v15
    s_waitcnt lgkmcnt(4)
    v_mfma_f32_32x32x16_bf16 v[64:79], a[24:27], v[92:95], v[64:79]
    v_lshrrev_b32 v3, 3, v4
    v_lshl_add_u32 v15, v3, 2, v15
    s_waitcnt vmcnt(20)
    s_barrier
    ds_read_b128 v[80:83], v1 offset:8192
    ds_read_b128 v[84:87], v1 offset:40960
    ds_read_b128 v[88:91], v11 offset:8192
    ds_read_b128 v[92:95], v11 offset:40960
    s_waitcnt lgkmcnt(7)
    v_mfma_f32_32x32x16_bf16 v[16:31], a[28:31], v[96:99], v[16:31]
    v_and_b32 v3, 3, v4
    v_add_u32 v15, v15, v3
    s_waitcnt lgkmcnt(6)
    v_mfma_f32_32x32x16_bf16 v[32:47], a[28:31], v[100:103], v[32:47]
    v_lshlrev_b32 v15, 2, v15
    buffer_load_dword v128, v15, s[4:7], s22 offen
    s_waitcnt lgkmcnt(5)
    v_mfma_f32_32x32x16_bf16 v[48:63], a[28:31], v[104:107], v[48:63]
    s_waitcnt lgkmcnt(4)
    v_mfma_f32_32x32x16_bf16 v[64:79], a[28:31], v[108:111], v[64:79]
    ds_read_b128 v[96:99], v1 offset:9216
    ds_read_b128 v[100:103], v1 offset:41984
    ds_read_b128 v[104:107], v11 offset:9216
    ds_read_b128 v[108:111], v11 offset:41984
    s_waitcnt vmcnt(17)
    s_waitcnt lgkmcnt(7)
    v_mfma_f32_32x32x16_bf16 v[16:31], a[32:35], v[80:83], v[16:31]
    s_add_u32 m0, s12, 16384
    s_waitcnt lgkmcnt(6)
    v_mfma_f32_32x32x16_bf16 v[32:47], a[32:35], v[84:87], v[32:47]
    s_nop 0
    s_waitcnt lgkmcnt(5)
    v_mfma_f32_32x32x16_bf16 v[48:63], a[32:35], v[88:91], v[48:63]
    buffer_load_dwordx4 v1, s[4:7], s10 offen offset:0 lds
    s_waitcnt lgkmcnt(4)
    v_mfma_f32_32x32x16_bf16 v[64:79], a[32:35], v[92:95], v[64:79]
    buffer_load_dwordx4 v1, s[4:7], s10 offen offset:1024 lds
    ds_read_b128 v[80:83], v1 offset:10240
    ds_read_b128 v[84:87], v1 offset:43008
    ds_read_b128 v[88:91], v11 offset:10240
    ds_read_b128 v[92:95], v11 offset:43008
    s_waitcnt lgkmcnt(7)
    v_mfma_f32_32x32x16_bf16 v[16:31], a[36:39], v[96:99], v[16:31]
    buffer_load_dwordx4 v1, s[4:7], s10 offen offset:2048 lds
    s_waitcnt lgkmcnt(6)
    v_mfma_f32_32x32x16_bf16 v[32:47], a[36:39], v[100:103], v[32:47]
    buffer_load_dwordx4 v1, s[4:7], s10 offen offset:3072 lds
    s_waitcnt lgkmcnt(5)
    v_mfma_f32_32x32x16_bf16 v[48:63], a[36:39], v[104:107], v[48:63]
    s_add_u32 s10, s10, 4096
    s_waitcnt lgkmcnt(4)
    v_mfma_f32_32x32x16_bf16 v[64:79], a[36:39], v[108:111], v[64:79]
    buffer_load_dwordx4 a[64:67], v1, s[4:7], s70 offen offset:0
    ds_read_b128 v[96:99], v1 offset:11264
    ds_read_b128 v[100:103], v1 offset:44032
    ds_read_b128 v[104:107], v11 offset:11264
    ds_read_b128 v[108:111], v11 offset:44032
    s_waitcnt lgkmcnt(7)
    v_mfma_f32_32x32x16_bf16 v[16:31], a[40:43], v[80:83], v[16:31]
    buffer_load_dwordx4 a[68:71], v1, s[4:7], s70 offen offset:1024
    s_waitcnt lgkmcnt(6)
    v_mfma_f32_32x32x16_bf16 v[32:47], a[40:43], v[84:87], v[32:47]
    buffer_load_dwordx4 a[72:75], v1, s[4:7], s70 offen offset:2048
    s_waitcnt lgkmcnt(5)
    v_mfma_f32_32x32x16_bf16 v[48:63], a[40:43], v[88:91], v[48:63]
    buffer_load_dwordx4 a[76:79], v1, s[4:7], s70 offen offset:3072
    s_waitcnt lgkmcnt(4)
    v_mfma_f32_32x32x16_bf16 v[64:79], a[40:43], v[92:95], v[64:79]
    s_add_u32 s70, s70, 4096
    s_waitcnt vmcnt(21)
    s_barrier
    ds_read_b128 v[80:83], v1 offset:12288
    ds_read_b128 v[84:87], v1 offset:45056
    ds_read_b128 v[88:91], v11 offset:12288
    ds_read_b128 v[92:95], v11 offset:45056
    s_waitcnt lgkmcnt(7)
    v_mfma_f32_32x32x16_bf16 v[16:31], a[44:47], v[96:99], v[16:31]
    s_waitcnt lgkmcnt(6)
    v_mfma_f32_32x32x16_bf16 v[32:47], a[44:47], v[100:103], v[32:47]
    s_waitcnt lgkmcnt(5)
    v_mfma_f32_32x32x16_bf16 v[48:63], a[44:47], v[104:107], v[48:63]
    s_waitcnt lgkmcnt(4)
    v_mfma_f32_32x32x16_bf16 v[64:79], a[44:47], v[108:111], v[64:79]
    ds_read_b128 v[96:99], v1 offset:13312
    ds_read_b128 v[100:103], v1 offset:46080
    ds_read_b128 v[104:107], v11 offset:13312
    ds_read_b128 v[108:111], v11 offset:46080
    s_waitcnt vmcnt(17)
    s_waitcnt lgkmcnt(7)
    v_mfma_f32_32x32x16_bf16 v[16:31], a[48:51], v[80:83], v[16:31]
    s_add_u32 m0, s12, 20480
    s_waitcnt lgkmcnt(6)
    v_mfma_f32_32x32x16_bf16 v[32:47], a[48:51], v[84:87], v[32:47]
    s_nop 0
    s_waitcnt lgkmcnt(5)
    v_mfma_f32_32x32x16_bf16 v[48:63], a[48:51], v[88:91], v[48:63]
    buffer_load_dwordx4 v1, s[4:7], s10 offen offset:0 lds
    s_waitcnt lgkmcnt(4)
    v_mfma_f32_32x32x16_bf16 v[64:79], a[48:51], v[92:95], v[64:79]
    buffer_load_dwordx4 v1, s[4:7], s10 offen offset:1024 lds
    ds_read_b128 v[80:83], v1 offset:14336
    ds_read_b128 v[84:87], v1 offset:47104
    ds_read_b128 v[88:91], v11 offset:14336
    ds_read_b128 v[92:95], v11 offset:47104
    s_waitcnt lgkmcnt(7)
    v_mfma_f32_32x32x16_bf16 v[16:31], a[52:55], v[96:99], v[16:31]
    buffer_load_dwordx4 v1, s[4:7], s10 offen offset:2048 lds
    s_waitcnt lgkmcnt(6)
    v_mfma_f32_32x32x16_bf16 v[32:47], a[52:55], v[100:103], v[32:47]
    buffer_load_dwordx4 v1, s[4:7], s10 offen offset:3072 lds
    s_waitcnt lgkmcnt(5)
    v_mfma_f32_32x32x16_bf16 v[48:63], a[52:55], v[104:107], v[48:63]
    s_add_u32 s10, s10, 4096
    s_waitcnt lgkmcnt(4)
    v_mfma_f32_32x32x16_bf16 v[64:79], a[52:55], v[108:111], v[64:79]
    buffer_load_dwordx4 a[80:83], v1, s[4:7], s70 offen offset:0
    ds_read_b128 v[96:99], v1 offset:15360
    ds_read_b128 v[100:103], v1 offset:48128
    ds_read_b128 v[104:107], v11 offset:15360
    ds_read_b128 v[108:111], v11 offset:48128
    s_waitcnt lgkmcnt(7)
    v_mfma_f32_32x32x16_bf16 v[16:31], a[56:59], v[80:83], v[16:31]
    buffer_load_dwordx4 a[84:87], v1, s[4:7], s70 offen offset:1024
    s_waitcnt lgkmcnt(6)
    v_mfma_f32_32x32x16_bf16 v[32:47], a[56:59], v[84:87], v[32:47]
    buffer_load_dwordx4 a[88:91], v1, s[4:7], s70 offen offset:2048
    s_waitcnt lgkmcnt(5)
    v_mfma_f32_32x32x16_bf16 v[48:63], a[56:59], v[88:91], v[48:63]
    buffer_load_dwordx4 a[92:95], v1, s[4:7], s70 offen offset:3072
    s_waitcnt lgkmcnt(4)
    v_mfma_f32_32x32x16_bf16 v[64:79], a[56:59], v[92:95], v[64:79]
    s_add_u32 s70, s70, 4096
    s_waitcnt vmcnt(12)
    s_barrier
    ds_read_b128 v[80:83], v1 offset:16384
    ds_read_b128 v[84:87], v1 offset:49152
    ds_read_b128 v[88:91], v11 offset:16384
    ds_read_b128 v[92:95], v11 offset:49152
    s_waitcnt lgkmcnt(7)
    v_mfma_f32_32x32x16_bf16 v[16:31], a[60:63], v[96:99], v[16:31]
    s_waitcnt lgkmcnt(6)
    v_mfma_f32_32x32x16_bf16 v[32:47], a[60:63], v[100:103], v[32:47]
    s_waitcnt lgkmcnt(5)
    v_mfma_f32_32x32x16_bf16 v[48:63], a[60:63], v[104:107], v[48:63]
    s_waitcnt lgkmcnt(4)
    v_mfma_f32_32x32x16_bf16 v[64:79], a[60:63], v[108:111], v[64:79]
    ds_read_b128 v[96:99], v1 offset:17408
    ds_read_b128 v[100:103], v1 offset:50176
    ds_read_b128 v[104:107], v11 offset:17408
    ds_read_b128 v[108:111], v11 offset:50176
    s_waitcnt vmcnt(8)
    s_waitcnt lgkmcnt(7)
    v_mfma_f32_32x32x16_bf16 v[16:31], a[64:67], v[80:83], v[16:31]
    s_add_u32 m0, s12, 24576
    s_waitcnt lgkmcnt(6)
    v_mfma_f32_32x32x16_bf16 v[32:47], a[64:67], v[84:87], v[32:47]
    s_nop 0
    s_waitcnt lgkmcnt(5)
    v_mfma_f32_32x32x16_bf16 v[48:63], a[64:67], v[88:91], v[48:63]
    buffer_load_dwordx4 v1, s[4:7], s10 offen offset:0 lds
    s_waitcnt lgkmcnt(4)
    v_mfma_f32_32x32x16_bf16 v[64:79], a[64:67], v[92:95], v[64:79]
    buffer_load_dwordx4 v1, s[4:7], s10 offen offset:1024 lds
    ds_read_b128 v[80:83], v1 offset:18432
    ds_read_b128 v[84:87], v1 offset:51200
    ds_read_b128 v[88:91], v11 offset:18432
    ds_read_b128 v[92:95], v11 offset:51200
    s_waitcnt lgkmcnt(7)
    v_mfma_f32_32x32x16_bf16 v[16:31], a[68:71], v[96:99], v[16:31]
    buffer_load_dwordx4 v1, s[4:7], s10 offen offset:2048 lds
    s_waitcnt lgkmcnt(6)
    v_mfma_f32_32x32x16_bf16 v[32:47], a[68:71], v[100:103], v[32:47]
    buffer_load_dwordx4 v1, s[4:7], s10 offen offset:3072 lds
    s_waitcnt lgkmcnt(5)
    v_mfma_f32_32x32x16_bf16 v[48:63], a[68:71], v[104:107], v[48:63]
    s_add_u32 s10, s10, 4096
    s_waitcnt lgkmcnt(4)
    v_mfma_f32_32x32x16_bf16 v[64:79], a[68:71], v[108:111], v[64:79]
    buffer_load_dwordx4 a[96:99], v1, s[4:7], s70 offen offset:0
    ds_read_b128 v[96:99], v1 offset:19456
    ds_read_b128 v[100:103], v1 offset:52224
    ds_read_b128 v[104:107], v11 offset:19456
    ds_read_b128 v[108:111], v11 offset:52224
    s_waitcnt lgkmcnt(7)
    v_mfma_f32_32x32x16_bf16 v[16:31], a[72:75], v[80:83], v[16:31]
    buffer_load_dwordx4 a[100:103], v1, s[4:7], s70 offen offset:1024
    s_waitcnt lgkmcnt(6)
    v_mfma_f32_32x32x16_bf16 v[32:47], a[72:75], v[84:87], v[32:47]
    buffer_load_dwordx4 a[104:107], v1, s[4:7], s70 offen offset:2048
    s_waitcnt lgkmcnt(5)
    v_mfma_f32_32x32x16_bf16 v[48:63], a[72:75], v[88:91], v[48:63]
    buffer_load_dwordx4 a[108:111], v1, s[4:7], s70 offen offset:3072
    s_waitcnt lgkmcnt(4)
    v_mfma_f32_32x32x16_bf16 v[64:79], a[72:75], v[92:95], v[64:79]
    s_add_u32 s70, s70, 4096
    s_waitcnt vmcnt(12)
    s_barrier
    ds_read_b128 v[80:83], v1 offset:20480
    ds_read_b128 v[84:87], v1 offset:53248
    ds_read_b128 v[88:91], v11 offset:20480
    ds_read_b128 v[92:95], v11 offset:53248
    s_waitcnt lgkmcnt(7)
    v_mfma_f32_32x32x16_bf16 v[16:31], a[76:79], v[96:99], v[16:31]
    s_waitcnt lgkmcnt(6)
    v_mfma_f32_32x32x16_bf16 v[32:47], a[76:79], v[100:103], v[32:47]
    s_waitcnt lgkmcnt(5)
    v_mfma_f32_32x32x16_bf16 v[48:63], a[76:79], v[104:107], v[48:63]
    s_waitcnt lgkmcnt(4)
    v_mfma_f32_32x32x16_bf16 v[64:79], a[76:79], v[108:111], v[64:79]
    ds_read_b128 v[96:99], v1 offset:21504
    ds_read_b128 v[100:103], v1 offset:54272
    ds_read_b128 v[104:107], v11 offset:21504
    ds_read_b128 v[108:111], v11 offset:54272
    s_waitcnt vmcnt(8)
    s_waitcnt lgkmcnt(7)
    v_mfma_f32_32x32x16_bf16 v[16:31], a[80:83], v[80:83], v[16:31]
    s_add_u32 m0, s12, 28672
    s_nop 0
    buffer_load_dwordx4 v1, s[4:7], s10 offen offset:0 lds
    buffer_load_dwordx4 v1, s[4:7], s10 offen offset:1024 lds
    s_waitcnt lgkmcnt(6)
    v_mfma_f32_32x32x16_bf16 v[32:47], a[80:83], v[84:87], v[32:47]
    buffer_load_dwordx4 v1, s[4:7], s10 offen offset:2048 lds
    buffer_load_dwordx4 v1, s[4:7], s10 offen offset:3072 lds
    s_add_u32 s10, s10, 4096
    buffer_load_dwordx4 a[112:115], v1, s[4:7], s70 offen offset:0
    s_waitcnt lgkmcnt(5)
    v_mfma_f32_32x32x16_bf16 v[48:63], a[80:83], v[88:91], v[48:63]
    buffer_load_dwordx4 a[116:119], v1, s[4:7], s70 offen offset:1024
    buffer_load_dwordx4 a[120:123], v1, s[4:7], s70 offen offset:2048
    buffer_load_dwordx4 a[124:127], v1, s[4:7], s70 offen offset:3072
    s_add_u32 s70, s70, 4096
    s_waitcnt lgkmcnt(4)
    v_mfma_f32_32x32x16_bf16 v[64:79], a[80:83], v[92:95], v[64:79]
    s_waitcnt vmcnt(32)
    v_add_f32 v168, v168, v170
    v_add_f32 v169, v169, v171
    v_add_f32 v168, v168, v172
    ds_read_b128 v[80:83], v1 offset:22528
    ds_read_b128 v[84:87], v1 offset:55296
    ds_read_b128 v[88:91], v11 offset:22528
    ds_read_b128 v[92:95], v11 offset:55296
    s_waitcnt lgkmcnt(7)
    v_mfma_f32_32x32x16_bf16 v[16:31], a[84:87], v[96:99], v[16:31]
    v_add_f32 v169, v169, v173
    v_add_f32 v168, v168, v174
    v_add_f32 v169, v169, v175
    s_waitcnt lgkmcnt(6)
    v_mfma_f32_32x32x16_bf16 v[32:47], a[84:87], v[100:103], v[32:47]
    v_add_f32 v168, v168, v176
    v_add_f32 v169, v169, v177
    v_add_f32 v168, v168, v178
    s_waitcnt lgkmcnt(5)
    v_mfma_f32_32x32x16_bf16 v[48:63], a[84:87], v[104:107], v[48:63]
    v_add_f32 v169, v169, v179
    v_add_f32 v168, v168, v180
    v_add_f32 v169, v169, v181
    s_waitcnt lgkmcnt(4)
    v_mfma_f32_32x32x16_bf16 v[64:79], a[84:87], v[108:111], v[64:79]
    v_add_f32 v168, v168, v182
    v_add_f32 v169, v169, v183
    v_mov_b32 v170, v168
    ds_read_b128 v[96:99], v1 offset:23552
    ds_read_b128 v[100:103], v1 offset:56320
    ds_read_b128 v[104:107], v11 offset:23552
    ds_read_b128 v[108:111], v11 offset:56320
    s_waitcnt lgkmcnt(7)
    v_mfma_f32_32x32x16_bf16 v[16:31], a[88:91], v[80:83], v[16:31]
    s_nop 1
    v_permlane32_swap_b32 v168, v170
    s_nop 1
    s_waitcnt lgkmcnt(6)
    v_mfma_f32_32x32x16_bf16 v[32:47], a[88:91], v[84:87], v[32:47]
    v_add_f32 v168, v168, v170
    v_mov_b32 v170, v169
    s_nop 1
    s_waitcnt lgkmcnt(5)
    v_mfma_f32_32x32x16_bf16 v[48:63], a[88:91], v[88:91], v[48:63]
    v_permlane32_swap_b32 v169, v170
    s_nop 1
    v_add_f32 v169, v169, v170
    s_waitcnt lgkmcnt(4)
    v_mfma_f32_32x32x16_bf16 v[64:79], a[88:91], v[92:95], v[64:79]
    v_mul_f32 v168, 0x3b000000, v168
    v_mul_f32 v169, 0x3b000000, v169
    v_fma_f32 v169, -v168, v168, v169
    s_waitcnt vmcnt(12)
    s_barrier
    ds_read_b128 v[80:83], v1 offset:24576
    ds_read_b128 v[84:87], v1 offset:57344
    ds_read_b128 v[88:91], v11 offset:24576
    ds_read_b128 v[92:95], v11 offset:57344
    s_waitcnt lgkmcnt(7)
    v_mfma_f32_32x32x16_bf16 v[16:31], a[92:95], v[96:99], v[16:31]
    v_max_f32 v169, 0, v169
    v_add_f32 v169, 0x3727c5ac, v169
    v_rsq_f32 v169, v169
    s_waitcnt lgkmcnt(6)
    v_mfma_f32_32x32x16_bf16 v[32:47], a[92:95], v[100:103], v[32:47]
    s_nop 0
    v_mul_f32 v168, v168, v169
    ds_write_b64 v12, v[168:169]
    s_waitcnt lgkmcnt(6)
    v_mfma_f32_32x32x16_bf16 v[48:63], a[92:95], v[104:107], v[48:63]
    s_waitcnt lgkmcnt(5)
    v_mfma_f32_32x32x16_bf16 v[64:79], a[92:95], v[108:111], v[64:79]
    ds_read_b128 v[96:99], v1 offset:25600
    ds_read_b128 v[100:103], v1 offset:58368
    ds_read_b128 v[104:107], v11 offset:25600
    ds_read_b128 v[108:111], v11 offset:58368
    s_waitcnt vmcnt(8)
    s_waitcnt lgkmcnt(8)
    v_mfma_f32_32x32x16_bf16 v[16:31], a[96:99], v[80:83], v[16:31]
    s_waitcnt lgkmcnt(7)
    v_mfma_f32_32x32x16_bf16 v[32:47], a[96:99], v[84:87], v[32:47]
    s_waitcnt lgkmcnt(6)
    v_mfma_f32_32x32x16_bf16 v[48:63], a[96:99], v[88:91], v[48:63]
    s_waitcnt lgkmcnt(5)
    v_mfma_f32_32x32x16_bf16 v[64:79], a[96:99], v[92:95], v[64:79]
    ds_read_b128 v[80:83], v1 offset:26624
    ds_read_b128 v[84:87], v1 offset:59392
    ds_read_b128 v[88:91], v11 offset:26624
    ds_read_b128 v[92:95], v11 offset:59392
    s_waitcnt lgkmcnt(7)
    v_mfma_f32_32x32x16_bf16 v[16:31], a[100:103], v[96:99], v[16:31]
    s_waitcnt lgkmcnt(6)
    v_mfma_f32_32x32x16_bf16 v[32:47], a[100:103], v[100:103], v[32:47]
    s_waitcnt lgkmcnt(5)
    v_mfma_f32_32x32x16_bf16 v[48:63], a[100:103], v[104:107], v[48:63]
    s_waitcnt lgkmcnt(4)
    v_mfma_f32_32x32x16_bf16 v[64:79], a[100:103], v[108:111], v[64:79]
    ds_read_b128 v[96:99], v1 offset:27648
    ds_read_b128 v[100:103], v1 offset:60416
    ds_read_b128 v[104:107], v11 offset:27648
    ds_read_b128 v[108:111], v11 offset:60416
    s_waitcnt lgkmcnt(7)
    v_mfma_f32_32x32x16_bf16 v[16:31], a[104:107], v[80:83], v[16:31]
    s_waitcnt lgkmcnt(6)
    v_mfma_f32_32x32x16_bf16 v[32:47], a[104:107], v[84:87], v[32:47]
    s_waitcnt lgkmcnt(5)
    v_mfma_f32_32x32x16_bf16 v[48:63], a[104:107], v[88:91], v[48:63]
    s_waitcnt lgkmcnt(4)
    v_mfma_f32_32x32x16_bf16 v[64:79], a[104:107], v[92:95], v[64:79]
    s_waitcnt vmcnt(4)
    s_waitcnt lgkmcnt(12)
    s_barrier
    ds_read_b64 v[144:145], v13 offset:0
    ds_read_b64 v[146:147], v13 offset:256
    ds_read_b64 v[148:149], v13 offset:512
    ds_read_b64 v[150:151], v13 offset:768
    ds_read_b128 v[80:83], v1 offset:28672
    ds_read_b128 v[84:87], v1 offset:61440
    ds_read_b128 v[88:91], v11 offset:28672
    ds_read_b128 v[92:95], v11 offset:61440
    s_waitcnt lgkmcnt(11)
    v_mfma_f32_32x32x16_bf16 v[16:31], a[108:111], v[96:99], v[16:31]
    s_waitcnt lgkmcnt(10)
    v_mfma_f32_32x32x16_bf16 v[32:47], a[108:111], v[100:103], v[32:47]
    s_waitcnt lgkmcnt(9)
    v_mfma_f32_32x32x16_bf16 v[48:63], a[108:111], v[104:107], v[48:63]
    s_waitcnt lgkmcnt(8)
    v_mfma_f32_32x32x16_bf16 v[64:79], a[108:111], v[108:111], v[64:79]
    ds_read_b128 v[96:99], v1 offset:29696
    ds_read_b128 v[100:103], v1 offset:62464
    ds_read_b128 v[104:107], v11 offset:29696
    ds_read_b128 v[108:111], v11 offset:62464
    s_waitcnt vmcnt(0)
    s_waitcnt lgkmcnt(7)
    v_mfma_f32_32x32x16_bf16 v[16:31], a[112:115], v[80:83], v[16:31]
    s_waitcnt lgkmcnt(6)
    v_mfma_f32_32x32x16_bf16 v[32:47], a[112:115], v[84:87], v[32:47]
    s_waitcnt lgkmcnt(5)
    v_mfma_f32_32x32x16_bf16 v[48:63], a[112:115], v[88:91], v[48:63]
    s_waitcnt lgkmcnt(4)
    v_mfma_f32_32x32x16_bf16 v[64:79], a[112:115], v[92:95], v[64:79]
    ds_read_b128 v[80:83], v1 offset:30720
    ds_read_b128 v[84:87], v1 offset:63488
    ds_read_b128 v[88:91], v11 offset:30720
    ds_read_b128 v[92:95], v11 offset:63488
    s_waitcnt lgkmcnt(7)
    v_mfma_f32_32x32x16_bf16 v[16:31], a[116:119], v[96:99], v[16:31]
    s_waitcnt lgkmcnt(6)
    v_mfma_f32_32x32x16_bf16 v[32:47], a[116:119], v[100:103], v[32:47]
    s_waitcnt lgkmcnt(5)
    v_mfma_f32_32x32x16_bf16 v[48:63], a[116:119], v[104:107], v[48:63]
    s_waitcnt lgkmcnt(4)
    v_mfma_f32_32x32x16_bf16 v[64:79], a[116:119], v[108:111], v[64:79]
    ds_read_b128 v[96:99], v1 offset:31744
    ds_read_b128 v[100:103], v1 offset:64512
    ds_read_b128 v[104:107], v11 offset:31744
    ds_read_b128 v[108:111], v11 offset:64512
    s_waitcnt lgkmcnt(7)
    v_mfma_f32_32x32x16_bf16 v[16:31], a[120:123], v[80:83], v[16:31]
    s_waitcnt lgkmcnt(6)
    v_mfma_f32_32x32x16_bf16 v[32:47], a[120:123], v[84:87], v[32:47]
    s_waitcnt lgkmcnt(5)
    v_mfma_f32_32x32x16_bf16 v[48:63], a[120:123], v[88:91], v[48:63]
    s_waitcnt lgkmcnt(4)
    v_mfma_f32_32x32x16_bf16 v[64:79], a[120:123], v[92:95], v[64:79]
    s_waitcnt lgkmcnt(3)
    v_mfma_f32_32x32x16_bf16 v[16:31], a[124:127], v[96:99], v[16:31]
    s_waitcnt lgkmcnt(2)
    v_mfma_f32_32x32x16_bf16 v[32:47], a[124:127], v[100:103], v[32:47]
    s_waitcnt lgkmcnt(1)
    v_mfma_f32_32x32x16_bf16 v[48:63], a[124:127], v[104:107], v[48:63]
    s_waitcnt lgkmcnt(0)
    v_mfma_f32_32x32x16_bf16 v[64:79], a[124:127], v[108:111], v[64:79]
    s_nop 15
    s_nop 3
    s_waitcnt lgkmcnt(15)
    v_mul_f32 v6, s27, v145
    v_mul_f32 v7, s27, v144
    v_pk_mul_f32 v[16:17], v[16:17], v[6:7] op_sel:[0,0] op_sel_hi:[1,0]
    v_pk_fma_f32 v[16:17], v[6:7], v[112:113], v[16:17] op_sel:[1,0,0] op_sel_hi:[1,1,1] neg_lo:[1,0,0] neg_hi:[1,0,0]
    v_pk_mul_f32 v[18:19], v[18:19], v[6:7] op_sel:[0,0] op_sel_hi:[1,0]
    v_pk_fma_f32 v[18:19], v[6:7], v[114:115], v[18:19] op_sel:[1,0,0] op_sel_hi:[1,1,1] neg_lo:[1,0,0] neg_hi:[1,0,0]
    v_pk_mul_f32 v[20:21], v[20:21], v[6:7] op_sel:[0,0] op_sel_hi:[1,0]
    v_pk_fma_f32 v[20:21], v[6:7], v[116:117], v[20:21] op_sel:[1,0,0] op_sel_hi:[1,1,1] neg_lo:[1,0,0] neg_hi:[1,0,0]
    v_pk_mul_f32 v[22:23], v[22:23], v[6:7] op_sel:[0,0] op_sel_hi:[1,0]
    v_pk_fma_f32 v[22:23], v[6:7], v[118:119], v[22:23] op_sel:[1,0,0] op_sel_hi:[1,1,1] neg_lo:[1,0,0] neg_hi:[1,0,0]
    v_pk_mul_f32 v[24:25], v[24:25], v[6:7] op_sel:[0,0] op_sel_hi:[1,0]
    v_pk_fma_f32 v[24:25], v[6:7], v[120:121], v[24:25] op_sel:[1,0,0] op_sel_hi:[1,1,1] neg_lo:[1,0,0] neg_hi:[1,0,0]
    v_pk_mul_f32 v[26:27], v[26:27], v[6:7] op_sel:[0,0] op_sel_hi:[1,0]
    v_pk_fma_f32 v[26:27], v[6:7], v[122:123], v[26:27] op_sel:[1,0,0] op_sel_hi:[1,1,1] neg_lo:[1,0,0] neg_hi:[1,0,0]
    v_pk_mul_f32 v[28:29], v[28:29], v[6:7] op_sel:[0,0] op_sel_hi:[1,0]
    v_pk_fma_f32 v[28:29], v[6:7], v[124:125], v[28:29] op_sel:[1,0,0] op_sel_hi:[1,1,1] neg_lo:[1,0,0] neg_hi:[1,0,0]
    v_pk_mul_f32 v[30:31], v[30:31], v[6:7] op_sel:[0,0] op_sel_hi:[1,0]
    v_pk_fma_f32 v[30:31], v[6:7], v[126:127], v[30:31] op_sel:[1,0,0] op_sel_hi:[1,1,1] neg_lo:[1,0,0] neg_hi:[1,0,0]
    v_cvt_pk_bf16_f32 v16, v16, v17
    v_cvt_pk_bf16_f32 v17, v18, v19
    v_cvt_pk_bf16_f32 v18, v20, v21
    v_cvt_pk_bf16_f32 v19, v22, v23
    v_cvt_pk_bf16_f32 v20, v24, v25
    v_cvt_pk_bf16_f32 v21, v26, v27
    v_cvt_pk_bf16_f32 v22, v28, v29
    v_cvt_pk_bf16_f32 v23, v30, v31
    buffer_store_dwordx4 v[16:19], v1, s[4:7], s30 offen offset:0
    buffer_store_dwordx4 v[20:23], v1, s[4:7], s31 offen offset:0
    s_waitcnt lgkmcnt(15)
    v_mul_f32 v6, s27, v147
    v_mul_f32 v7, s27, v146
    v_pk_mul_f32 v[32:33], v[32:33], v[6:7] op_sel:[0,0] op_sel_hi:[1,0]
    v_pk_fma_f32 v[32:33], v[6:7], v[112:113], v[32:33] op_sel:[1,0,0] op_sel_hi:[1,1,1] neg_lo:[1,0,0] neg_hi:[1,0,0]
    v_pk_mul_f32 v[34:35], v[34:35], v[6:7] op_sel:[0,0] op_sel_hi:[1,0]
    v_pk_fma_f32 v[34:35], v[6:7], v[114:115], v[34:35] op_sel:[1,0,0] op_sel_hi:[1,1,1] neg_lo:[1,0,0] neg_hi:[1,0,0]
    v_pk_mul_f32 v[36:37], v[36:37], v[6:7] op_sel:[0,0] op_sel_hi:[1,0]
    v_pk_fma_f32 v[36:37], v[6:7], v[116:117], v[36:37] op_sel:[1,0,0] op_sel_hi:[1,1,1] neg_lo:[1,0,0] neg_hi:[1,0,0]
    v_pk_mul_f32 v[38:39], v[38:39], v[6:7] op_sel:[0,0] op_sel_hi:[1,0]
    v_pk_fma_f32 v[38:39], v[6:7], v[118:119], v[38:39] op_sel:[1,0,0] op_sel_hi:[1,1,1] neg_lo:[1,0,0] neg_hi:[1,0,0]
    v_pk_mul_f32 v[40:41], v[40:41], v[6:7] op_sel:[0,0] op_sel_hi:[1,0]
    v_pk_fma_f32 v[40:41], v[6:7], v[120:121], v[40:41] op_sel:[1,0,0] op_sel_hi:[1,1,1] neg_lo:[1,0,0] neg_hi:[1,0,0]
    v_pk_mul_f32 v[42:43], v[42:43], v[6:7] op_sel:[0,0] op_sel_hi:[1,0]
    v_pk_fma_f32 v[42:43], v[6:7], v[122:123], v[42:43] op_sel:[1,0,0] op_sel_hi:[1,1,1] neg_lo:[1,0,0] neg_hi:[1,0,0]
    v_pk_mul_f32 v[44:45], v[44:45], v[6:7] op_sel:[0,0] op_sel_hi:[1,0]
    v_pk_fma_f32 v[44:45], v[6:7], v[124:125], v[44:45] op_sel:[1,0,0] op_sel_hi:[1,1,1] neg_lo:[1,0,0] neg_hi:[1,0,0]
    v_pk_mul_f32 v[46:47], v[46:47], v[6:7] op_sel:[0,0] op_sel_hi:[1,0]
    v_pk_fma_f32 v[46:47], v[6:7], v[126:127], v[46:47] op_sel:[1,0,0] op_sel_hi:[1,1,1] neg_lo:[1,0,0] neg_hi:[1,0,0]
    v_cvt_pk_bf16_f32 v32, v32, v33
    v_cvt_pk_bf16_f32 v33, v34, v35
    v_cvt_pk_bf16_f32 v34, v36, v37
    v_cvt_pk_bf16_f32 v35, v38, v39
    v_cvt_pk_bf16_f32 v36, v40, v41
    v_cvt_pk_bf16_f32 v37, v42, v43
    v_cvt_pk_bf16_f32 v38, v44, v45
    v_cvt_pk_bf16_f32 v39, v46, v47
    buffer_store_dwordx4 v[32:35], v1, s[4:7], s30 offen offset:1024
    buffer_store_dwordx4 v[36:39], v1, s[4:7], s31 offen offset:1024
    s_waitcnt lgkmcnt(15)
    v_mul_f32 v6, s27, v149
    v_mul_f32 v7, s27, v148
    v_pk_mul_f32 v[48:49], v[48:49], v[6:7] op_sel:[0,0] op_sel_hi:[1,0]
    v_pk_fma_f32 v[48:49], v[6:7], v[112:113], v[48:49] op_sel:[1,0,0] op_sel_hi:[1,1,1] neg_lo:[1,0,0] neg_hi:[1,0,0]
    v_pk_mul_f32 v[50:51], v[50:51], v[6:7] op_sel:[0,0] op_sel_hi:[1,0]
    v_pk_fma_f32 v[50:51], v[6:7], v[114:115], v[50:51] op_sel:[1,0,0] op_sel_hi:[1,1,1] neg_lo:[1,0,0] neg_hi:[1,0,0]
    v_pk_mul_f32 v[52:53], v[52:53], v[6:7] op_sel:[0,0] op_sel_hi:[1,0]
    v_pk_fma_f32 v[52:53], v[6:7], v[116:117], v[52:53] op_sel:[1,0,0] op_sel_hi:[1,1,1] neg_lo:[1,0,0] neg_hi:[1,0,0]
    v_pk_mul_f32 v[54:55], v[54:55], v[6:7] op_sel:[0,0] op_sel_hi:[1,0]
    v_pk_fma_f32 v[54:55], v[6:7], v[118:119], v[54:55] op_sel:[1,0,0] op_sel_hi:[1,1,1] neg_lo:[1,0,0] neg_hi:[1,0,0]
    v_pk_mul_f32 v[56:57], v[56:57], v[6:7] op_sel:[0,0] op_sel_hi:[1,0]
    v_pk_fma_f32 v[56:57], v[6:7], v[120:121], v[56:57] op_sel:[1,0,0] op_sel_hi:[1,1,1] neg_lo:[1,0,0] neg_hi:[1,0,0]
    v_pk_mul_f32 v[58:59], v[58:59], v[6:7] op_sel:[0,0] op_sel_hi:[1,0]
    v_pk_fma_f32 v[58:59], v[6:7], v[122:123], v[58:59] op_sel:[1,0,0] op_sel_hi:[1,1,1] neg_lo:[1,0,0] neg_hi:[1,0,0]
    v_pk_mul_f32 v[60:61], v[60:61], v[6:7] op_sel:[0,0] op_sel_hi:[1,0]
    v_pk_fma_f32 v[60:61], v[6:7], v[124:125], v[60:61] op_sel:[1,0,0] op_sel_hi:[1,1,1] neg_lo:[1,0,0] neg_hi:[1,0,0]
    v_pk_mul_f32 v[62:63], v[62:63], v[6:7] op_sel:[0,0] op_sel_hi:[1,0]
    v_pk_fma_f32 v[62:63], v[6:7], v[126:127], v[62:63] op_sel:[1,0,0] op_sel_hi:[1,1,1] neg_lo:[1,0,0] neg_hi:[1,0,0]
    v_cvt_pk_bf16_f32 v48, v48, v49
    v_cvt_pk_bf16_f32 v49, v50, v51
    v_cvt_pk_bf16_f32 v50, v52, v53
    v_cvt_pk_bf16_f32 v51, v54, v55
    v_cvt_pk_bf16_f32 v52, v56, v57
    v_cvt_pk_bf16_f32 v53, v58, v59
    v_cvt_pk_bf16_f32 v54, v60, v61
    v_cvt_pk_bf16_f32 v55, v62, v63
    buffer_store_dwordx4 v[48:51], v1, s[4:7], s30 offen offset:2048
    buffer_store_dwordx4 v[52:55], v1, s[4:7], s31 offen offset:2048
    s_waitcnt lgkmcnt(15)
    v_mul_f32 v6, s27, v151
    v_mul_f32 v7, s27, v150
    v_pk_mul_f32 v[64:65], v[64:65], v[6:7] op_sel:[0,0] op_sel_hi:[1,0]
    v_pk_fma_f32 v[64:65], v[6:7], v[112:113], v[64:65] op_sel:[1,0,0] op_sel_hi:[1,1,1] neg_lo:[1,0,0] neg_hi:[1,0,0]
    v_pk_mul_f32 v[66:67], v[66:67], v[6:7] op_sel:[0,0] op_sel_hi:[1,0]
    v_pk_fma_f32 v[66:67], v[6:7], v[114:115], v[66:67] op_sel:[1,0,0] op_sel_hi:[1,1,1] neg_lo:[1,0,0] neg_hi:[1,0,0]
    v_pk_mul_f32 v[68:69], v[68:69], v[6:7] op_sel:[0,0] op_sel_hi:[1,0]
    v_pk_fma_f32 v[68:69], v[6:7], v[116:117], v[68:69] op_sel:[1,0,0] op_sel_hi:[1,1,1] neg_lo:[1,0,0] neg_hi:[1,0,0]
    v_pk_mul_f32 v[70:71], v[70:71], v[6:7] op_sel:[0,0] op_sel_hi:[1,0]
    v_pk_fma_f32 v[70:71], v[6:7], v[118:119], v[70:71] op_sel:[1,0,0] op_sel_hi:[1,1,1] neg_lo:[1,0,0] neg_hi:[1,0,0]
    v_pk_mul_f32 v[72:73], v[72:73], v[6:7] op_sel:[0,0] op_sel_hi:[1,0]
    v_pk_fma_f32 v[72:73], v[6:7], v[120:121], v[72:73] op_sel:[1,0,0] op_sel_hi:[1,1,1] neg_lo:[1,0,0] neg_hi:[1,0,0]
    v_pk_mul_f32 v[74:75], v[74:75], v[6:7] op_sel:[0,0] op_sel_hi:[1,0]
    v_pk_fma_f32 v[74:75], v[6:7], v[122:123], v[74:75] op_sel:[1,0,0] op_sel_hi:[1,1,1] neg_lo:[1,0,0] neg_hi:[1,0,0]
    v_pk_mul_f32 v[76:77], v[76:77], v[6:7] op_sel:[0,0] op_sel_hi:[1,0]
    v_pk_fma_f32 v[76:77], v[6:7], v[124:125], v[76:77] op_sel:[1,0,0] op_sel_hi:[1,1,1] neg_lo:[1,0,0] neg_hi:[1,0,0]
    v_pk_mul_f32 v[78:79], v[78:79], v[6:7] op_sel:[0,0] op_sel_hi:[1,0]
    v_pk_fma_f32 v[78:79], v[6:7], v[126:127], v[78:79] op_sel:[1,0,0] op_sel_hi:[1,1,1] neg_lo:[1,0,0] neg_hi:[1,0,0]
    v_cvt_pk_bf16_f32 v64, v64, v65
    v_cvt_pk_bf16_f32 v65, v66, v67
    v_cvt_pk_bf16_f32 v66, v68, v69
    v_cvt_pk_bf16_f32 v67, v70, v71
    v_cvt_pk_bf16_f32 v68, v72, v73
    v_cvt_pk_bf16_f32 v69, v74, v75
    v_cvt_pk_bf16_f32 v70, v76, v77
    v_cvt_pk_bf16_f32 v71, v78, v79
    buffer_store_dwordx4 v[64:67], v1, s[4:7], s30 offen offset:3072
    buffer_store_dwordx4 v[68:71], v1, s[4:7], s31 offen offset:3072
    s_branch L_qkv_kernel_fin
L_qkv_1_v:
    v_lshlrev_b32 v7, 5, v5
    v_add_u32 v7, 131072, v7
    v_lshrrev_b32 v8, 4, v4
    v_lshlrev_b32 v8, 16, v8
    v_and_b32 v9, 15, v4
    v_lshl_add_u32 v9, v5, 4, v9
    v_lshl_add_u32 v8, v9, 4, v8
    s_sub_u32 s30, s19, 32
    s_lshl_b32 s30, s30, 7
    s_add_u32 s30, s30, s8
    s_lshl_b32 s30, s30, 10
    s_add_u32 s30, s30, 12345344
    s_waitcnt vmcnt(12)
    s_barrier
    ds_read_b128 v[80:83], v1 offset:0
    ds_read_b128 v[84:87], v1 offset:32768
    ds_read_b128 v[88:91], v11 offset:0
    ds_read_b128 v[92:95], v11 offset:32768
    ds_read_b128 v[96:99], v1 offset:1024
    ds_read_b128 v[100:103], v1 offset:33792
    ds_read_b128 v[104:107], v11 offset:1024
    ds_read_b128 v[108:111], v11 offset:33792
    s_waitcnt vmcnt(8)
    s_waitcnt lgkmcnt(7)
    v_mfma_f32_32x32x16_bf16 v[16:31], v[80:83], a[0:3], 0
    s_add_u32 m0, s12, 8192
    s_waitcnt lgkmcnt(6)
    v_mfma_f32_32x32x16_bf16 v[32:47], v[84:87], a[0:3], 0
    s_nop 0
    s_waitcnt lgkmcnt(5)
    v_mfma_f32_32x32x16_bf16 v[48:63], v[88:91], a[0:3], 0
    buffer_load_dwordx4 v1, s[4:7], s10 offen offset:0 lds
    s_waitcnt lgkmcnt(4)
    v_mfma_f32_32x32x16_bf16 v[64:79], v[92:95], a[0:3], 0
    buffer_load_dwordx4 v1, s[4:7], s10 offen offset:1024 lds
    ds_read_b128 v[80:83], v1 offset:2048
    ds_read_b128 v[84:87], v1 offset:34816
    ds_read_b128 v[88:91], v11 offset:2048
    ds_read_b128 v[92:95], v11 offset:34816
    s_waitcnt lgkmcnt(7)
    v_mfma_f32_32x32x16_bf16 v[16:31], v[96:99], a[4:7], v[16:31]
    buffer_load_dwordx4 v1, s[4:7], s10 offen offset:2048 lds
    s_waitcnt lgkmcnt(6)
    v_mfma_f32_32x32x16_bf16 v[32:47], v[100:103], a[4:7], v[32:47]
    buffer_load_dwordx4 v1, s[4:7], s10 offen offset:3072 lds
    s_waitcnt lgkmcnt(5)
    v_mfma_f32_32x32x16_bf16 v[48:63], v[104:107], a[4:7], v[48:63]
    s_add_u32 s10, s10, 4096
    s_waitcnt lgkmcnt(4)
    v_mfma_f32_32x32x16_bf16 v[64:79], v[108:111], a[4:7], v[64:79]
    buffer_load_dwordx4 a[32:35], v1, s[4:7], s70 offen offset:0
    ds_read_b128 v[96:99], v1 offset:3072
    ds_read_b128 v[100:103], v1 offset:35840
    ds_read_b128 v[104:107], v11 offset:3072
    ds_read_b128 v[108:111], v11 offset:35840
    s_waitcnt lgkmcnt(7)
    v_mfma_f32_32x32x16_bf16 v[16:31], v[80:83], a[8:11], v[16:31]
    buffer_load_dwordx4 a[36:39], v1, s[4:7], s70 offen offset:1024
    s_waitcnt lgkmcnt(6)
    v_mfma_f32_32x32x16_bf16 v[32:47], v[84:87], a[8:11], v[32:47]
    buffer_load_dwordx4 a[40:43], v1, s[4:7], s70 offen offset:2048
    s_waitcnt lgkmcnt(5)
    v_mfma_f32_32x32x16_bf16 v[48:63], v[88:91], a[8:11], v[48:63]
    buffer_load_dwordx4 a[44:47], v1, s[4:7], s70 offen offset:3072
    s_waitcnt lgkmcnt(4)
    v_mfma_f32_32x32x16_bf16 v[64:79], v[92:95], a[8:11], v[64:79]
    s_add_u32 s70, s70, 4096
    s_waitcnt vmcnt(12)
    s_barrier
    ds_read_b128 v[80:83], v1 offset:4096
    ds_read_b128 v[84:87], v1 offset:36864
    ds_read_b128 v[88:91], v11 offset:4096
    ds_read_b128 v[92:95], v11 offset:36864
    s_waitcnt lgkmcnt(7)
    v_mfma_f32_32x32x16_bf16 v[16:31], v[96:99], a[12:15], v[16:31]
    s_waitcnt lgkmcnt(6)
    v_mfma_f32_32x32x16_bf16 v[32:47], v[100:103], a[12:15], v[32:47]
    s_waitcnt lgkmcnt(5)
    v_mfma_f32_32x32x16_bf16 v[48:63], v[104:107], a[12:15], v[48:63]
    s_waitcnt lgkmcnt(4)
    v_mfma_f32_32x32x16_bf16 v[64:79], v[108:111], a[12:15], v[64:79]
    ds_read_b128 v[96:99], v1 offset:5120
    ds_read_b128 v[100:103], v1 offset:37888
    ds_read_b128 v[104:107], v11 offset:5120
    ds_read_b128 v[108:111], v11 offset:37888
    s_waitcnt vmcnt(8)
    s_waitcnt lgkmcnt(7)
    v_mfma_f32_32x32x16_bf16 v[16:31], v[80:83], a[16:19], v[16:31]
    s_add_u32 m0, s12, 12288
    s_nop 0
    buffer_load_dwordx4 v1, s[4:7], s10 offen offset:0 lds
    s_waitcnt lgkmcnt(6)
    v_mfma_f32_32x32x16_bf16 v[32:47], v[84:87], a[16:19], v[32:47]
    buffer_load_dwordx4 v1, s[4:7], s10 offen offset:1024 lds
    buffer_load_dwordx4 v1, s[4:7], s10 offen offset:2048 lds
    buffer_load_dwordx4 v1, s[4:7], s10 offen offset:3072 lds
    s_waitcnt lgkmcnt(5)
    v_mfma_f32_32x32x16_bf16 v[48:63], v[88:91], a[16:19], v[48:63]
    s_add_u32 s10, s10, 4096
    buffer_load_dwordx4 a[48:51], v1, s[4:7], s70 offen offset:0
    buffer_load_dwordx4 a[52:55], v1, s[4:7], s70 offen offset:1024
    s_waitcnt lgkmcnt(4)
    v_mfma_f32_32x32x16_bf16 v[64:79], v[92:95], a[16:19], v[64:79]
    buffer_load_dwordx4 a[56:59], v1, s[4:7], s70 offen offset:2048
    buffer_load_dwordx4 a[60:63], v1, s[4:7], s70 offen offset:3072
    s_add_u32 s70, s70, 4096
    ds_read_b128 v[80:83], v1 offset:6144
    ds_read_b128 v[84:87], v1 offset:38912
    ds_read_b128 v[88:91], v11 offset:6144
    ds_read_b128 v[92:95], v11 offset:38912
    s_waitcnt lgkmcnt(7)
    v_mfma_f32_32x32x16_bf16 v[16:31], v[96:99], a[20:23], v[16:31]
    s_add_u32 s21, s8, s3
    s_lshl_b32 s21, s21, 12
    s_add_u32 s21, s21, 7888896
    s_waitcnt lgkmcnt(6)
    v_mfma_f32_32x32x16_bf16 v[32:47], v[100:103], a[20:23], v[32:47]
    buffer_load_dwordx4 v[168:171], v1, s[4:7], s21 offen offset:0
    buffer_load_dwordx4 v[172:175], v1, s[4:7], s21 offen offset:1024
    buffer_load_dwordx4 v[176:179], v1, s[4:7], s21 offen offset:2048
    s_waitcnt lgkmcnt(5)
    v_mfma_f32_32x32x16_bf16 v[48:63], v[104:107], a[20:23], v[48:63]
    buffer_load_dwordx4 v[180:183], v1, s[4:7], s21 offen offset:3072
    v_lshlrev_b32 v14, 6, v5
    s_waitcnt lgkmcnt(4)
    v_mfma_f32_32x32x16_bf16 v[64:79], v[108:111], a[20:23], v[64:79]
    s_lshl_b32 s22, s19, 7
    s_add_u32 s22, s22, 5767168
    ds_read_b128 v[96:99], v1 offset:7168
    ds_read_b128 v[100:103], v1 offset:39936
    ds_read_b128 v[104:107], v11 offset:7168
    ds_read_b128 v[108:111], v11 offset:39936
    s_waitcnt lgkmcnt(7)
    v_mfma_f32_32x32x16_bf16 v[16:31], v[80:83], a[24:27], v[16:31]
    buffer_load_dwordx4 v[112:115], v14, s[4:7], s22 offen offset:0
    buffer_load_dwordx4 v[116:119], v14, s[4:7], s22 offen offset:16
    s_waitcnt lgkmcnt(6)
    v_mfma_f32_32x32x16_bf16 v[32:47], v[84:87], a[24:27], v[32:47]
    buffer_load_dwordx4 v[120:123], v14, s[4:7], s22 offen offset:32
    buffer_load_dwordx4 v[124:127], v14, s[4:7], s22 offen offset:48
    s_waitcnt lgkmcnt(5)
    v_mfma_f32_32x32x16_bf16 v[48:63], v[88:91], a[24:27], v[48:63]
    v_bfe_u32 v15, v4, 2, 1
    v_lshlrev_b32 v15, 4, v15
    s_waitcnt lgkmcnt(4)
    v_mfma_f32_32x32x16_bf16 v[64:79], v[92:95], a[24:27], v[64:79]
    v_lshrrev_b32 v3, 3, v4
    v_lshl_add_u32 v15, v3, 2, v15
    s_waitcnt vmcnt(20)
    s_barrier
    ds_read_b128 v[80:83], v1 offset:8192
    ds_read_b128 v[84:87], v1 offset:40960
    ds_read_b128 v[88:91], v11 offset:8192
    ds_read_b128 v[92:95], v11 offset:40960
    s_waitcnt lgkmcnt(7)
    v_mfma_f32_32x32x16_bf16 v[16:31], v[96:99], a[28:31], v[16:31]
    v_and_b32 v3, 3, v4
    v_add_u32 v15, v15, v3
    s_waitcnt lgkmcnt(6)
    v_mfma_f32_32x32x16_bf16 v[32:47], v[100:103], a[28:31], v[32:47]
    v_lshlrev_b32 v15, 2, v15
    buffer_load_dword v128, v15, s[4:7], s22 offen
    s_waitcnt lgkmcnt(5)
    v_mfma_f32_32x32x16_bf16 v[48:63], v[104:107], a[28:31], v[48:63]
    s_waitcnt lgkmcnt(4)
    v_mfma_f32_32x32x16_bf16 v[64:79], v[108:111], a[28:31], v[64:79]
    ds_read_b128 v[96:99], v1 offset:9216
    ds_read_b128 v[100:103], v1 offset:41984
    ds_read_b128 v[104:107], v11 offset:9216
    ds_read_b128 v[108:111], v11 offset:41984
    s_waitcnt vmcnt(17)
    s_waitcnt lgkmcnt(7)
    v_mfma_f32_32x32x16_bf16 v[16:31], v[80:83], a[32:35], v[16:31]
    s_add_u32 m0, s12, 16384
    s_waitcnt lgkmcnt(6)
    v_mfma_f32_32x32x16_bf16 v[32:47], v[84:87], a[32:35], v[32:47]
    s_nop 0
    s_waitcnt lgkmcnt(5)
    v_mfma_f32_32x32x16_bf16 v[48:63], v[88:91], a[32:35], v[48:63]
    buffer_load_dwordx4 v1, s[4:7], s10 offen offset:0 lds
    s_waitcnt lgkmcnt(4)
    v_mfma_f32_32x32x16_bf16 v[64:79], v[92:95], a[32:35], v[64:79]
    buffer_load_dwordx4 v1, s[4:7], s10 offen offset:1024 lds
    ds_read_b128 v[80:83], v1 offset:10240
    ds_read_b128 v[84:87], v1 offset:43008
    ds_read_b128 v[88:91], v11 offset:10240
    ds_read_b128 v[92:95], v11 offset:43008
    s_waitcnt lgkmcnt(7)
    v_mfma_f32_32x32x16_bf16 v[16:31], v[96:99], a[36:39], v[16:31]
    buffer_load_dwordx4 v1, s[4:7], s10 offen offset:2048 lds
    s_waitcnt lgkmcnt(6)
    v_mfma_f32_32x32x16_bf16 v[32:47], v[100:103], a[36:39], v[32:47]
    buffer_load_dwordx4 v1, s[4:7], s10 offen offset:3072 lds
    s_waitcnt lgkmcnt(5)
    v_mfma_f32_32x32x16_bf16 v[48:63], v[104:107], a[36:39], v[48:63]
    s_add_u32 s10, s10, 4096
    s_waitcnt lgkmcnt(4)
    v_mfma_f32_32x32x16_bf16 v[64:79], v[108:111], a[36:39], v[64:79]
    buffer_load_dwordx4 a[64:67], v1, s[4:7], s70 offen offset:0
    ds_read_b128 v[96:99], v1 offset:11264
    ds_read_b128 v[100:103], v1 offset:44032
    ds_read_b128 v[104:107], v11 offset:11264
    ds_read_b128 v[108:111], v11 offset:44032
    s_waitcnt lgkmcnt(7)
    v_mfma_f32_32x32x16_bf16 v[16:31], v[80:83], a[40:43], v[16:31]
    buffer_load_dwordx4 a[68:71], v1, s[4:7], s70 offen offset:1024
    s_waitcnt lgkmcnt(6)
    v_mfma_f32_32x32x16_bf16 v[32:47], v[84:87], a[40:43], v[32:47]
    buffer_load_dwordx4 a[72:75], v1, s[4:7], s70 offen offset:2048
    s_waitcnt lgkmcnt(5)
    v_mfma_f32_32x32x16_bf16 v[48:63], v[88:91], a[40:43], v[48:63]
    buffer_load_dwordx4 a[76:79], v1, s[4:7], s70 offen offset:3072
    s_waitcnt lgkmcnt(4)
    v_mfma_f32_32x32x16_bf16 v[64:79], v[92:95], a[40:43], v[64:79]
    s_add_u32 s70, s70, 4096
    s_waitcnt vmcnt(21)
    s_barrier
    ds_read_b128 v[80:83], v1 offset:12288
    ds_read_b128 v[84:87], v1 offset:45056
    ds_read_b128 v[88:91], v11 offset:12288
    ds_read_b128 v[92:95], v11 offset:45056
    s_waitcnt lgkmcnt(7)
    v_mfma_f32_32x32x16_bf16 v[16:31], v[96:99], a[44:47], v[16:31]
    s_waitcnt lgkmcnt(6)
    v_mfma_f32_32x32x16_bf16 v[32:47], v[100:103], a[44:47], v[32:47]
    s_waitcnt lgkmcnt(5)
    v_mfma_f32_32x32x16_bf16 v[48:63], v[104:107], a[44:47], v[48:63]
    s_waitcnt lgkmcnt(4)
    v_mfma_f32_32x32x16_bf16 v[64:79], v[108:111], a[44:47], v[64:79]
    ds_read_b128 v[96:99], v1 offset:13312
    ds_read_b128 v[100:103], v1 offset:46080
    ds_read_b128 v[104:107], v11 offset:13312
    ds_read_b128 v[108:111], v11 offset:46080
    s_waitcnt vmcnt(17)
    s_waitcnt lgkmcnt(7)
    v_mfma_f32_32x32x16_bf16 v[16:31], v[80:83], a[48:51], v[16:31]
    s_add_u32 m0, s12, 20480
    s_waitcnt lgkmcnt(6)
    v_mfma_f32_32x32x16_bf16 v[32:47], v[84:87], a[48:51], v[32:47]
    s_nop 0
    s_waitcnt lgkmcnt(5)
    v_mfma_f32_32x32x16_bf16 v[48:63], v[88:91], a[48:51], v[48:63]
    buffer_load_dwordx4 v1, s[4:7], s10 offen offset:0 lds
    s_waitcnt lgkmcnt(4)
    v_mfma_f32_32x32x16_bf16 v[64:79], v[92:95], a[48:51], v[64:79]
    buffer_load_dwordx4 v1, s[4:7], s10 offen offset:1024 lds
    ds_read_b128 v[80:83], v1 offset:14336
    ds_read_b128 v[84:87], v1 offset:47104
    ds_read_b128 v[88:91], v11 offset:14336
    ds_read_b128 v[92:95], v11 offset:47104
    s_waitcnt lgkmcnt(7)
    v_mfma_f32_32x32x16_bf16 v[16:31], v[96:99], a[52:55], v[16:31]
    buffer_load_dwordx4 v1, s[4:7], s10 offen offset:2048 lds
    s_waitcnt lgkmcnt(6)
    v_mfma_f32_32x32x16_bf16 v[32:47], v[100:103], a[52:55], v[32:47]
    buffer_load_dwordx4 v1, s[4:7], s10 offen offset:3072 lds
    s_waitcnt lgkmcnt(5)
    v_mfma_f32_32x32x16_bf16 v[48:63], v[104:107], a[52:55], v[48:63]
    s_add_u32 s10, s10, 4096
    s_waitcnt lgkmcnt(4)
    v_mfma_f32_32x32x16_bf16 v[64:79], v[108:111], a[52:55], v[64:79]
    buffer_load_dwordx4 a[80:83], v1, s[4:7], s70 offen offset:0
    ds_read_b128 v[96:99], v1 offset:15360
    ds_read_b128 v[100:103], v1 offset:48128
    ds_read_b128 v[104:107], v11 offset:15360
    ds_read_b128 v[108:111], v11 offset:48128
    s_waitcnt lgkmcnt(7)
    v_mfma_f32_32x32x16_bf16 v[16:31], v[80:83], a[56:59], v[16:31]
    buffer_load_dwordx4 a[84:87], v1, s[4:7], s70 offen offset:1024
    s_waitcnt lgkmcnt(6)
    v_mfma_f32_32x32x16_bf16 v[32:47], v[84:87], a[56:59], v[32:47]
    buffer_load_dwordx4 a[88:91], v1, s[4:7], s70 offen offset:2048
    s_waitcnt lgkmcnt(5)
    v_mfma_f32_32x32x16_bf16 v[48:63], v[88:91], a[56:59], v[48:63]
    buffer_load_dwordx4 a[92:95], v1, s[4:7], s70 offen offset:3072
    s_waitcnt lgkmcnt(4)
    v_mfma_f32_32x32x16_bf16 v[64:79], v[92:95], a[56:59], v[64:79]
    s_add_u32 s70, s70, 4096
    s_waitcnt vmcnt(12)
    s_barrier
    ds_read_b128 v[80:83], v1 offset:16384
    ds_read_b128 v[84:87], v1 offset:49152
    ds_read_b128 v[88:91], v11 offset:16384
    ds_read_b128 v[92:95], v11 offset:49152
    s_waitcnt lgkmcnt(7)
    v_mfma_f32_32x32x16_bf16 v[16:31], v[96:99], a[60:63], v[16:31]
    s_waitcnt lgkmcnt(6)
    v_mfma_f32_32x32x16_bf16 v[32:47], v[100:103], a[60:63], v[32:47]
    s_waitcnt lgkmcnt(5)
    v_mfma_f32_32x32x16_bf16 v[48:63], v[104:107], a[60:63], v[48:63]
    s_waitcnt lgkmcnt(4)
    v_mfma_f32_32x32x16_bf16 v[64:79], v[108:111], a[60:63], v[64:79]
    ds_read_b128 v[96:99], v1 offset:17408
    ds_read_b128 v[100:103], v1 offset:50176
    ds_read_b128 v[104:107], v11 offset:17408
    ds_read_b128 v[108:111], v11 offset:50176
    s_waitcnt vmcnt(8)
    s_waitcnt lgkmcnt(7)
    v_mfma_f32_32x32x16_bf16 v[16:31], v[80:83], a[64:67], v[16:31]
    s_add_u32 m0, s12, 24576
    s_waitcnt lgkmcnt(6)
    v_mfma_f32_32x32x16_bf16 v[32:47], v[84:87], a[64:67], v[32:47]
    s_nop 0
    s_waitcnt lgkmcnt(5)
    v_mfma_f32_32x32x16_bf16 v[48:63], v[88:91], a[64:67], v[48:63]
    buffer_load_dwordx4 v1, s[4:7], s10 offen offset:0 lds
    s_waitcnt lgkmcnt(4)
    v_mfma_f32_32x32x16_bf16 v[64:79], v[92:95], a[64:67], v[64:79]
    buffer_load_dwordx4 v1, s[4:7], s10 offen offset:1024 lds
    ds_read_b128 v[80:83], v1 offset:18432
    ds_read_b128 v[84:87], v1 offset:51200
    ds_read_b128 v[88:91], v11 offset:18432
    ds_read_b128 v[92:95], v11 offset:51200
    s_waitcnt lgkmcnt(7)
    v_mfma_f32_32x32x16_bf16 v[16:31], v[96:99], a[68:71], v[16:31]
    buffer_load_dwordx4 v1, s[4:7], s10 offen offset:2048 lds
    s_waitcnt lgkmcnt(6)
    v_mfma_f32_32x32x16_bf16 v[32:47], v[100:103], a[68:71], v[32:47]
    buffer_load_dwordx4 v1, s[4:7], s10 offen offset:3072 lds
    s_waitcnt lgkmcnt(5)
    v_mfma_f32_32x32x16_bf16 v[48:63], v[104:107], a[68:71], v[48:63]
    s_add_u32 s10, s10, 4096
    s_waitcnt lgkmcnt(4)
    v_mfma_f32_32x32x16_bf16 v[64:79], v[108:111], a[68:71], v[64:79]
    buffer_load_dwordx4 a[96:99], v1, s[4:7], s70 offen offset:0
    ds_read_b128 v[96:99], v1 offset:19456
    ds_read_b128 v[100:103], v1 offset:52224
    ds_read_b128 v[104:107], v11 offset:19456
    ds_read_b128 v[108:111], v11 offset:52224
    s_waitcnt lgkmcnt(7)
    v_mfma_f32_32x32x16_bf16 v[16:31], v[80:83], a[72:75], v[16:31]
    buffer_load_dwordx4 a[100:103], v1, s[4:7], s70 offen offset:1024
    s_waitcnt lgkmcnt(6)
    v_mfma_f32_32x32x16_bf16 v[32:47], v[84:87], a[72:75], v[32:47]
    buffer_load_dwordx4 a[104:107], v1, s[4:7], s70 offen offset:2048
    s_waitcnt lgkmcnt(5)
    v_mfma_f32_32x32x16_bf16 v[48:63], v[88:91], a[72:75], v[48:63]
    buffer_load_dwordx4 a[108:111], v1, s[4:7], s70 offen offset:3072
    s_waitcnt lgkmcnt(4)
    v_mfma_f32_32x32x16_bf16 v[64:79], v[92:95], a[72:75], v[64:79]
    s_add_u32 s70, s70, 4096
    s_waitcnt vmcnt(12)
    s_barrier
    ds_read_b128 v[80:83], v1 offset:20480
    ds_read_b128 v[84:87], v1 offset:53248
    ds_read_b128 v[88:91], v11 offset:20480
    ds_read_b128 v[92:95], v11 offset:53248
    s_waitcnt lgkmcnt(7)
    v_mfma_f32_32x32x16_bf16 v[16:31], v[96:99], a[76:79], v[16:31]
    s_waitcnt lgkmcnt(6)
    v_mfma_f32_32x32x16_bf16 v[32:47], v[100:103], a[76:79], v[32:47]
    s_waitcnt lgkmcnt(5)
    v_mfma_f32_32x32x16_bf16 v[48:63], v[104:107], a[76:79], v[48:63]
    s_waitcnt lgkmcnt(4)
    v_mfma_f32_32x32x16_bf16 v[64:79], v[108:111], a[76:79], v[64:79]
    ds_read_b128 v[96:99], v1 offset:21504
    ds_read_b128 v[100:103], v1 offset:54272
    ds_read_b128 v[104:107], v11 offset:21504
    ds_read_b128 v[108:111], v11 offset:54272
    s_waitcnt vmcnt(8)
    s_waitcnt lgkmcnt(7)
    v_mfma_f32_32x32x16_bf16 v[16:31], v[80:83], a[80:83], v[16:31]
    s_add_u32 m0, s12, 28672
    s_nop 0
    buffer_load_dwordx4 v1, s[4:7], s10 offen offset:0 lds
    buffer_load_dwordx4 v1, s[4:7], s10 offen offset:1024 lds
    s_waitcnt lgkmcnt(6)
    v_mfma_f32_32x32x16_bf16 v[32:47], v[84:87], a[80:83], v[32:47]
    buffer_load_dwordx4 v1, s[4:7], s10 offen offset:2048 lds
    buffer_load_dwordx4 v1, s[4:7], s10 offen offset:3072 lds
    s_add_u32 s10, s10, 4096
    buffer_load_dwordx4 a[112:115], v1, s[4:7], s70 offen offset:0
    s_waitcnt lgkmcnt(5)
    v_mfma_f32_32x32x16_bf16 v[48:63], v[88:91], a[80:83], v[48:63]
    buffer_load_dwordx4 a[116:119], v1, s[4:7], s70 offen offset:1024
    buffer_load_dwordx4 a[120:123], v1, s[4:7], s70 offen offset:2048
    buffer_load_dwordx4 a[124:127], v1, s[4:7], s70 offen offset:3072
    s_add_u32 s70, s70, 4096
    s_waitcnt lgkmcnt(4)
    v_mfma_f32_32x32x16_bf16 v[64:79], v[92:95], a[80:83], v[64:79]
    s_waitcnt vmcnt(32)
    v_add_f32 v168, v168, v170
    v_add_f32 v169, v169, v171
    v_add_f32 v168, v168, v172
    ds_read_b128 v[80:83], v1 offset:22528
    ds_read_b128 v[84:87], v1 offset:55296
    ds_read_b128 v[88:91], v11 offset:22528
    ds_read_b128 v[92:95], v11 offset:55296
    s_waitcnt lgkmcnt(7)
    v_mfma_f32_32x32x16_bf16 v[16:31], v[96:99], a[84:87], v[16:31]
    v_add_f32 v169, v169, v173
    v_add_f32 v168, v168, v174
    v_add_f32 v169, v169, v175
    s_waitcnt lgkmcnt(6)
    v_mfma_f32_32x32x16_bf16 v[32:47], v[100:103], a[84:87], v[32:47]
    v_add_f32 v168, v168, v176
    v_add_f32 v169, v169, v177
    v_add_f32 v168, v168, v178
    s_waitcnt lgkmcnt(5)
    v_mfma_f32_32x32x16_bf16 v[48:63], v[104:107], a[84:87], v[48:63]
    v_add_f32 v169, v169, v179
    v_add_f32 v168, v168, v180
    v_add_f32 v169, v169, v181
    s_waitcnt lgkmcnt(4)
    v_mfma_f32_32x32x16_bf16 v[64:79], v[108:111], a[84:87], v[64:79]
    v_add_f32 v168, v168, v182
    v_add_f32 v169, v169, v183
    v_mov_b32 v170, v168
    ds_read_b128 v[96:99], v1 offset:23552
    ds_read_b128 v[100:103], v1 offset:56320
    ds_read_b128 v[104:107], v11 offset:23552
    ds_read_b128 v[108:111], v11 offset:56320
    s_waitcnt lgkmcnt(7)
    v_mfma_f32_32x32x16_bf16 v[16:31], v[80:83], a[88:91], v[16:31]
    s_nop 1
    v_permlane32_swap_b32 v168, v170
    s_nop 1
    s_waitcnt lgkmcnt(6)
    v_mfma_f32_32x32x16_bf16 v[32:47], v[84:87], a[88:91], v[32:47]
    v_add_f32 v168, v168, v170
    v_mov_b32 v170, v169
    s_nop 1
    s_waitcnt lgkmcnt(5)
    v_mfma_f32_32x32x16_bf16 v[48:63], v[88:91], a[88:91], v[48:63]
    v_permlane32_swap_b32 v169, v170
    s_nop 1
    v_add_f32 v169, v169, v170
    s_waitcnt lgkmcnt(4)
    v_mfma_f32_32x32x16_bf16 v[64:79], v[92:95], a[88:91], v[64:79]
    v_mul_f32 v168, 0x3b000000, v168
    v_mul_f32 v169, 0x3b000000, v169
    v_fma_f32 v169, -v168, v168, v169
    s_waitcnt vmcnt(12)
    s_barrier
    ds_read_b128 v[80:83], v1 offset:24576
    ds_read_b128 v[84:87], v1 offset:57344
    ds_read_b128 v[88:91], v11 offset:24576
    ds_read_b128 v[92:95], v11 offset:57344
    s_waitcnt lgkmcnt(7)
    v_mfma_f32_32x32x16_bf16 v[16:31], v[96:99], a[92:95], v[16:31]
    v_max_f32 v169, 0, v169
    v_add_f32 v169, 0x3727c5ac, v169
    v_rsq_f32 v169, v169
    s_waitcnt lgkmcnt(6)
    v_mfma_f32_32x32x16_bf16 v[32:47], v[100:103], a[92:95], v[32:47]
    s_nop 0
    v_mul_f32 v168, v168, v169
    ds_write_b64 v12, v[168:169]
    s_waitcnt lgkmcnt(6)
    v_mfma_f32_32x32x16_bf16 v[48:63], v[104:107], a[92:95], v[48:63]
    s_waitcnt lgkmcnt(5)
    v_mfma_f32_32x32x16_bf16 v[64:79], v[108:111], a[92:95], v[64:79]
    ds_read_b128 v[96:99], v1 offset:25600
    ds_read_b128 v[100:103], v1 offset:58368
    ds_read_b128 v[104:107], v11 offset:25600
    ds_read_b128 v[108:111], v11 offset:58368
    s_waitcnt vmcnt(8)
    s_waitcnt lgkmcnt(8)
    v_mfma_f32_32x32x16_bf16 v[16:31], v[80:83], a[96:99], v[16:31]
    s_waitcnt lgkmcnt(7)
    v_mfma_f32_32x32x16_bf16 v[32:47], v[84:87], a[96:99], v[32:47]
    s_waitcnt lgkmcnt(6)
    v_mfma_f32_32x32x16_bf16 v[48:63], v[88:91], a[96:99], v[48:63]
    s_waitcnt lgkmcnt(5)
    v_mfma_f32_32x32x16_bf16 v[64:79], v[92:95], a[96:99], v[64:79]
    ds_read_b128 v[80:83], v1 offset:26624
    ds_read_b128 v[84:87], v1 offset:59392
    ds_read_b128 v[88:91], v11 offset:26624
    ds_read_b128 v[92:95], v11 offset:59392
    s_waitcnt lgkmcnt(7)
    v_mfma_f32_32x32x16_bf16 v[16:31], v[96:99], a[100:103], v[16:31]
    s_waitcnt lgkmcnt(6)
    v_mfma_f32_32x32x16_bf16 v[32:47], v[100:103], a[100:103], v[32:47]
    s_waitcnt lgkmcnt(5)
    v_mfma_f32_32x32x16_bf16 v[48:63], v[104:107], a[100:103], v[48:63]
    s_waitcnt lgkmcnt(4)
    v_mfma_f32_32x32x16_bf16 v[64:79], v[108:111], a[100:103], v[64:79]
    ds_read_b128 v[96:99], v1 offset:27648
    ds_read_b128 v[100:103], v1 offset:60416
    ds_read_b128 v[104:107], v11 offset:27648
    ds_read_b128 v[108:111], v11 offset:60416
    s_waitcnt lgkmcnt(7)
    v_mfma_f32_32x32x16_bf16 v[16:31], v[80:83], a[104:107], v[16:31]
    s_waitcnt lgkmcnt(6)
    v_mfma_f32_32x32x16_bf16 v[32:47], v[84:87], a[104:107], v[32:47]
    s_waitcnt lgkmcnt(5)
    v_mfma_f32_32x32x16_bf16 v[48:63], v[88:91], a[104:107], v[48:63]
    s_waitcnt lgkmcnt(4)
    v_mfma_f32_32x32x16_bf16 v[64:79], v[92:95], a[104:107], v[64:79]
    s_waitcnt vmcnt(4)
    s_waitcnt lgkmcnt(12)
    s_barrier
    ds_read_b128 v[80:83], v1 offset:28672
    ds_read_b128 v[84:87], v1 offset:61440
    ds_read_b128 v[88:91], v11 offset:28672
    ds_read_b128 v[92:95], v11 offset:61440
    s_waitcnt lgkmcnt(7)
    v_mfma_f32_32x32x16_bf16 v[16:31], v[96:99], a[108:111], v[16:31]
    s_waitcnt lgkmcnt(6)
    v_mfma_f32_32x32x16_bf16 v[32:47], v[100:103], a[108:111], v[32:47]
    s_waitcnt lgkmcnt(5)
    v_mfma_f32_32x32x16_bf16 v[48:63], v[104:107], a[108:111], v[48:63]
    s_waitcnt lgkmcnt(4)
    v_mfma_f32_32x32x16_bf16 v[64:79], v[108:111], a[108:111], v[64:79]
    ds_read_b128 v[96:99], v1 offset:29696
    ds_read_b128 v[100:103], v1 offset:62464
    ds_read_b128 v[104:107], v11 offset:29696
    ds_read_b128 v[108:111], v11 offset:62464
    s_waitcnt vmcnt(0)
    s_waitcnt lgkmcnt(7)
    v_mfma_f32_32x32x16_bf16 v[16:31], v[80:83], a[112:115], v[16:31]
    s_waitcnt lgkmcnt(6)
    v_mfma_f32_32x32x16_bf16 v[32:47], v[84:87], a[112:115], v[32:47]
    s_waitcnt lgkmcnt(5)
    v_mfma_f32_32x32x16_bf16 v[48:63], v[88:91], a[112:115], v[48:63]
    s_waitcnt lgkmcnt(4)
    v_mfma_f32_32x32x16_bf16 v[64:79], v[92:95], a[112:115], v[64:79]
    ds_read_b128 v[80:83], v1 offset:30720
    ds_read_b128 v[84:87], v1 offset:63488
    ds_read_b128 v[88:91], v11 offset:30720
    ds_read_b128 v[92:95], v11 offset:63488
    s_waitcnt lgkmcnt(7)
    v_mfma_f32_32x32x16_bf16 v[16:31], v[96:99], a[116:119], v[16:31]
    s_waitcnt lgkmcnt(6)
    v_mfma_f32_32x32x16_bf16 v[32:47], v[100:103], a[116:119], v[32:47]
    s_waitcnt lgkmcnt(5)
    v_mfma_f32_32x32x16_bf16 v[48:63], v[104:107], a[116:119], v[48:63]
    s_waitcnt lgkmcnt(4)
    v_mfma_f32_32x32x16_bf16 v[64:79], v[108:111], a[116:119], v[64:79]
    ds_read_b128 v[96:99], v1 offset:31744
    ds_read_b128 v[100:103], v1 offset:64512
    ds_read_b128 v[104:107], v11 offset:31744
    ds_read_b128 v[108:111], v11 offset:64512
    s_waitcnt lgkmcnt(7)
    v_mfma_f32_32x32x16_bf16 v[16:31], v[80:83], a[120:123], v[16:31]
    s_waitcnt lgkmcnt(6)
    v_mfma_f32_32x32x16_bf16 v[32:47], v[84:87], a[120:123], v[32:47]
    s_waitcnt lgkmcnt(5)
    v_mfma_f32_32x32x16_bf16 v[48:63], v[88:91], a[120:123], v[48:63]
    s_waitcnt lgkmcnt(4)
    v_mfma_f32_32x32x16_bf16 v[64:79], v[92:95], a[120:123], v[64:79]
    s_waitcnt lgkmcnt(3)
    v_mfma_f32_32x32x16_bf16 v[16:31], v[96:99], a[124:127], v[16:31]
    s_waitcnt lgkmcnt(2)
    v_mfma_f32_32x32x16_bf16 v[32:47], v[100:103], a[124:127], v[32:47]
    s_waitcnt lgkmcnt(1)
    v_mfma_f32_32x32x16_bf16 v[48:63], v[104:107], a[124:127], v[48:63]
    s_waitcnt lgkmcnt(0)
    v_mfma_f32_32x32x16_bf16 v[64:79], v[108:111], a[124:127], v[64:79]
    s_nop 15
    s_nop 3
    ds_read_b128 v[184:187], v7 offset:0
    ds_read_b128 v[188:191], v7 offset:16
    ds_read_b128 v[192:195], v7 offset:64
    ds_read_b128 v[196:199], v7 offset:80
    ds_read_b128 v[200:203], v7 offset:128
    ds_read_b128 v[204:207], v7 offset:144
    ds_read_b128 v[208:211], v7 offset:192
    ds_read_b128 v[212:215], v7 offset:208
    s_waitcnt lgkmcnt(0)
    v_mul_f32 v16, v16, v185
    v_fma_f32 v16, -v184, v128, v16
    v_mul_f32 v17, v17, v187
    v_fma_f32 v17, -v186, v128, v17
    v_mul_f32 v18, v18, v189
    v_fma_f32 v18, -v188, v128, v18
    v_mul_f32 v19, v19, v191
    v_fma_f32 v19, -v190, v128, v19
    v_mul_f32 v20, v20, v193
    v_fma_f32 v20, -v192, v128, v20
    v_mul_f32 v21, v21, v195
    v_fma_f32 v21, -v194, v128, v21
    v_mul_f32 v22, v22, v197
    v_fma_f32 v22, -v196, v128, v22
    v_mul_f32 v23, v23, v199
    v_fma_f32 v23, -v198, v128, v23
    v_mul_f32 v24, v24, v201
    v_fma_f32 v24, -v200, v128, v24
    v_mul_f32 v25, v25, v203
    v_fma_f32 v25, -v202, v128, v25
    v_mul_f32 v26, v26, v205
    v_fma_f32 v26, -v204, v128, v26
    v_mul_f32 v27, v27, v207
    v_fma_f32 v27, -v206, v128, v27
    v_mul_f32 v28, v28, v209
    v_fma_f32 v28, -v208, v128, v28
    v_mul_f32 v29, v29, v211
    v_fma_f32 v29, -v210, v128, v29
    v_mul_f32 v30, v30, v213
    v_fma_f32 v30, -v212, v128, v30
    v_mul_f32 v31, v31, v215
    v_fma_f32 v31, -v214, v128, v31
    v_cvt_pk_bf16_f32 v16, v16, v17
    v_cvt_pk_bf16_f32 v17, v18, v19
    v_cvt_pk_bf16_f32 v18, v20, v21
    v_cvt_pk_bf16_f32 v19, v22, v23
    v_cvt_pk_bf16_f32 v20, v24, v25
    v_cvt_pk_bf16_f32 v21, v26, v27
    v_cvt_pk_bf16_f32 v22, v28, v29
    v_cvt_pk_bf16_f32 v23, v30, v31
    buffer_store_dwordx4 v[16:19], v8, s[4:7], s30 offen offset:0
    buffer_store_dwordx4 v[20:23], v8, s[4:7], s30 offen offset:512
    ds_read_b128 v[184:187], v7 offset:256
    ds_read_b128 v[188:191], v7 offset:272
    ds_read_b128 v[192:195], v7 offset:320
    ds_read_b128 v[196:199], v7 offset:336
    ds_read_b128 v[200:203], v7 offset:384
    ds_read_b128 v[204:207], v7 offset:400
    ds_read_b128 v[208:211], v7 offset:448
    ds_read_b128 v[212:215], v7 offset:464
    s_waitcnt lgkmcnt(0)
    v_mul_f32 v32, v32, v185
    v_fma_f32 v32, -v184, v128, v32
    v_mul_f32 v33, v33, v187
    v_fma_f32 v33, -v186, v128, v33
    v_mul_f32 v34, v34, v189
    v_fma_f32 v34, -v188, v128, v34
    v_mul_f32 v35, v35, v191
    v_fma_f32 v35, -v190, v128, v35
    v_mul_f32 v36, v36, v193
    v_fma_f32 v36, -v192, v128, v36
    v_mul_f32 v37, v37, v195
    v_fma_f32 v37, -v194, v128, v37
    v_mul_f32 v38, v38, v197
    v_fma_f32 v38, -v196, v128, v38
    v_mul_f32 v39, v39, v199
    v_fma_f32 v39, -v198, v128, v39
    v_mul_f32 v40, v40, v201
    v_fma_f32 v40, -v200, v128, v40
    v_mul_f32 v41, v41, v203
    v_fma_f32 v41, -v202, v128, v41
    v_mul_f32 v42, v42, v205
    v_fma_f32 v42, -v204, v128, v42
    v_mul_f32 v43, v43, v207
    v_fma_f32 v43, -v206, v128, v43
    v_mul_f32 v44, v44, v209
    v_fma_f32 v44, -v208, v128, v44
    v_mul_f32 v45, v45, v211
    v_fma_f32 v45, -v210, v128, v45
    v_mul_f32 v46, v46, v213
    v_fma_f32 v46, -v212, v128, v46
    v_mul_f32 v47, v47, v215
    v_fma_f32 v47, -v214, v128, v47
    v_cvt_pk_bf16_f32 v32, v32, v33
    v_cvt_pk_bf16_f32 v33, v34, v35
    v_cvt_pk_bf16_f32 v34, v36, v37
    v_cvt_pk_bf16_f32 v35, v38, v39
    v_cvt_pk_bf16_f32 v36, v40, v41
    v_cvt_pk_bf16_f32 v37, v42, v43
    v_cvt_pk_bf16_f32 v38, v44, v45
    v_cvt_pk_bf16_f32 v39, v46, v47
    buffer_store_dwordx4 v[32:35], v8, s[4:7], s30 offen offset:1024
    buffer_store_dwordx4 v[36:39], v8, s[4:7], s30 offen offset:1536
    ds_read_b128 v[184:187], v7 offset:512
    ds_read_b128 v[188:191], v7 offset:528
    ds_read_b128 v[192:195], v7 offset:576
    ds_read_b128 v[196:199], v7 offset:592
    ds_read_b128 v[200:203], v7 offset:640
    ds_read_b128 v[204:207], v7 offset:656
    ds_read_b128 v[208:211], v7 offset:704
    ds_read_b128 v[212:215], v7 offset:720
    s_waitcnt lgkmcnt(0)
    v_mul_f32 v48, v48, v185
    v_fma_f32 v48, -v184, v128, v48
    v_mul_f32 v49, v49, v187
    v_fma_f32 v49, -v186, v128, v49
    v_mul_f32 v50, v50, v189
    v_fma_f32 v50, -v188, v128, v50
    v_mul_f32 v51, v51, v191
    v_fma_f32 v51, -v190, v128, v51
    v_mul_f32 v52, v52, v193
    v_fma_f32 v52, -v192, v128, v52
    v_mul_f32 v53, v53, v195
    v_fma_f32 v53, -v194, v128, v53
    v_mul_f32 v54, v54, v197
    v_fma_f32 v54, -v196, v128, v54
    v_mul_f32 v55, v55, v199
    v_fma_f32 v55, -v198, v128, v55
    v_mul_f32 v56, v56, v201
    v_fma_f32 v56, -v200, v128, v56
    v_mul_f32 v57, v57, v203
    v_fma_f32 v57, -v202, v128, v57
    v_mul_f32 v58, v58, v205
    v_fma_f32 v58, -v204, v128, v58
    v_mul_f32 v59, v59, v207
    v_fma_f32 v59, -v206, v128, v59
    v_mul_f32 v60, v60, v209
    v_fma_f32 v60, -v208, v128, v60
    v_mul_f32 v61, v61, v211
    v_fma_f32 v61, -v210, v128, v61
    v_mul_f32 v62, v62, v213
    v_fma_f32 v62, -v212, v128, v62
    v_mul_f32 v63, v63, v215
    v_fma_f32 v63, -v214, v128, v63
    v_cvt_pk_bf16_f32 v48, v48, v49
    v_cvt_pk_bf16_f32 v49, v50, v51
    v_cvt_pk_bf16_f32 v50, v52, v53
    v_cvt_pk_bf16_f32 v51, v54, v55
    v_cvt_pk_bf16_f32 v52, v56, v57
    v_cvt_pk_bf16_f32 v53, v58, v59
    v_cvt_pk_bf16_f32 v54, v60, v61
    v_cvt_pk_bf16_f32 v55, v62, v63
    buffer_store_dwordx4 v[48:51], v8, s[4:7], s30 offen offset:2048
    buffer_store_dwordx4 v[52:55], v8, s[4:7], s30 offen offset:2560
    ds_read_b128 v[184:187], v7 offset:768
    ds_read_b128 v[188:191], v7 offset:784
    ds_read_b128 v[192:195], v7 offset:832
    ds_read_b128 v[196:199], v7 offset:848
    ds_read_b128 v[200:203], v7 offset:896
    ds_read_b128 v[204:207], v7 offset:912
    ds_read_b128 v[208:211], v7 offset:960
    ds_read_b128 v[212:215], v7 offset:976
    s_waitcnt lgkmcnt(0)
    v_mul_f32 v64, v64, v185
    v_fma_f32 v64, -v184, v128, v64
    v_mul_f32 v65, v65, v187
    v_fma_f32 v65, -v186, v128, v65
    v_mul_f32 v66, v66, v189
    v_fma_f32 v66, -v188, v128, v66
    v_mul_f32 v67, v67, v191
    v_fma_f32 v67, -v190, v128, v67
    v_mul_f32 v68, v68, v193
    v_fma_f32 v68, -v192, v128, v68
    v_mul_f32 v69, v69, v195
    v_fma_f32 v69, -v194, v128, v69
    v_mul_f32 v70, v70, v197
    v_fma_f32 v70, -v196, v128, v70
    v_mul_f32 v71, v71, v199
    v_fma_f32 v71, -v198, v128, v71
    v_mul_f32 v72, v72, v201
    v_fma_f32 v72, -v200, v128, v72
    v_mul_f32 v73, v73, v203
    v_fma_f32 v73, -v202, v128, v73
    v_mul_f32 v74, v74, v205
    v_fma_f32 v74, -v204, v128, v74
    v_mul_f32 v75, v75, v207
    v_fma_f32 v75, -v206, v128, v75
    v_mul_f32 v76, v76, v209
    v_fma_f32 v76, -v208, v128, v76
    v_mul_f32 v77, v77, v211
    v_fma_f32 v77, -v210, v128, v77
    v_mul_f32 v78, v78, v213
    v_fma_f32 v78, -v212, v128, v78
    v_mul_f32 v79, v79, v215
    v_fma_f32 v79, -v214, v128, v79
    v_cvt_pk_bf16_f32 v64, v64, v65
    v_cvt_pk_bf16_f32 v65, v66, v67
    v_cvt_pk_bf16_f32 v66, v68, v69
    v_cvt_pk_bf16_f32 v67, v70, v71
    v_cvt_pk_bf16_f32 v68, v72, v73
    v_cvt_pk_bf16_f32 v69, v74, v75
    v_cvt_pk_bf16_f32 v70, v76, v77
    v_cvt_pk_bf16_f32 v71, v78, v79
    buffer_store_dwordx4 v[64:67], v8, s[4:7], s30 offen offset:3072
    buffer_store_dwordx4 v[68:71], v8, s[4:7], s30 offen offset:3584
L_qkv_kernel_fin:
L_qkv_kernel_end:
    s_endpgm
.globl attn_kernel
.p2align 8
.type attn_kernel,@function
attn_kernel:
    s_cmp_ge_u32 s2, 256
    s_cbranch_scc1 L_attn_kernel_end
    s_load_dwordx2 s[4:5], s[0:1], 72
    v_and_b32 v2, 63, v0
    v_lshrrev_b32 v3, 6, v0
    v_lshlrev_b32 v1, 4, v2
    v_readfirstlane_b32 s3, v3
    s_mov_b32 s6, 0x10000000
    s_mov_b32 s7, 0x00020000
    s_waitcnt lgkmcnt(0)
    v_and_b32 v4, 31, v2
    v_lshrrev_b32 v5, 5, v2
    s_and_b32 s8, s2, 7
    s_lshr_b32 s9, s2, 3
    s_lshl_b32 s8, s8, 2
    s_and_b32 s10, s9, 3
    s_add_u32 s8, s8, s10
    s_lshr_b32 s9, s9, 2
    s_and_b32 s24, s3, 7
    s_lshr_b32 s25, s3, 3
    s_cmp_lg_u32 s2, 0
    s_cbranch_scc1 L_attn_nz
    s_cmp_ge_u32 s3, 6
    s_cbranch_scc1 L_attn_nz
    v_mov_b32 v8, 0
    v_mov_b32 v9, 0
    v_mov_b32 v10, 0
    v_mov_b32 v11, 0
    s_lshl_b32 s26, s3, 10
    s_add_u32 s26, s26, 28598272
    buffer_store_dwordx4 v[8:11], v1, s[4:7], s26 offen
    s_nop 1
L_attn_nz:
    s_lshl_b32 s9, s9, 3
    s_add_u32 s9, s9, s24
    s_lshl_b32 s10, s8, 6
    s_add_u32 s11, s10, s9
    s_lshl_b32 s11, s11, 10
    s_add_u32 s11, s11, 8151040
    buffer_load_dwordx4 v[8:11], v1, s[4:7], s11 offen
    s_lshl_b32 s10, s10, 10
    s_add_u32 s12, s10, 10248192
    s_add_u32 s13, s10, 12345344
    s_lshl_b32 s14, s25, 5
    s_add_u32 s14, s14, s24
    s_lshl_b32 s14, s14, 10
    s_add_u32 s15, s12, s14
    s_add_u32 s16, s13, s14
    s_mov_b32 m0, s14
    s_nop 0
    buffer_load_dwordx4 v1, s[4:7], s15 offen lds
    s_add_u32 m0, s14, 0x10000
    s_nop 0
    buffer_load_dwordx4 v1, s[4:7], s16 offen lds
    v_and_b32 v6, 27, v4
    v_cmp_eq_u32 vcc, 16, v6
    v_mov_b32 v7, 0x3f803f80
    s_nop 1
    v_cndmask_b32 v6, 0, v7, vcc
    v_mov_b32 v76, v6
    v_mov_b32 v77, v6
    v_mov_b32 v78, v6
    v_mov_b32 v79, v6
    v_mov_b32 v80, v6
    v_mov_b32 v81, v6
    v_mov_b32 v82, v6
    v_mov_b32 v83, v6
    v_mov_b32 v84, v6
    v_mov_b32 v85, v6
    v_mov_b32 v86, v6
    v_mov_b32 v87, v6
    v_mov_b32 v88, v6
    v_mov_b32 v89, v6
    v_mov_b32 v90, v6
    v_mov_b32 v91, v6
    s_mov_b32 s20, 0xffff
    s_mov_b32 s21, 0xffff
    s_mov_b32 s22, 0
    s_lshl_b32 s26, s25, 15
    s_waitcnt vmcnt(0)
    s_barrier
    s_mul_i32 s14, s24, 3
    s_add_u32 s14, s14, 8
    s_lshl_b32 s17, s25, 5
    s_add_u32 s14, s14, s17
    s_lshl_b32 s14, s14, 10
    s_add_u32 s15, s12, s14
    s_add_u32 s16, s13, s14
    s_mov_b32 m0, s14
    s_nop 0
    buffer_load_dwordx4 v1, s[4:7], s15 offen offset:0 lds
    buffer_load_dwordx4 v1, s[4:7], s15 offen offset:1024 lds
    buffer_load_dwordx4 v1, s[4:7], s15 offen offset:2048 lds
    s_add_u32 m0, s14, 0x10000
    s_nop 0
    buffer_load_dwordx4 v1, s[4:7], s16 offen offset:0 lds
    buffer_load_dwordx4 v1, s[4:7], s16 offen offset:1024 lds
    buffer_load_dwordx4 v1, s[4:7], s16 offen offset:2048 lds
    ds_read_b128 v[68:71], v1
    s_waitcnt lgkmcnt(0)
    v_mfma_f32_32x32x16_bf16 v[28:43], v[68:71], v[8:11], 0
    s_nop 15
    s_nop 3
    v_max3_f32 v6, v28, v29, v30
    v_max_f32 v6, v6, v31
    v_max3_f32 v6, v6, v32, v33
    v_max3_f32 v6, v6, v34, v35
    v_max3_f32 v6, v6, v36, v37
    v_max3_f32 v6, v6, v38, v39
    v_max3_f32 v6, v6, v40, v41
    v_max3_f32 v6, v6, v42, v43
L_attn_setneg:
    v_mov_b32 v7, v6
    s_nop 1
    v_permlane32_swap_b32 v6, v7
    s_nop 1
    v_max_f32 v6, v6, v7
    v_sub_f32 v12, 0, v6
    v_mov_b32 v13, v12
    v_mov_b32 v14, v12
    v_mov_b32 v15, v12
    v_mov_b32 v16, v12
    v_mov_b32 v17, v12
    v_mov_b32 v18, v12
    v_mov_b32 v19, v12
    v_mov_b32 v20, v12
    v_mov_b32 v21, v12
    v_mov_b32 v22, v12
    v_mov_b32 v23, v12
    v_mov_b32 v24, v12
    v_mov_b32 v25, v12
    v_mov_b32 v26, v12
    v_mov_b32 v27, v12
    v_add_u32 v2, s26, v1
    v_lshl_add_u32 v3, v5, 4, v4
    v_lshlrev_b32 v3, 4, v3
    v_add_u32 v3, 0x10000, v3
    v_add_u32 v3, s26, v3
    v_mov_b32 v92, 0
    v_mov_b32 v93, 0
    v_mov_b32 v94, 0
    v_mov_b32 v95, 0
    v_mov_b32 v96, 0
    v_mov_b32 v97, 0
    v_mov_b32 v98, 0
    v_mov_b32 v99, 0
    v_mov_b32 v100, 0
    v_mov_b32 v101, 0
    v_mov_b32 v102, 0
    v_mov_b32 v103, 0
    v_mov_b32 v104, 0
    v_mov_b32 v105, 0
    v_mov_b32 v106, 0
    v_mov_b32 v107, 0
    ds_read_b128 v[68:71], v2
    s_mov_b64 exec, s[20:21]
    ds_read_b128 v[76:79], v3 offset:0
    ds_read_b128 v[80:83], v3 offset:512
    s_mov_b64 exec, -1
    s_waitcnt lgkmcnt(0)
    v_mfma_f32_32x32x16_bf16 v[28:43], v[68:71], v[8:11], v[12:27]
    ds_read_b128 v[72:75], v2 offset:1024
    s_mov_b64 exec, s[20:21]
    ds_read_b128 v[84:87], v3 offset:1024
    ds_read_b128 v[88:91], v3 offset:1536
    s_mov_b64 exec, -1
    s_nop 7
    s_cmp_lg_u32 s22, 0
    s_cbranch_scc0 L_attn_phA
    s_mov_b32 s23, 32
    s_branch L_attn_loopB
L_attn_phA:
    s_setprio 3
    s_waitcnt lgkmcnt(2)
    v_mfma_f32_32x32x16_bf16 v[44:59], v[72:75], v[8:11], v[12:27]
    ds_read_b128 v[68:71], v2 offset:2048
    v_exp_f32 v28, v28
    v_exp_f32 v29, v29
    v_exp_f32 v30, v30
    v_exp_f32 v31, v31
    v_exp_f32 v32, v32
    v_exp_f32 v33, v33
    v_exp_f32 v34, v34
    v_exp_f32 v35, v35
    v_cvt_pk_bf16_f32 v60, v28, v29
    v_cvt_pk_bf16_f32 v61, v30, v31
    v_cvt_pk_bf16_f32 v62, v32, v33
    v_cvt_pk_bf16_f32 v63, v34, v35
    v_exp_f32 v36, v36
    v_exp_f32 v37, v37
    v_mfma_f32_32x32x16_bf16 v[92:107], v[76:79], v[60:63], v[92:107]
    v_exp_f32 v38, v38
    v_exp_f32 v39, v39
    v_exp_f32 v40, v40
    v_exp_f32 v41, v41
    v_exp_f32 v42, v42
    v_exp_f32 v43, v43
    v_cvt_pk_bf16_f32 v64, v36, v37
    v_cvt_pk_bf16_f32 v65, v38, v39
    v_cvt_pk_bf16_f32 v66, v40, v41
    v_cvt_pk_bf16_f32 v67, v42, v43
    s_nop 1
    v_mfma_f32_32x32x16_bf16 v[92:107], v[80:83], v[64:67], v[92:107]
    s_mov_b64 exec, s[20:21]
    ds_read_b128 v[76:79], v3 offset:2048
    ds_read_b128 v[80:83], v3 offset:2560
    s_mov_b64 exec, -1
    s_waitcnt lgkmcnt(2)
    v_mfma_f32_32x32x16_bf16 v[28:43], v[68:71], v[8:11], v[12:27]
    ds_read_b128 v[72:75], v2 offset:3072
    v_exp_f32 v44, v44
    v_exp_f32 v45, v45
    v_exp_f32 v46, v46
    v_exp_f32 v47, v47
    v_exp_f32 v48, v48
    v_exp_f32 v49, v49
    v_exp_f32 v50, v50
    v_exp_f32 v51, v51
    v_cvt_pk_bf16_f32 v60, v44, v45
    v_cvt_pk_bf16_f32 v61, v46, v47
    v_cvt_pk_bf16_f32 v62, v48, v49
    v_cvt_pk_bf16_f32 v63, v50, v51
    v_exp_f32 v52, v52
    v_exp_f32 v53, v53
    v_mfma_f32_32x32x16_bf16 v[92:107], v[84:87], v[60:63], v[92:107]
    v_exp_f32 v54, v54
    v_exp_f32 v55, v55
    v_exp_f32 v56, v56
    v_exp_f32 v57, v57
    v_exp_f32 v58, v58
    v_exp_f32 v59, v59
    v_cvt_pk_bf16_f32 v64, v52, v53
    v_cvt_pk_bf16_f32 v65, v54, v55
    v_cvt_pk_bf16_f32 v66, v56, v57
    v_cvt_pk_bf16_f32 v67, v58, v59
    v_add_u32 v2, 2048, v2
    s_sub_u32 s23, s23, 1
    v_mfma_f32_32x32x16_bf16 v[92:107], v[88:91], v[64:67], v[92:107]
    s_mov_b64 exec, s[20:21]
    ds_read_b128 v[84:87], v3 offset:3072
    ds_read_b128 v[88:91], v3 offset:3584
    s_mov_b64 exec, -1
    v_add_u32 v3, 2048, v3
    s_cmp_lg_u32 s23, 0
    s_setprio 2
    s_waitcnt lgkmcnt(2)
    v_mfma_f32_32x32x16_bf16 v[44:59], v[72:75], v[8:11], v[12:27]
    ds_read_b128 v[68:71], v2 offset:2048
    v_exp_f32 v28, v28
    v_exp_f32 v29, v29
    v_exp_f32 v30, v30
    v_exp_f32 v31, v31
    v_exp_f32 v32, v32
    v_exp_f32 v33, v33
    v_exp_f32 v34, v34
    v_exp_f32 v35, v35
    v_cvt_pk_bf16_f32 v60, v28, v29
    v_cvt_pk_bf16_f32 v61, v30, v31
    v_cvt_pk_bf16_f32 v62, v32, v33
    v_cvt_pk_bf16_f32 v63, v34, v35
    v_exp_f32 v36, v36
    v_exp_f32 v37, v37
    v_mfma_f32_32x32x16_bf16 v[92:107], v[76:79], v[60:63], v[92:107]
    v_exp_f32 v38, v38
    v_exp_f32 v39, v39
    v_exp_f32 v40, v40
    v_exp_f32 v41, v41
    v_exp_f32 v42, v42
    v_exp_f32 v43, v43
    v_cvt_pk_bf16_f32 v64, v36, v37
    v_cvt_pk_bf16_f32 v65, v38, v39
    v_cvt_pk_bf16_f32 v66, v40, v41
    v_cvt_pk_bf16_f32 v67, v42, v43
    s_nop 1
    v_mfma_f32_32x32x16_bf16 v[92:107], v[80:83], v[64:67], v[92:107]
    s_mov_b64 exec, s[20:21]
    ds_read_b128 v[76:79], v3 offset:2048
    ds_read_b128 v[80:83], v3 offset:2560
    s_mov_b64 exec, -1
    s_waitcnt lgkmcnt(2)
    v_mfma_f32_32x32x16_bf16 v[28:43], v[68:71], v[8:11], v[12:27]
    ds_read_b128 v[72:75], v2 offset:3072
    v_exp_f32 v44, v44
    v_exp_f32 v45, v45
    v_exp_f32 v46, v46
    v_exp_f32 v47, v47
    v_exp_f32 v48, v48
    v_exp_f32 v49, v49
    v_exp_f32 v50, v50
    v_exp_f32 v51, v51
    v_cvt_pk_bf16_f32 v60, v44, v45
    v_cvt_pk_bf16_f32 v61, v46, v47
    v_cvt_pk_bf16_f32 v62, v48, v49
    v_cvt_pk_bf16_f32 v63, v50, v51
    v_exp_f32 v52, v52
    v_exp_f32 v53, v53
    v_mfma_f32_32x32x16_bf16 v[92:107], v[84:87], v[60:63], v[92:107]
    v_exp_f32 v54, v54
    v_exp_f32 v55, v55
    v_exp_f32 v56, v56
    v_exp_f32 v57, v57
    v_exp_f32 v58, v58
    v_exp_f32 v59, v59
    v_cvt_pk_bf16_f32 v64, v52, v53
    v_cvt_pk_bf16_f32 v65, v54, v55
    v_cvt_pk_bf16_f32 v66, v56, v57
    v_cvt_pk_bf16_f32 v67, v58, v59
    v_add_u32 v2, 2048, v2
    s_sub_u32 s23, s23, 1
    v_mfma_f32_32x32x16_bf16 v[92:107], v[88:91], v[64:67], v[92:107]
    s_mov_b64 exec, s[20:21]
    ds_read_b128 v[84:87], v3 offset:3072
    ds_read_b128 v[88:91], v3 offset:3584
    s_mov_b64 exec, -1
    v_add_u32 v3, 2048, v3
    s_cmp_lg_u32 s23, 0
    s_setprio 1
    s_waitcnt lgkmcnt(2)
    v_mfma_f32_32x32x16_bf16 v[44:59], v[72:75], v[8:11], v[12:27]
    ds_read_b128 v[68:71], v2 offset:2048
    v_exp_f32 v28, v28
    v_exp_f32 v29, v29
    v_exp_f32 v30, v30
    v_exp_f32 v31, v31
    v_exp_f32 v32, v32
    v_exp_f32 v33, v33
    v_exp_f32 v34, v34
    v_exp_f32 v35, v35
    v_cvt_pk_bf16_f32 v60, v28, v29
    v_cvt_pk_bf16_f32 v61, v30, v31
    v_cvt_pk_bf16_f32 v62, v32, v33
    v_cvt_pk_bf16_f32 v63, v34, v35
    v_exp_f32 v36, v36
    v_exp_f32 v37, v37
    v_mfma_f32_32x32x16_bf16 v[92:107], v[76:79], v[60:63], v[92:107]
    v_exp_f32 v38, v38
    v_exp_f32 v39, v39
    v_exp_f32 v40, v40
    v_exp_f32 v41, v41
    v_exp_f32 v42, v42
    v_exp_f32 v43, v43
    v_cvt_pk_bf16_f32 v64, v36, v37
    v_cvt_pk_bf16_f32 v65, v38, v39
    v_cvt_pk_bf16_f32 v66, v40, v41
    v_cvt_pk_bf16_f32 v67, v42, v43
    s_nop 1
    v_mfma_f32_32x32x16_bf16 v[92:107], v[80:83], v[64:67], v[92:107]
    s_mov_b64 exec, s[20:21]
    ds_read_b128 v[76:79], v3 offset:2048
    ds_read_b128 v[80:83], v3 offset:2560
    s_mov_b64 exec, -1
    s_waitcnt lgkmcnt(2)
    v_mfma_f32_32x32x16_bf16 v[28:43], v[68:71], v[8:11], v[12:27]
    ds_read_b128 v[72:75], v2 offset:3072
    v_exp_f32 v44, v44
    v_exp_f32 v45, v45
    v_exp_f32 v46, v46
    v_exp_f32 v47, v47
    v_exp_f32 v48, v48
    v_exp_f32 v49, v49
    v_exp_f32 v50, v50
    v_exp_f32 v51, v51
    v_cvt_pk_bf16_f32 v60, v44, v45
    v_cvt_pk_bf16_f32 v61, v46, v47
    v_cvt_pk_bf16_f32 v62, v48, v49
    v_cvt_pk_bf16_f32 v63, v50, v51
    v_exp_f32 v52, v52
    v_exp_f32 v53, v53
    v_mfma_f32_32x32x16_bf16 v[92:107], v[84:87], v[60:63], v[92:107]
    v_exp_f32 v54, v54
    v_exp_f32 v55, v55
    v_exp_f32 v56, v56
    v_exp_f32 v57, v57
    v_exp_f32 v58, v58
    v_exp_f32 v59, v59
    v_cvt_pk_bf16_f32 v64, v52, v53
    v_cvt_pk_bf16_f32 v65, v54, v55
    v_cvt_pk_bf16_f32 v66, v56, v57
    v_cvt_pk_bf16_f32 v67, v58, v59
    v_add_u32 v2, 2048, v2
    s_sub_u32 s23, s23, 1
    v_mfma_f32_32x32x16_bf16 v[92:107], v[88:91], v[64:67], v[92:107]
    s_mov_b64 exec, s[20:21]
    ds_read_b128 v[84:87], v3 offset:3072
    ds_read_b128 v[88:91], v3 offset:3584
    s_mov_b64 exec, -1
    v_add_u32 v3, 2048, v3
    s_cmp_lg_u32 s23, 0
    s_waitcnt vmcnt(0)
    s_barrier
    s_setprio 3
    s_mov_b32 s23, 3
L_attn_loopS0:
    s_waitcnt lgkmcnt(2)
    v_mfma_f32_32x32x16_bf16 v[44:59], v[72:75], v[8:11], v[12:27]
    ds_read_b128 v[68:71], v2 offset:2048
    v_exp_f32 v28, v28
    v_exp_f32 v29, v29
    v_exp_f32 v30, v30
    v_exp_f32 v31, v31
    v_exp_f32 v32, v32
    v_exp_f32 v33, v33
    v_exp_f32 v34, v34
    v_exp_f32 v35, v35
    v_cvt_pk_bf16_f32 v60, v28, v29
    v_cvt_pk_bf16_f32 v61, v30, v31
    v_cvt_pk_bf16_f32 v62, v32, v33
    v_cvt_pk_bf16_f32 v63, v34, v35
    v_exp_f32 v36, v36
    v_exp_f32 v37, v37
    v_mfma_f32_32x32x16_bf16 v[92:107], v[76:79], v[60:63], v[92:107]
    v_exp_f32 v38, v38
    v_exp_f32 v39, v39
    v_exp_f32 v40, v40
    v_exp_f32 v41, v41
    v_exp_f32 v42, v42
    v_exp_f32 v43, v43
    v_cvt_pk_bf16_f32 v64, v36, v37
    v_cvt_pk_bf16_f32 v65, v38, v39
    v_cvt_pk_bf16_f32 v66, v40, v41
    v_cvt_pk_bf16_f32 v67, v42, v43
    s_nop 1
    v_mfma_f32_32x32x16_bf16 v[92:107], v[80:83], v[64:67], v[92:107]
    s_mov_b64 exec, s[20:21]
    ds_read_b128 v[76:79], v3 offset:2048
    ds_read_b128 v[80:83], v3 offset:2560
    s_mov_b64 exec, -1
    s_waitcnt lgkmcnt(2)
    v_mfma_f32_32x32x16_bf16 v[28:43], v[68:71], v[8:11], v[12:27]
    ds_read_b128 v[72:75], v2 offset:3072
    v_exp_f32 v44, v44
    v_exp_f32 v45, v45
    v_exp_f32 v46, v46
    v_exp_f32 v47, v47
    v_exp_f32 v48, v48
    v_exp_f32 v49, v49
    v_exp_f32 v50, v50
    v_exp_f32 v51, v51
    v_cvt_pk_bf16_f32 v60, v44, v45
    v_cvt_pk_bf16_f32 v61, v46, v47
    v_cvt_pk_bf16_f32 v62, v48, v49
    v_cvt_pk_bf16_f32 v63, v50, v51
    v_exp_f32 v52, v52
    v_exp_f32 v53, v53
    v_mfma_f32_32x32x16_bf16 v[92:107], v[84:87], v[60:63], v[92:107]
    v_exp_f32 v54, v54
    v_exp_f32 v55, v55
    v_exp_f32 v56, v56
    v_exp_f32 v57, v57
    v_exp_f32 v58, v58
    v_exp_f32 v59, v59
    v_cvt_pk_bf16_f32 v64, v52, v53
    v_cvt_pk_bf16_f32 v65, v54, v55
    v_cvt_pk_bf16_f32 v66, v56, v57
    v_cvt_pk_bf16_f32 v67, v58, v59
    v_add_u32 v2, 2048, v2
    s_sub_u32 s23, s23, 1
    v_mfma_f32_32x32x16_bf16 v[92:107], v[88:91], v[64:67], v[92:107]
    s_mov_b64 exec, s[20:21]
    ds_read_b128 v[84:87], v3 offset:3072
    ds_read_b128 v[88:91], v3 offset:3584
    s_mov_b64 exec, -1
    v_add_u32 v3, 2048, v3
    s_cmp_lg_u32 s23, 0
    s_cbranch_scc1 L_attn_loopS0
    s_setprio 2
    s_mov_b32 s23, 4
L_attn_loopS1:
    s_waitcnt lgkmcnt(2)
    v_mfma_f32_32x32x16_bf16 v[44:59], v[72:75], v[8:11], v[12:27]
    ds_read_b128 v[68:71], v2 offset:2048
    v_exp_f32 v28, v28
    v_exp_f32 v29, v29
    v_exp_f32 v30, v30
    v_exp_f32 v31, v31
    v_exp_f32 v32, v32
    v_exp_f32 v33, v33
    v_exp_f32 v34, v34
    v_exp_f32 v35, v35
    v_cvt_pk_bf16_f32 v60, v28, v29
    v_cvt_pk_bf16_f32 v61, v30, v31
    v_cvt_pk_bf16_f32 v62, v32, v33
    v_cvt_pk_bf16_f32 v63, v34, v35
    v_exp_f32 v36, v36
    v_exp_f32 v37, v37
    v_mfma_f32_32x32x16_bf16 v[92:107], v[76:79], v[60:63], v[92:107]
    v_exp_f32 v38, v38
    v_exp_f32 v39, v39
    v_exp_f32 v40, v40
    v_exp_f32 v41, v41
    v_exp_f32 v42, v42
    v_exp_f32 v43, v43
    v_cvt_pk_bf16_f32 v64, v36, v37
    v_cvt_pk_bf16_f32 v65, v38, v39
    v_cvt_pk_bf16_f32 v66, v40, v41
    v_cvt_pk_bf16_f32 v67, v42, v43
    s_nop 1
    v_mfma_f32_32x32x16_bf16 v[92:107], v[80:83], v[64:67], v[92:107]
    s_mov_b64 exec, s[20:21]
    ds_read_b128 v[76:79], v3 offset:2048
    ds_read_b128 v[80:83], v3 offset:2560
    s_mov_b64 exec, -1
    s_waitcnt lgkmcnt(2)
    v_mfma_f32_32x32x16_bf16 v[28:43], v[68:71], v[8:11], v[12:27]
    ds_read_b128 v[72:75], v2 offset:3072
    v_exp_f32 v44, v44
    v_exp_f32 v45, v45
    v_exp_f32 v46, v46
    v_exp_f32 v47, v47
    v_exp_f32 v48, v48
    v_exp_f32 v49, v49
    v_exp_f32 v50, v50
    v_exp_f32 v51, v51
    v_cvt_pk_bf16_f32 v60, v44, v45
    v_cvt_pk_bf16_f32 v61, v46, v47
    v_cvt_pk_bf16_f32 v62, v48, v49
    v_cvt_pk_bf16_f32 v63, v50, v51
    v_exp_f32 v52, v52
    v_exp_f32 v53, v53
    v_mfma_f32_32x32x16_bf16 v[92:107], v[84:87], v[60:63], v[92:107]
    v_exp_f32 v54, v54
    v_exp_f32 v55, v55
    v_exp_f32 v56, v56
    v_exp_f32 v57, v57
    v_exp_f32 v58, v58
    v_exp_f32 v59, v59
    v_cvt_pk_bf16_f32 v64, v52, v53
    v_cvt_pk_bf16_f32 v65, v54, v55
    v_cvt_pk_bf16_f32 v66, v56, v57
    v_cvt_pk_bf16_f32 v67, v58, v59
    v_add_u32 v2, 2048, v2
    s_sub_u32 s23, s23, 1
    v_mfma_f32_32x32x16_bf16 v[92:107], v[88:91], v[64:67], v[92:107]
    s_mov_b64 exec, s[20:21]
    ds_read_b128 v[84:87], v3 offset:3072
    ds_read_b128 v[88:91], v3 offset:3584
    s_mov_b64 exec, -1
    v_add_u32 v3, 2048, v3
    s_cmp_lg_u32 s23, 0
    s_cbranch_scc1 L_attn_loopS1
    s_setprio 1
    s_mov_b32 s23, 3
L_attn_loopS2:
    s_waitcnt lgkmcnt(2)
    v_mfma_f32_32x32x16_bf16 v[44:59], v[72:75], v[8:11], v[12:27]
    ds_read_b128 v[68:71], v2 offset:2048
    v_exp_f32 v28, v28
    v_exp_f32 v29, v29
    v_exp_f32 v30, v30
    v_exp_f32 v31, v31
    v_exp_f32 v32, v32
    v_exp_f32 v33, v33
    v_exp_f32 v34, v34
    v_exp_f32 v35, v35
    v_cvt_pk_bf16_f32 v60, v28, v29
    v_cvt_pk_bf16_f32 v61, v30, v31
    v_cvt_pk_bf16_f32 v62, v32, v33
    v_cvt_pk_bf16_f32 v63, v34, v35
    v_exp_f32 v36, v36
    v_exp_f32 v37, v37
    v_mfma_f32_32x32x16_bf16 v[92:107], v[76:79], v[60:63], v[92:107]
    v_exp_f32 v38, v38
    v_exp_f32 v39, v39
    v_exp_f32 v40, v40
    v_exp_f32 v41, v41
    v_exp_f32 v42, v42
    v_exp_f32 v43, v43
    v_cvt_pk_bf16_f32 v64, v36, v37
    v_cvt_pk_bf16_f32 v65, v38, v39
    v_cvt_pk_bf16_f32 v66, v40, v41
    v_cvt_pk_bf16_f32 v67, v42, v43
    s_nop 1
    v_mfma_f32_32x32x16_bf16 v[92:107], v[80:83], v[64:67], v[92:107]
    s_mov_b64 exec, s[20:21]
    ds_read_b128 v[76:79], v3 offset:2048
    ds_read_b128 v[80:83], v3 offset:2560
    s_mov_b64 exec, -1
    s_waitcnt lgkmcnt(2)
    v_mfma_f32_32x32x16_bf16 v[28:43], v[68:71], v[8:11], v[12:27]
    ds_read_b128 v[72:75], v2 offset:3072
    v_exp_f32 v44, v44
    v_exp_f32 v45, v45
    v_exp_f32 v46, v46
    v_exp_f32 v47, v47
    v_exp_f32 v48, v48
    v_exp_f32 v49, v49
    v_exp_f32 v50, v50
    v_exp_f32 v51, v51
    v_cvt_pk_bf16_f32 v60, v44, v45
    v_cvt_pk_bf16_f32 v61, v46, v47
    v_cvt_pk_bf16_f32 v62, v48, v49
    v_cvt_pk_bf16_f32 v63, v50, v51
    v_exp_f32 v52, v52
    v_exp_f32 v53, v53
    v_mfma_f32_32x32x16_bf16 v[92:107], v[84:87], v[60:63], v[92:107]
    v_exp_f32 v54, v54
    v_exp_f32 v55, v55
    v_exp_f32 v56, v56
    v_exp_f32 v57, v57
    v_exp_f32 v58, v58
    v_exp_f32 v59, v59
    v_cvt_pk_bf16_f32 v64, v52, v53
    v_cvt_pk_bf16_f32 v65, v54, v55
    v_cvt_pk_bf16_f32 v66, v56, v57
    v_cvt_pk_bf16_f32 v67, v58, v59
    v_add_u32 v2, 2048, v2
    s_sub_u32 s23, s23, 1
    v_mfma_f32_32x32x16_bf16 v[92:107], v[88:91], v[64:67], v[92:107]
    s_mov_b64 exec, s[20:21]
    ds_read_b128 v[84:87], v3 offset:3072
    ds_read_b128 v[88:91], v3 offset:3584
    s_mov_b64 exec, -1
    v_add_u32 v3, 2048, v3
    s_cmp_lg_u32 s23, 0
    s_cbranch_scc1 L_attn_loopS2
    s_setprio 0
    s_mov_b32 s23, 3
L_attn_loopB:
    s_waitcnt lgkmcnt(2)
    v_mfma_f32_32x32x16_bf16 v[44:59], v[72:75], v[8:11], v[12:27]
    ds_read_b128 v[68:71], v2 offset:2048
    v_exp_f32 v28, v28
    v_exp_f32 v29, v29
    v_exp_f32 v30, v30
    v_exp_f32 v31, v31
    v_exp_f32 v32, v32
    v_exp_f32 v33, v33
    v_exp_f32 v34, v34
    v_exp_f32 v35, v35
    v_cvt_pk_bf16_f32 v60, v28, v29
    v_cvt_pk_bf16_f32 v61, v30, v31
    v_cvt_pk_bf16_f32 v62, v32, v33
    v_cvt_pk_bf16_f32 v63, v34, v35
    v_exp_f32 v36, v36
    v_exp_f32 v37, v37
    v_mfma_f32_32x32x16_bf16 v[92:107], v[76:79], v[60:63], v[92:107]
    v_exp_f32 v38, v38
    v_exp_f32 v39, v39
    v_exp_f32 v40, v40
    v_exp_f32 v41, v41
    v_exp_f32 v42, v42
    v_exp_f32 v43, v43
    v_cvt_pk_bf16_f32 v64, v36, v37
    v_cvt_pk_bf16_f32 v65, v38, v39
    v_cvt_pk_bf16_f32 v66, v40, v41
    v_cvt_pk_bf16_f32 v67, v42, v43
    s_nop 1
    v_mfma_f32_32x32x16_bf16 v[92:107], v[80:83], v[64:67], v[92:107]
    s_mov_b64 exec, s[20:21]
    ds_read_b128 v[76:79], v3 offset:2048
    ds_read_b128 v[80:83], v3 offset:2560
    s_mov_b64 exec, -1
    s_waitcnt lgkmcnt(2)
    v_mfma_f32_32x32x16_bf16 v[28:43], v[68:71], v[8:11], v[12:27]
    ds_read_b128 v[72:75], v2 offset:3072
    v_exp_f32 v44, v44
    v_exp_f32 v45, v45
    v_exp_f32 v46, v46
    v_exp_f32 v47, v47
    v_exp_f32 v48, v48
    v_exp_f32 v49, v49
    v_exp_f32 v50, v50
    v_exp_f32 v51, v51
    v_cvt_pk_bf16_f32 v60, v44, v45
    v_cvt_pk_bf16_f32 v61, v46, v47
    v_cvt_pk_bf16_f32 v62, v48, v49
    v_cvt_pk_bf16_f32 v63, v50, v51
    v_exp_f32 v52, v52
    v_exp_f32 v53, v53
    v_mfma_f32_32x32x16_bf16 v[92:107], v[84:87], v[60:63], v[92:107]
    v_exp_f32 v54, v54
    v_exp_f32 v55, v55
    v_exp_f32 v56, v56
    v_exp_f32 v57, v57
    v_exp_f32 v58, v58
    v_exp_f32 v59, v59
    v_cvt_pk_bf16_f32 v64, v52, v53
    v_cvt_pk_bf16_f32 v65, v54, v55
    v_cvt_pk_bf16_f32 v66, v56, v57
    v_cvt_pk_bf16_f32 v67, v58, v59
    v_add_u32 v2, 2048, v2
    s_sub_u32 s23, s23, 1
    v_mfma_f32_32x32x16_bf16 v[92:107], v[88:91], v[64:67], v[92:107]
    s_mov_b64 exec, s[20:21]
    ds_read_b128 v[84:87], v3 offset:3072
    ds_read_b128 v[88:91], v3 offset:3584
    s_mov_b64 exec, -1
    v_add_u32 v3, 2048, v3
    s_cmp_lg_u32 s23, 0
    s_cbranch_scc1 L_attn_loopB
    s_waitcnt lgkmcnt(0)
    s_nop 15
    s_nop 3
    s_cmp_lg_u32 s22, 0
    s_cbranch_scc1 L_attn_fin
    s_mul_i32 s27, s24, 2304
    v_lshrrev_b32 v6, 2, v1
    v_add_u32 v6, s27, v6
    v_add_u32 v6, 135168, v6
    s_cmp_eq_u32 s25, 0
    s_cbranch_scc1 L_attn_lo
    ds_write_b32 v6, v92 offset:0
    ds_write_b32 v6, v93 offset:256
    ds_write_b32 v6, v94 offset:512
    ds_write_b32 v6, v95 offset:768
    ds_write_b32 v6, v96 offset:1024
    ds_write_b32 v6, v97 offset:1280
    ds_write_b32 v6, v98 offset:1536
    ds_write_b32 v6, v99 offset:1792
    ds_write_b32 v6, v100 offset:2048
    s_waitcnt lgkmcnt(0)
    s_barrier
    s_branch L_attn_kernel_end
L_attn_lo:
    s_barrier
    ds_read_b32 v28, v6 offset:0
    ds_read_b32 v29, v6 offset:256
    ds_read_b32 v30, v6 offset:512
    ds_read_b32 v31, v6 offset:768
    ds_read_b32 v32, v6 offset:1024
    ds_read_b32 v33, v6 offset:1280
    ds_read_b32 v34, v6 offset:1536
    ds_read_b32 v35, v6 offset:1792
    ds_read_b32 v36, v6 offset:2048
    s_waitcnt lgkmcnt(0)
    v_add_f32 v92, v92, v28
    v_add_f32 v93, v93, v29
    v_add_f32 v94, v94, v30
    v_add_f32 v95, v95, v31
    v_add_f32 v96, v96, v32
    v_add_f32 v97, v97, v33
    v_add_f32 v98, v98, v34
    v_add_f32 v99, v99, v35
    v_add_f32 v100, v100, v36
    v_cmp_gt_f32 vcc, 0x5f800000, v100
    s_nop 3
    s_cmp_eq_u64 vcc, exec
    s_cbranch_scc1 L_attn_fin
    s_mov_b32 s22, 1
    v_mov_b32 v2, v1
    v_mov_b32 v6, 0xff800000
    s_mov_b32 s23, 64
L_attn_maxp:
    ds_read_b128 v[68:71], v2
    s_waitcnt lgkmcnt(0)
    v_mfma_f32_32x32x16_bf16 v[28:43], v[68:71], v[8:11], 0
    s_nop 15
    s_nop 3
    v_max3_f32 v6, v6, v28, v29
    v_max3_f32 v6, v6, v30, v31
    v_max3_f32 v6, v6, v32, v33
    v_max3_f32 v6, v6, v34, v35
    v_max3_f32 v6, v6, v36, v37
    v_max3_f32 v6, v6, v38, v39
    v_max3_f32 v6, v6, v40, v41
    v_max3_f32 v6, v6, v42, v43
    v_add_u32 v2, 1024, v2
    s_sub_u32 s23, s23, 1
    s_cmp_lg_u32 s23, 0
    s_cbranch_scc1 L_attn_maxp
    s_branch L_attn_setneg
L_attn_fin:
    v_rcp_f32 v6, v100
    s_nop 0
    v_mul_f32 v92, v92, v6
    v_mul_f32 v93, v93, v6
    v_mul_f32 v94, v94, v6
    v_mul_f32 v95, v95, v6
    v_mul_f32 v96, v96, v6
    v_mul_f32 v97, v97, v6
    v_mul_f32 v98, v98, v6
    v_mul_f32 v99, v99, v6
    v_cvt_pk_bf16_f32 v92, v92, v93
    v_cvt_pk_bf16_f32 v93, v94, v95
    v_cvt_pk_bf16_f32 v94, v96, v97
    v_cvt_pk_bf16_f32 v95, v98, v99
    s_lshl_b32 s10, s9, 5
    s_add_u32 s10, s10, s8
    s_lshl_b32 s10, s10, 10
    s_add_u32 s10, s10, 14442496
    buffer_store_dwordx4 v[92:95], v1, s[4:7], s10 offen
L_attn_kernel_fin:
L_attn_kernel_end:
    s_endpgm
.globl chain1_kernel
.p2align 8
.type chain1_kernel,@function
chain1_kernel:
    s_cmp_ge_u32 s2, 256
    s_cbranch_scc1 L_chain1_kernel_end
    s_load_dwordx2 s[4:5], s[0:1], 72
    v_and_b32 v2, 63, v0
    v_lshrrev_b32 v3, 6, v0
    v_lshlrev_b32 v1, 4, v2
    v_readfirstlane_b32 s3, v3
    s_mov_b32 s6, 0x10000000
    s_mov_b32 s7, 0x00020000
    s_waitcnt lgkmcnt(0)
    v_and_b32 v4, 31, v2
    v_lshrrev_b32 v5, 5, v2
    s_and_b32 s61, s2, 7
    s_lshr_b32 s62, s2, 3
    s_lshr_b32 s60, s61, 1
    s_lshl_b32 s60, s60, 2
    s_and_b32 s63, s62, 3
    s_add_u32 s60, s60, s63
    s_lshr_b32 s62, s62, 2
    s_and_b32 s61, s61, 1
    s_lshr_b32 s44, s62, 2
    s_lshl_b32 s44, s44, 1
    s_lshl_b32 s45, s60, 2
    s_add_u32 s44, s44, s45
    s_and_b32 s45, s62, 3
    s_lshl_b32 s46, s61, 2
    s_add_u32 s45, s45, s46
    s_lshl_b32 s45, s45, 1
    s_and_b32 s46, s3, 1
    s_mov_b32 s47, 14442496
    s_mov_b32 s48, 1572864
    s_cmp_lt_u32 s3, 2
    s_cselect_b32 s49, s44, s45
    s_cselect_b32 s47, s47, s48
    s_add_u32 s49, s49, s46
    s_mul_i32 s49, s49, 32768
    s_add_u32 s50, s47, s49
    s_add_u32 s51, s50, 4096
    s_lshl_b32 s52, s3, 13
    s_add_u32 s53, s52, 4096
    s_add_u32 m0, s52, 0
    s_nop 0
    buffer_load_dwordx4 v1, s[4:7], s50 offen offset:0 lds
    buffer_load_dwordx4 v1, s[4:7], s50 offen offset:1024 lds
    buffer_load_dwordx4 v1, s[4:7], s50 offen offset:2048 lds
    buffer_load_dwordx4 v1, s[4:7], s50 offen offset:3072 lds
    s_add_u32 m0, s53, 0
    s_nop 0
    buffer_load_dwordx4 v1, s[4:7], s51 offen offset:0 lds
    buffer_load_dwordx4 v1, s[4:7], s51 offen offset:1024 lds
    buffer_load_dwordx4 v1, s[4:7], s51 offen offset:2048 lds
    buffer_load_dwordx4 v1, s[4:7], s51 offen offset:3072 lds
    s_add_u32 s50, s50, 8192
    s_add_u32 s51, s51, 8192
    s_add_u32 m0, s52, 32768
    s_nop 0
    buffer_load_dwordx4 v1, s[4:7], s50 offen offset:0 lds
    buffer_load_dwordx4 v1, s[4:7], s50 offen offset:1024 lds
    buffer_load_dwordx4 v1, s[4:7], s50 offen offset:2048 lds
    buffer_load_dwordx4 v1, s[4:7], s50 offen offset:3072 lds
    s_add_u32 m0, s53, 32768
    s_nop 0
    buffer_load_dwordx4 v1, s[4:7], s51 offen offset:0 lds
    buffer_load_dwordx4 v1, s[4:7], s51 offen offset:1024 lds
    buffer_load_dwordx4 v1, s[4:7], s51 offen offset:2048 lds
    buffer_load_dwordx4 v1, s[4:7], s51 offen offset:3072 lds
    s_add_u32 s50, s50, 8192
    s_add_u32 s51, s51, 8192
    s_add_u32 m0, s52, 65536
    s_nop 0
    buffer_load_dwordx4 v1, s[4:7], s50 offen offset:0 lds
    buffer_load_dwordx4 v1, s[4:7], s50 offen offset:1024 lds
    buffer_load_dwordx4 v1, s[4:7], s50 offen offset:2048 lds
    buffer_load_dwordx4 v1, s[4:7], s50 offen offset:3072 lds
    s_add_u32 m0, s53, 65536
    s_nop 0
    buffer_load_dwordx4 v1, s[4:7], s51 offen offset:0 lds
    buffer_load_dwordx4 v1, s[4:7], s51 offen offset:1024 lds
    buffer_load_dwordx4 v1, s[4:7], s51 offen offset:2048 lds
    buffer_load_dwordx4 v1, s[4:7], s51 offen offset:3072 lds
    s_add_u32 s50, s50, 8192
    s_add_u32 s51, s51, 8192
    s_mul_i32 s70, s61, 7
    s_add_u32 s70, s70, s62
    s_lshl_b32 s70, s70, 2
    s_add_u32 s70, s70, s3
    s_lshl_b32 s70, s70, 15
    s_add_u32 s70, s70, 2097152
    s_lshr_b32 s16, s3, 1
    s_and_b32 s17, s3, 1
    s_add_u32 s18, s16, s44
    s_add_u32 s19, s17, s45
    s_lshl_b32 s20, s18, 5
    s_lshl_b32 s21, s19, 1
    s_add_u32 s20, s20, s21
    s_lshl_b32 s20, s20, 10
    s_add_u32 s21, s20, 5791744
    buffer_load_dwordx4 v[56:59], v1, s[4:7], s21 offen
    buffer_load_dwordx4 v[60:63], v1, s[4:7], s21 offen offset:1024
    s_lshl_b32 s26, s16, 13
    v_add_u32 v10, s26, v1
    s_lshl_b32 s26, s17, 13
    s_add_u32 s26, s26, 16384
    v_add_u32 v11, s26, v1
    v_add_u32 v12, 0x10000, v10
    v_add_u32 v13, 0x10000, v11
    s_waitcnt vmcnt(18)
    s_barrier
    s_add_u32 m0, s52, 98304
    s_nop 0
    buffer_load_dwordx4 v1, s[4:7], s50 offen offset:0 lds
    buffer_load_dwordx4 v1, s[4:7], s50 offen offset:1024 lds
    buffer_load_dwordx4 v1, s[4:7], s50 offen offset:2048 lds
    buffer_load_dwordx4 v1, s[4:7], s50 offen offset:3072 lds
    s_add_u32 m0, s53, 98304
    s_nop 0
    buffer_load_dwordx4 v1, s[4:7], s51 offen offset:0 lds
    buffer_load_dwordx4 v1, s[4:7], s51 offen offset:1024 lds
    buffer_load_dwordx4 v1, s[4:7], s51 offen offset:2048 lds
    buffer_load_dwordx4 v1, s[4:7], s51 offen offset:3072 lds
    s_add_u32 s50, s50, 8192
    s_add_u32 s51, s51, 8192
    ds_read_b128 v[32:35], v10 offset:0
    ds_read_b128 v[36:39], v11 offset:0
    ds_read_b128 v[40:43], v10 offset:1024
    ds_read_b128 v[44:47], v11 offset:1024
    ds_read_b128 v[48:51], v10 offset:2048
    ds_read_b128 v[52:55], v11 offset:2048
    s_waitcnt lgkmcnt(4)
    v_mfma_f32_32x32x16_bf16 v[16:31], v[36:39], v[32:35], 0
    buffer_load_dwordx4 a[0:3], v1, s[4:7], s70 offen offset:0
    buffer_load_dwordx4 a[4:7], v1, s[4:7], s70 offen offset:1024
    ds_read_b128 v[32:35], v10 offset:3072
    ds_read_b128 v[36:39], v11 offset:3072
    s_waitcnt lgkmcnt(4)
    v_mfma_f32_32x32x16_bf16 v[16:31], v[44:47], v[40:43], v[16:31]
    buffer_load_dwordx4 a[8:11], v1, s[4:7], s70 offen offset:2048
    buffer_load_dwordx4 a[12:15], v1, s[4:7], s70 offen offset:3072
    ds_read_b128 v[40:43], v10 offset:4096
    ds_read_b128 v[44:47], v11 offset:4096
    s_waitcnt lgkmcnt(4)
    v_mfma_f32_32x32x16_bf16 v[16:31], v[52:55], v[48:51], v[16:31]
    s_add_u32 s70, s70, 4096
    ds_read_b128 v[48:51], v10 offset:5120
    ds_read_b128 v[52:55], v11 offset:5120
    s_waitcnt lgkmcnt(4)
    v_mfma_f32_32x32x16_bf16 v[16:31], v[36:39], v[32:35], v[16:31]
    buffer_load_dwordx4 a[16:19], v1, s[4:7], s70 offen offset:0
    ds_read_b128 v[32:35], v10 offset:6144
    ds_read_b128 v[36:39], v11 offset:6144
    s_waitcnt lgkmcnt(4)
    v_mfma_f32_32x32x16_bf16 v[16:31], v[44:47], v[40:43], v[16:31]
    buffer_load_dwordx4 a[20:23], v1, s[4:7], s70 offen offset:1024
    ds_read_b128 v[40:43], v10 offset:7168
    ds_read_b128 v[44:47], v11 offset:7168
    s_waitcnt lgkmcnt(4)
    v_mfma_f32_32x32x16_bf16 v[16:31], v[52:55], v[48:51], v[16:31]
    buffer_load_dwordx4 a[24:27], v1, s[4:7], s70 offen offset:2048
    s_waitcnt lgkmcnt(2)
    v_mfma_f32_32x32x16_bf16 v[16:31], v[36:39], v[32:35], v[16:31]
    buffer_load_dwordx4 a[28:31], v1, s[4:7], s70 offen offset:3072
    s_waitcnt lgkmcnt(0)
    v_mfma_f32_32x32x16_bf16 v[16:31], v[44:47], v[40:43], v[16:31]
    s_add_u32 s70, s70, 4096
    s_waitcnt vmcnt(26)
    s_barrier
    ds_read_b128 v[32:35], v10 offset:32768
    ds_read_b128 v[36:39], v11 offset:32768
    ds_read_b128 v[40:43], v10 offset:33792
    ds_read_b128 v[44:47], v11 offset:33792
    ds_read_b128 v[48:51], v10 offset:34816
    ds_read_b128 v[52:55], v11 offset:34816
    s_waitcnt lgkmcnt(4)
    v_mfma_f32_32x32x16_bf16 v[16:31], v[36:39], v[32:35], v[16:31]
    buffer_load_dwordx4 a[32:35], v1, s[4:7], s70 offen offset:0
    buffer_load_dwordx4 a[36:39], v1, s[4:7], s70 offen offset:1024
    ds_read_b128 v[32:35], v10 offset:35840
    ds_read_b128 v[36:39], v11 offset:35840
    s_waitcnt lgkmcnt(4)
    v_mfma_f32_32x32x16_bf16 v[16:31], v[44:47], v[40:43], v[16:31]
    buffer_load_dwordx4 a[40:43], v1, s[4:7], s70 offen offset:2048
    buffer_load_dwordx4 a[44:47], v1, s[4:7], s70 offen offset:3072
    ds_read_b128 v[40:43], v10 offset:36864
    ds_read_b128 v[44:47], v11 offset:36864
    s_waitcnt lgkmcnt(4)
    v_mfma_f32_32x32x16_bf16 v[16:31], v[52:55], v[48:51], v[16:31]
    s_add_u32 s70, s70, 4096
    ds_read_b128 v[48:51], v10 offset:37888
    ds_read_b128 v[52:55], v11 offset:37888
    s_waitcnt lgkmcnt(4)
    v_mfma_f32_32x32x16_bf16 v[16:31], v[36:39], v[32:35], v[16:31]
    buffer_load_dwordx4 a[48:51], v1, s[4:7], s70 offen offset:0
    ds_read_b128 v[32:35], v10 offset:38912
    ds_read_b128 v[36:39], v11 offset:38912
    s_waitcnt lgkmcnt(4)
    v_mfma_f32_32x32x16_bf16 v[16:31], v[44:47], v[40:43], v[16:31]
    buffer_load_dwordx4 a[52:55], v1, s[4:7], s70 offen offset:1024
    ds_read_b128 v[40:43], v10 offset:39936
    ds_read_b128 v[44:47], v11 offset:39936
    s_waitcnt lgkmcnt(4)
    v_mfma_f32_32x32x16_bf16 v[16:31], v[52:55], v[48:51], v[16:31]
    buffer_load_dwordx4 a[56:59], v1, s[4:7], s70 offen offset:2048
    s_waitcnt lgkmcnt(2)
    v_mfma_f32_32x32x16_bf16 v[16:31], v[36:39], v[32:35], v[16:31]
    buffer_load_dwordx4 a[60:63], v1, s[4:7], s70 offen offset:3072
    s_waitcnt lgkmcnt(0)
    v_mfma_f32_32x32x16_bf16 v[16:31], v[44:47], v[40:43], v[16:31]
    s_add_u32 s70, s70, 4096
    s_waitcnt vmcnt(26)
    s_barrier
    ds_read_b128 v[32:35], v12 offset:0
    ds_read_b128 v[36:39], v13 offset:0
    ds_read_b128 v[40:43], v12 offset:1024
    ds_read_b128 v[44:47], v13 offset:1024
    ds_read_b128 v[48:51], v12 offset:2048
    ds_read_b128 v[52:55], v13 offset:2048
    s_waitcnt lgkmcnt(4)
    v_mfma_f32_32x32x16_bf16 v[16:31], v[36:39], v[32:35], v[16:31]
    buffer_load_dwordx4 a[64:67], v1, s[4:7], s70 offen offset:0
    buffer_load_dwordx4 a[68:71], v1, s[4:7], s70 offen offset:1024
    ds_read_b128 v[32:35], v12 offset:3072
    ds_read_b128 v[36:39], v13 offset:3072
    s_waitcnt lgkmcnt(4)
    v_mfma_f32_32x32x16_bf16 v[16:31], v[44:47], v[40:43], v[16:31]
    buffer_load_dwordx4 a[72:75], v1, s[4:7], s70 offen offset:2048
    buffer_load_dwordx4 a[76:79], v1, s[4:7], s70 offen offset:3072
    ds_read_b128 v[40:43], v12 offset:4096
    ds_read_b128 v[44:47], v13 offset:4096
    s_waitcnt lgkmcnt(4)
    v_mfma_f32_32x32x16_bf16 v[16:31], v[52:55], v[48:51], v[16:31]
    s_add_u32 s70, s70, 4096
    ds_read_b128 v[48:51], v12 offset:5120
    ds_read_b128 v[52:55], v13 offset:5120
    s_waitcnt lgkmcnt(4)
    v_mfma_f32_32x32x16_bf16 v[16:31], v[36:39], v[32:35], v[16:31]
    buffer_load_dwordx4 a[80:83], v1, s[4:7], s70 offen offset:0
    ds_read_b128 v[32:35], v12 offset:6144
    ds_read_b128 v[36:39], v13 offset:6144
    s_waitcnt lgkmcnt(4)
    v_mfma_f32_32x32x16_bf16 v[16:31], v[44:47], v[40:43], v[16:31]
    buffer_load_dwordx4 a[84:87], v1, s[4:7], s70 offen offset:1024
    ds_read_b128 v[40:43], v12 offset:7168
    ds_read_b128 v[44:47], v13 offset:7168
    s_waitcnt lgkmcnt(4)
    v_mfma_f32_32x32x16_bf16 v[16:31], v[52:55], v[48:51], v[16:31]
    buffer_load_dwordx4 a[88:91], v1, s[4:7], s70 offen offset:2048
    s_waitcnt lgkmcnt(2)
    v_mfma_f32_32x32x16_bf16 v[16:31], v[36:39], v[32:35], v[16:31]
    buffer_load_dwordx4 a[92:95], v1, s[4:7], s70 offen offset:3072
    s_waitcnt lgkmcnt(0)
    v_mfma_f32_32x32x16_bf16 v[16:31], v[44:47], v[40:43], v[16:31]
    s_add_u32 s70, s70, 4096
    s_waitcnt vmcnt(24)
    s_barrier
    ds_read_b128 v[32:35], v12 offset:32768
    ds_read_b128 v[36:39], v13 offset:32768
    ds_read_b128 v[40:43], v12 offset:33792
    ds_read_b128 v[44:47], v13 offset:33792
    ds_read_b128 v[48:51], v12 offset:34816
    ds_read_b128 v[52:55], v13 offset:34816
    s_waitcnt lgkmcnt(4)
    v_mfma_f32_32x32x16_bf16 v[16:31], v[36:39], v[32:35], v[16:31]
    buffer_load_dwordx4 a[96:99], v1, s[4:7], s70 offen offset:0
    buffer_load_dwordx4 a[100:103], v1, s[4:7], s70 offen offset:1024
    ds_read_b128 v[32:35], v12 offset:35840
    ds_read_b128 v[36:39], v13 offset:35840
    s_waitcnt lgkmcnt(4)
    v_mfma_f32_32x32x16_bf16 v[16:31], v[44:47], v[40:43], v[16:31]
    buffer_load_dwordx4 a[104:107], v1, s[4:7], s70 offen offset:2048
    buffer_load_dwordx4 a[108:111], v1, s[4:7], s70 offen offset:3072
    ds_read_b128 v[40:43], v12 offset:36864
    ds_read_b128 v[44:47], v13 offset:36864
    s_waitcnt lgkmcnt(4)
    v_mfma_f32_32x32x16_bf16 v[16:31], v[52:55], v[48:51], v[16:31]
    s_add_u32 s70, s70, 4096
    ds_read_b128 v[48:51], v12 offset:37888
    ds_read_b128 v[52:55], v13 offset:37888
    s_waitcnt lgkmcnt(4)
    v_mfma_f32_32x32x16_bf16 v[16:31], v[36:39], v[32:35], v[16:31]
    buffer_load_dwordx4 a[112:115], v1, s[4:7], s70 offen offset:0
    ds_read_b128 v[32:35], v12 offset:38912
    ds_read_b128 v[36:39], v13 offset:38912
    s_waitcnt lgkmcnt(4)
    v_mfma_f32_32x32x16_bf16 v[16:31], v[44:47], v[40:43], v[16:31]
    buffer_load_dwordx4 a[116:119], v1, s[4:7], s70 offen offset:1024
    ds_read_b128 v[40:43], v12 offset:39936
    ds_read_b128 v[44:47], v13 offset:39936
    s_waitcnt lgkmcnt(4)
    v_mfma_f32_32x32x16_bf16 v[16:31], v[52:55], v[48:51], v[16:31]
    buffer_load_dwordx4 a[120:123], v1, s[4:7], s70 offen offset:2048
    s_waitcnt lgkmcnt(2)
    v_mfma_f32_32x32x16_bf16 v[16:31], v[36:39], v[32:35], v[16:31]
    buffer_load_dwordx4 a[124:127], v1, s[4:7], s70 offen offset:3072
    s_waitcnt lgkmcnt(0)
    v_mfma_f32_32x32x16_bf16 v[16:31], v[44:47], v[40:43], v[16:31]
    s_add_u32 s70, s70, 4096
    s_nop 15
    s_nop 3
    s_waitcnt vmcnt(40)
    v_lshlrev_b32 v6, 16, v56
    v_and_b32 v7, 0xffff0000, v56
    v_add_f32 v16, v16, v6
    v_add_f32 v17, v17, v7
    v_lshlrev_b32 v6, 16, v57
    v_and_b32 v7, 0xffff0000, v57
    v_add_f32 v18, v18, v6
    v_add_f32 v19, v19, v7
    v_lshlrev_b32 v6, 16, v58
    v_and_b32 v7, 0xffff0000, v58
    v_add_f32 v20, v20, v6
    v_add_f32 v21, v21, v7
    v_lshlrev_b32 v6, 16, v59
    v_and_b32 v7, 0xffff0000, v59
    v_add_f32 v22, v22, v6
    v_add_f32 v23, v23, v7
    v_lshlrev_b32 v6, 16, v60
    v_and_b32 v7, 0xffff0000, v60
    v_add_f32 v24, v24, v6
    v_add_f32 v25, v25, v7
    v_lshlrev_b32 v6, 16, v61
    v_and_b32 v7, 0xffff0000, v61
    v_add_f32 v26, v26, v6
    v_add_f32 v27, v27, v7
    v_lshlrev_b32 v6, 16, v62
    v_and_b32 v7, 0xffff0000, v62
    v_add_f32 v28, v28, v6
    v_add_f32 v29, v29, v7
    v_lshlrev_b32 v6, 16, v63
    v_and_b32 v7, 0xffff0000, v63
    v_add_f32 v30, v30, v6
    v_add_f32 v31, v31, v7
    v_cvt_pk_bf16_f32 v216, v16, v17
    v_cvt_pk_bf16_f32 v217, v18, v19
    v_cvt_pk_bf16_f32 v218, v20, v21
    v_cvt_pk_bf16_f32 v219, v22, v23
    v_cvt_pk_bf16_f32 v220, v24, v25
    v_cvt_pk_bf16_f32 v221, v26, v27
    v_cvt_pk_bf16_f32 v222, v28, v29
    v_cvt_pk_bf16_f32 v223, v30, v31
    s_add_u32 s21, s20, 23879680
    buffer_store_dwordx4 v[216:219], v1, s[4:7], s21 offen sc1
    buffer_store_dwordx4 v[220:223], v1, s[4:7], s21 offen offset:1024 sc1
    v_lshlrev_b32 v6, 16, v216
    v_and_b32 v7, 0xffff0000, v216
    v_add_f32 v64, v6, v7
    v_mul_f32 v65, v6, v6
    v_fmac_f32 v65, v7, v7
    v_lshlrev_b32 v6, 16, v217
    v_and_b32 v7, 0xffff0000, v217
    v_add_f32 v64, v64, v6
    v_add_f32 v64, v64, v7
    v_fmac_f32 v65, v6, v6
    v_fmac_f32 v65, v7, v7
    v_lshlrev_b32 v6, 16, v218
    v_and_b32 v7, 0xffff0000, v218
    v_add_f32 v64, v64, v6
    v_add_f32 v64, v64, v7
    v_fmac_f32 v65, v6, v6
    v_fmac_f32 v65, v7, v7
    v_lshlrev_b32 v6, 16, v219
    v_and_b32 v7, 0xffff0000, v219
    v_add_f32 v64, v64, v6
    v_add_f32 v64, v64, v7
    v_fmac_f32 v65, v6, v6
    v_fmac_f32 v65, v7, v7
    v_lshlrev_b32 v6, 16, v220
    v_and_b32 v7, 0xffff0000, v220
    v_add_f32 v64, v64, v6
    v_add_f32 v64, v64, v7
    v_fmac_f32 v65, v6, v6
    v_fmac_f32 v65, v7, v7
    v_lshlrev_b32 v6, 16, v221
    v_and_b32 v7, 0xffff0000, v221
    v_add_f32 v64, v64, v6
    v_add_f32 v64, v64, v7
    v_fmac_f32 v65, v6, v6
    v_fmac_f32 v65, v7, v7
    v_lshlrev_b32 v6, 16, v222
    v_and_b32 v7, 0xffff0000, v222
    v_add_f32 v64, v64, v6
    v_add_f32 v64, v64, v7
    v_fmac_f32 v65, v6, v6
    v_fmac_f32 v65, v7, v7
    v_lshlrev_b32 v6, 16, v223
    v_and_b32 v7, 0xffff0000, v223
    v_add_f32 v64, v64, v6
    v_add_f32 v64, v64, v7
    v_fmac_f32 v65, v6, v6
    v_fmac_f32 v65, v7, v7
    v_mov_b32 v6, v64
    s_nop 1
    v_permlane32_swap_b32 v64, v6
    s_nop 1
    v_add_f32 v64, v64, v6
    v_mov_b32 v6, v65
    s_nop 1
    v_permlane32_swap_b32 v65, v6
    s_nop 1
    v_add_f32 v65, v65, v6
    v_lshlrev_b32 v6, 4, v4
    s_lshl_b32 s30, s18, 3
    s_lshr_b32 s31, s19, 1
    s_add_u32 s30, s30, s31
    s_lshl_b32 s30, s30, 9
    s_and_b32 s31, s19, 1
    s_lshl_b32 s31, s31, 3
    s_add_u32 s31, s31, s30
    s_add_u32 s31, s31, 28073984
    buffer_store_dwordx2 v[64:65], v6, s[4:7], s31 offen sc1
    s_waitcnt vmcnt(0)
    s_barrier
    s_cmp_lg_u32 s3, 0
    s_cbranch_scc1 L_pub_2
    s_lshl_b32 s64, s60, 7
    s_lshl_b32 s65, s61, 5
    s_add_u32 s64, s64, s65
    s_lshl_b32 s65, s62, 2
    s_add_u32 s64, s64, s65
    s_add_u32 s64, s64, 28598272
    v_mov_b32 v2, 0
    v_mov_b32 v3, 1
    s_mov_b64 exec, 1
    buffer_store_dword v3, v2, s[4:7], s64 offen sc1
    s_mov_b64 exec, -1
L_pub_2:
    s_cmp_ge_u32 s62, 7
    s_cbranch_scc1 L_skipw1_3
    s_lshl_b32 s8, s60, 2
    s_mul_i32 s9, s61, 7
    s_add_u32 s9, s9, s62
    s_lshl_b32 s9, s9, 2
    s_add_u32 s19, s9, s3
    s_add_u32 s10, s8, s3
    s_lshl_b32 s10, s10, 15
    s_add_u32 s10, s10, 23879680
    s_lshl_b32 s12, s3, 15
    s_cmp_lg_u32 s3, 0
    s_cbranch_scc1 L_aw_6
    s_lshl_b32 s64, s60, 7
    s_add_u32 s64, s64, 28598272
    v_lshrrev_b32 v2, 2, v1
    v_and_b32 v2, 60, v2
    s_mov_b32 s66, 0x20000
L_poll_7:
    buffer_load_dword v3, v2, s[4:7], s64 offen sc1
    s_waitcnt vmcnt(0)
    v_cmp_eq_u32 vcc, 1, v3
    s_nop 3
    s_and_b32 s65, vcc_lo, 0xffff
    s_cmp_eq_u32 s65, 0xffff
    s_cbranch_scc1 L_done_8
    s_sub_u32 s66, s66, 1
    s_cmp_lg_u32 s66, 0
    s_cbranch_scc1 L_poll_7
L_done_8:
    s_waitcnt vmcnt(0)
L_aw_6:
    s_barrier
    s_add_u32 m0, s12, 0
    s_nop 0
    buffer_load_dwordx4 v1, s[4:7], s10 offen offset:0 sc1 lds
    buffer_load_dwordx4 v1, s[4:7], s10 offen offset:1024 sc1 lds
    buffer_load_dwordx4 v1, s[4:7], s10 offen offset:2048 sc1 lds
    buffer_load_dwordx4 v1, s[4:7], s10 offen offset:3072 sc1 lds
    s_add_u32 s10, s10, 4096
    s_add_u32 m0, s12, 4096
    s_nop 0
    buffer_load_dwordx4 v1, s[4:7], s10 offen offset:0 sc1 lds
    buffer_load_dwordx4 v1, s[4:7], s10 offen offset:1024 sc1 lds
    buffer_load_dwordx4 v1, s[4:7], s10 offen offset:2048 sc1 lds
    buffer_load_dwordx4 v1, s[4:7], s10 offen offset:3072 sc1 lds
    s_add_u32 s10, s10, 4096
    s_add_u32 m0, s12, 8192
    s_nop 0
    buffer_load_dwordx4 v1, s[4:7], s10 offen offset:0 sc1 lds
    buffer_load_dwordx4 v1, s[4:7], s10 offen offset:1024 sc1 lds
    buffer_load_dwordx4 v1, s[4:7], s10 offen offset:2048 sc1 lds
    buffer_load_dwordx4 v1, s[4:7], s10 offen offset:3072 sc1 lds
    s_add_u32 s10, s10, 4096
    s_add_u32 m0, s12, 12288
    s_nop 0
    buffer_load_dwordx4 v1, s[4:7], s10 offen offset:0 sc1 lds
    buffer_load_dwordx4 v1, s[4:7], s10 offen offset:1024 sc1 lds
    buffer_load_dwordx4 v1, s[4:7], s10 offen offset:2048 sc1 lds
    buffer_load_dwordx4 v1, s[4:7], s10 offen offset:3072 sc1 lds
    s_add_u32 s10, s10, 4096
    v_add_u32 v11, 0x10000, v1
    s_lshl_b32 s26, s3, 8
    v_lshlrev_b32 v12, 3, v4
    v_add_u32 v13, 131072, v12
    v_add_u32 v12, s26, v13
    s_mul_i32 s30, s8, 112
    s_lshl_b32 s31, s19, 1
    s_add_u32 s30, s30, s31
    s_lshl_b32 s30, s30, 10
    s_add_u32 s30, s30, 16539648
    s_mov_b32 s32, 0x3fb8aa3b
    s_mov_b32 s33, 0x3fb8aa3b
    s_mov_b32 s34, 2.0
    s_mov_b32 s35, 2.0
    s_mov_b32 s36, -2.0
    s_mov_b32 s37, -2.0
    s_waitcnt vmcnt(12)
    s_barrier
    ds_read_b128 v[80:83], v1 offset:0
    ds_read_b128 v[84:87], v1 offset:32768
    ds_read_b128 v[88:91], v11 offset:0
    ds_read_b128 v[92:95], v11 offset:32768
    ds_read_b128 v[96:99], v1 offset:1024
    ds_read_b128 v[100:103], v1 offset:33792
    ds_read_b128 v[104:107], v11 offset:1024
    ds_read_b128 v[108:111], v11 offset:33792
    s_waitcnt vmcnt(16)
    s_waitcnt lgkmcnt(7)
    v_mfma_f32_32x32x16_bf16 v[16:31], a[0:3], v[80:83], 0
    s_add_u32 m0, s12, 16384
    s_waitcnt lgkmcnt(6)
    v_mfma_f32_32x32x16_bf16 v[32:47], a[0:3], v[84:87], 0
    s_nop 0
    s_waitcnt lgkmcnt(5)
    v_mfma_f32_32x32x16_bf16 v[48:63], a[0:3], v[88:91], 0
    buffer_load_dwordx4 v1, s[4:7], s10 offen offset:0 sc1 lds
    s_waitcnt lgkmcnt(4)
    v_mfma_f32_32x32x16_bf16 v[64:79], a[0:3], v[92:95], 0
    buffer_load_dwordx4 v1, s[4:7], s10 offen offset:1024 sc1 lds
    ds_read_b128 v[80:83], v1 offset:2048
    ds_read_b128 v[84:87], v1 offset:34816
    ds_read_b128 v[88:91], v11 offset:2048
    ds_read_b128 v[92:95], v11 offset:34816
    s_waitcnt lgkmcnt(7)
    v_mfma_f32_32x32x16_bf16 v[16:31], a[4:7], v[96:99], v[16:31]
    buffer_load_dwordx4 v1, s[4:7], s10 offen offset:2048 sc1 lds
    s_waitcnt lgkmcnt(6)
    v_mfma_f32_32x32x16_bf16 v[32:47], a[4:7], v[100:103], v[32:47]
    buffer_load_dwordx4 v1, s[4:7], s10 offen offset:3072 sc1 lds
    s_waitcnt lgkmcnt(5)
    v_mfma_f32_32x32x16_bf16 v[48:63], a[4:7], v[104:107], v[48:63]
    s_add_u32 s10, s10, 4096
    s_waitcnt lgkmcnt(4)
    v_mfma_f32_32x32x16_bf16 v[64:79], a[4:7], v[108:111], v[64:79]
    ds_read_b128 v[96:99], v1 offset:3072
    ds_read_b128 v[100:103], v1 offset:35840
    ds_read_b128 v[104:107], v11 offset:3072
    ds_read_b128 v[108:111], v11 offset:35840
    s_waitcnt lgkmcnt(7)
    v_mfma_f32_32x32x16_bf16 v[16:31], a[8:11], v[80:83], v[16:31]
    s_waitcnt lgkmcnt(6)
    v_mfma_f32_32x32x16_bf16 v[32:47], a[8:11], v[84:87], v[32:47]
    s_waitcnt lgkmcnt(5)
    v_mfma_f32_32x32x16_bf16 v[48:63], a[8:11], v[88:91], v[48:63]
    s_waitcnt lgkmcnt(4)
    v_mfma_f32_32x32x16_bf16 v[64:79], a[8:11], v[92:95], v[64:79]
    s_waitcnt vmcnt(12)
    s_barrier
    ds_read_b128 v[80:83], v1 offset:4096
    ds_read_b128 v[84:87], v1 offset:36864
    ds_read_b128 v[88:91], v11 offset:4096
    ds_read_b128 v[92:95], v11 offset:36864
    s_waitcnt lgkmcnt(7)
    v_mfma_f32_32x32x16_bf16 v[16:31], a[12:15], v[96:99], v[16:31]
    s_waitcnt lgkmcnt(6)
    v_mfma_f32_32x32x16_bf16 v[32:47], a[12:15], v[100:103], v[32:47]
    s_waitcnt lgkmcnt(5)
    v_mfma_f32_32x32x16_bf16 v[48:63], a[12:15], v[104:107], v[48:63]
    s_waitcnt lgkmcnt(4)
    v_mfma_f32_32x32x16_bf16 v[64:79], a[12:15], v[108:111], v[64:79]
    ds_read_b128 v[96:99], v1 offset:5120
    ds_read_b128 v[100:103], v1 offset:37888
    ds_read_b128 v[104:107], v11 offset:5120
    ds_read_b128 v[108:111], v11 offset:37888
    s_waitcnt vmcnt(20)
    s_waitcnt lgkmcnt(7)
    v_mfma_f32_32x32x16_bf16 v[16:31], a[16:19], v[80:83], v[16:31]
    s_add_u32 m0, s12, 20480
    s_nop 0
    s_waitcnt lgkmcnt(6)
    v_mfma_f32_32x32x16_bf16 v[32:47], a[16:19], v[84:87], v[32:47]
    buffer_load_dwordx4 v1, s[4:7], s10 offen offset:0 sc1 lds
    buffer_load_dwordx4 v1, s[4:7], s10 offen offset:1024 sc1 lds
    s_waitcnt lgkmcnt(5)
    v_mfma_f32_32x32x16_bf16 v[48:63], a[16:19], v[88:91], v[48:63]
    buffer_load_dwordx4 v1, s[4:7], s10 offen offset:2048 sc1 lds
    buffer_load_dwordx4 v1, s[4:7], s10 offen offset:3072 sc1 lds
    s_waitcnt lgkmcnt(4)
    v_mfma_f32_32x32x16_bf16 v[64:79], a[16:19], v[92:95], v[64:79]
    s_add_u32 s10, s10, 4096
    s_add_u32 s21, s8, s3
    ds_read_b128 v[80:83], v1 offset:6144
    ds_read_b128 v[84:87], v1 offset:38912
    ds_read_b128 v[88:91], v11 offset:6144
    ds_read_b128 v[92:95], v11 offset:38912
    s_waitcnt lgkmcnt(7)
    v_mfma_f32_32x32x16_bf16 v[16:31], a[20:23], v[96:99], v[16:31]
    s_lshl_b32 s21, s21, 12
    s_add_u32 s21, s21, 28073984
    s_waitcnt lgkmcnt(6)
    v_mfma_f32_32x32x16_bf16 v[32:47], a[20:23], v[100:103], v[32:47]
    buffer_load_dwordx4 v[168:171], v1, s[4:7], s21 offen offset:0 sc1
    buffer_load_dwordx4 v[172:175], v1, s[4:7], s21 offen offset:1024 sc1
    s_waitcnt lgkmcnt(5)
    v_mfma_f32_32x32x16_bf16 v[48:63], a[20:23], v[104:107], v[48:63]
    buffer_load_dwordx4 v[176:179], v1, s[4:7], s21 offen offset:2048 sc1
    buffer_load_dwordx4 v[180:183], v1, s[4:7], s21 offen offset:3072 sc1
    s_waitcnt lgkmcnt(4)
    v_mfma_f32_32x32x16_bf16 v[64:79], a[20:23], v[108:111], v[64:79]
    v_lshlrev_b32 v14, 6, v5
    s_lshl_b32 s22, s19, 7
    ds_read_b128 v[96:99], v1 offset:7168
    ds_read_b128 v[100:103], v1 offset:39936
    ds_read_b128 v[104:107], v11 offset:7168
    ds_read_b128 v[108:111], v11 offset:39936
    s_waitcnt lgkmcnt(7)
    v_mfma_f32_32x32x16_bf16 v[16:31], a[24:27], v[80:83], v[16:31]
    s_add_u32 s22, s22, 5775360
    buffer_load_dwordx4 v[112:115], v14, s[4:7], s22 offen offset:0
    s_waitcnt lgkmcnt(6)
    v_mfma_f32_32x32x16_bf16 v[32:47], a[24:27], v[84:87], v[32:47]
    buffer_load_dwordx4 v[116:119], v14, s[4:7], s22 offen offset:16
    buffer_load_dwordx4 v[120:123], v14, s[4:7], s22 offen offset:32
    s_waitcnt lgkmcnt(5)
    v_mfma_f32_32x32x16_bf16 v[48:63], a[24:27], v[88:91], v[48:63]
    buffer_load_dwordx4 v[124:127], v14, s[4:7], s22 offen offset:48
    s_lshl_b32 s23, s19, 7
    s_waitcnt lgkmcnt(4)
    v_mfma_f32_32x32x16_bf16 v[64:79], a[24:27], v[92:95], v[64:79]
    s_add_u32 s23, s23, 5783552
    buffer_load_dwordx4 v[128:131], v14, s[4:7], s23 offen offset:0
    s_waitcnt vmcnt(21)
    s_barrier
    ds_read_b128 v[80:83], v1 offset:8192
    ds_read_b128 v[84:87], v1 offset:40960
    ds_read_b128 v[88:91], v11 offset:8192
    ds_read_b128 v[92:95], v11 offset:40960
    s_waitcnt lgkmcnt(7)
    v_mfma_f32_32x32x16_bf16 v[16:31], a[28:31], v[96:99], v[16:31]
    buffer_load_dwordx4 v[132:135], v14, s[4:7], s23 offen offset:16
    buffer_load_dwordx4 v[136:139], v14, s[4:7], s23 offen offset:32
    s_waitcnt lgkmcnt(6)
    v_mfma_f32_32x32x16_bf16 v[32:47], a[28:31], v[100:103], v[32:47]
    buffer_load_dwordx4 v[140:143], v14, s[4:7], s23 offen offset:48
    s_waitcnt lgkmcnt(5)
    v_mfma_f32_32x32x16_bf16 v[48:63], a[28:31], v[104:107], v[48:63]
    s_waitcnt lgkmcnt(4)
    v_mfma_f32_32x32x16_bf16 v[64:79], a[28:31], v[108:111], v[64:79]
    ds_read_b128 v[96:99], v1 offset:9216
    ds_read_b128 v[100:103], v1 offset:41984
    ds_read_b128 v[104:107], v11 offset:9216
    ds_read_b128 v[108:111], v11 offset:41984
    s_waitcnt vmcnt(36)
    s_waitcnt lgkmcnt(7)
    v_mfma_f32_32x32x16_bf16 v[16:31], a[32:35], v[80:83], v[16:31]
    s_add_u32 m0, s12, 24576
    s_waitcnt lgkmcnt(6)
    v_mfma_f32_32x32x16_bf16 v[32:47], a[32:35], v[84:87], v[32:47]
    s_nop 0
    s_waitcnt lgkmcnt(5)
    v_mfma_f32_32x32x16_bf16 v[48:63], a[32:35], v[88:91], v[48:63]
    buffer_load_dwordx4 v1, s[4:7], s10 offen offset:0 sc1 lds
    s_waitcnt lgkmcnt(4)
    v_mfma_f32_32x32x16_bf16 v[64:79], a[32:35], v[92:95], v[64:79]
    buffer_load_dwordx4 v1, s[4:7], s10 offen offset:1024 sc1 lds
    ds_read_b128 v[80:83], v1 offset:10240
    ds_read_b128 v[84:87], v1 offset:43008
    ds_read_b128 v[88:91], v11 offset:10240
    ds_read_b128 v[92:95], v11 offset:43008
    s_waitcnt lgkmcnt(7)
    v_mfma_f32_32x32x16_bf16 v[16:31], a[36:39], v[96:99], v[16:31]
    buffer_load_dwordx4 v1, s[4:7], s10 offen offset:2048 sc1 lds
    s_waitcnt lgkmcnt(6)
    v_mfma_f32_32x32x16_bf16 v[32:47], a[36:39], v[100:103], v[32:47]
    buffer_load_dwordx4 v1, s[4:7], s10 offen offset:3072 sc1 lds
    s_waitcnt lgkmcnt(5)
    v_mfma_f32_32x32x16_bf16 v[48:63], a[36:39], v[104:107], v[48:63]
    s_add_u32 s10, s10, 4096
    s_waitcnt lgkmcnt(4)
    v_mfma_f32_32x32x16_bf16 v[64:79], a[36:39], v[108:111], v[64:79]
    ds_read_b128 v[96:99], v1 offset:11264
    ds_read_b128 v[100:103], v1 offset:44032
    ds_read_b128 v[104:107], v11 offset:11264
    ds_read_b128 v[108:111], v11 offset:44032
    s_waitcnt lgkmcnt(7)
    v_mfma_f32_32x32x16_bf16 v[16:31], a[40:43], v[80:83], v[16:31]
    s_waitcnt lgkmcnt(6)
    v_mfma_f32_32x32x16_bf16 v[32:47], a[40:43], v[84:87], v[32:47]
    s_waitcnt lgkmcnt(5)
    v_mfma_f32_32x32x16_bf16 v[48:63], a[40:43], v[88:91], v[48:63]
    s_waitcnt lgkmcnt(4)
    v_mfma_f32_32x32x16_bf16 v[64:79], a[40:43], v[92:95], v[64:79]
    s_waitcnt vmcnt(24)
    s_barrier
    ds_read_b128 v[80:83], v1 offset:12288
    ds_read_b128 v[84:87], v1 offset:45056
    ds_read_b128 v[88:91], v11 offset:12288
    ds_read_b128 v[92:95], v11 offset:45056
    s_waitcnt lgkmcnt(7)
    v_mfma_f32_32x32x16_bf16 v[16:31], a[44:47], v[96:99], v[16:31]
    s_waitcnt lgkmcnt(6)
    v_mfma_f32_32x32x16_bf16 v[32:47], a[44:47], v[100:103], v[32:47]
    s_waitcnt lgkmcnt(5)
    v_mfma_f32_32x32x16_bf16 v[48:63], a[44:47], v[104:107], v[48:63]
    s_waitcnt lgkmcnt(4)
    v_mfma_f32_32x32x16_bf16 v[64:79], a[44:47], v[108:111], v[64:79]
    ds_read_b128 v[96:99], v1 offset:13312
    ds_read_b128 v[100:103], v1 offset:46080
    ds_read_b128 v[104:107], v11 offset:13312
    ds_read_b128 v[108:111], v11 offset:46080
    s_waitcnt vmcnt(40)
    s_waitcnt lgkmcnt(7)
    v_mfma_f32_32x32x16_bf16 v[16:31], a[48:51], v[80:83], v[16:31]
    s_add_u32 m0, s12, 28672
    s_waitcnt lgkmcnt(6)
    v_mfma_f32_32x32x16_bf16 v[32:47], a[48:51], v[84:87], v[32:47]
    s_nop 0
    s_waitcnt lgkmcnt(5)
    v_mfma_f32_32x32x16_bf16 v[48:63], a[48:51], v[88:91], v[48:63]
    buffer_load_dwordx4 v1, s[4:7], s10 offen offset:0 sc1 lds
    s_waitcnt lgkmcnt(4)
    v_mfma_f32_32x32x16_bf16 v[64:79], a[48:51], v[92:95], v[64:79]
    buffer_load_dwordx4 v1, s[4:7], s10 offen offset:1024 sc1 lds
    ds_read_b128 v[80:83], v1 offset:14336
    ds_read_b128 v[84:87], v1 offset:47104
    ds_read_b128 v[88:91], v11 offset:14336
    ds_read_b128 v[92:95], v11 offset:47104
    s_waitcnt lgkmcnt(7)
    v_mfma_f32_32x32x16_bf16 v[16:31], a[52:55], v[96:99], v[16:31]
    buffer_load_dwordx4 v1, s[4:7], s10 offen offset:2048 sc1 lds
    s_waitcnt lgkmcnt(6)
    v_mfma_f32_32x32x16_bf16 v[32:47], a[52:55], v[100:103], v[32:47]
    buffer_load_dwordx4 v1, s[4:7], s10 offen offset:3072 sc1 lds
    s_waitcnt lgkmcnt(5)
    v_mfma_f32_32x32x16_bf16 v[48:63], a[52:55], v[104:107], v[48:63]
    s_add_u32 s10, s10, 4096
    s_waitcnt lgkmcnt(4)
    v_mfma_f32_32x32x16_bf16 v[64:79], a[52:55], v[108:111], v[64:79]
    ds_read_b128 v[96:99], v1 offset:15360
    ds_read_b128 v[100:103], v1 offset:48128
    ds_read_b128 v[104:107], v11 offset:15360
    ds_read_b128 v[108:111], v11 offset:48128
    s_waitcnt lgkmcnt(7)
    v_mfma_f32_32x32x16_bf16 v[16:31], a[56:59], v[80:83], v[16:31]
    s_waitcnt lgkmcnt(6)
    v_mfma_f32_32x32x16_bf16 v[32:47], a[56:59], v[84:87], v[32:47]
    s_waitcnt lgkmcnt(5)
    v_mfma_f32_32x32x16_bf16 v[48:63], a[56:59], v[88:91], v[48:63]
    s_waitcnt lgkmcnt(4)
    v_mfma_f32_32x32x16_bf16 v[64:79], a[56:59], v[92:95], v[64:79]
    s_waitcnt vmcnt(24)
    s_barrier
    ds_read_b128 v[80:83], v1 offset:16384
    ds_read_b128 v[84:87], v1 offset:49152
    ds_read_b128 v[88:91], v11 offset:16384
    ds_read_b128 v[92:95], v11 offset:49152
    s_waitcnt lgkmcnt(7)
    v_mfma_f32_32x32x16_bf16 v[16:31], a[60:63], v[96:99], v[16:31]
    s_waitcnt lgkmcnt(6)
    v_mfma_f32_32x32x16_bf16 v[32:47], a[60:63], v[100:103], v[32:47]
    s_waitcnt lgkmcnt(5)
    v_mfma_f32_32x32x16_bf16 v[48:63], a[60:63], v[104:107], v[48:63]
    s_waitcnt lgkmcnt(4)
    v_mfma_f32_32x32x16_bf16 v[64:79], a[60:63], v[108:111], v[64:79]
    ds_read_b128 v[96:99], v1 offset:17408
    ds_read_b128 v[100:103], v1 offset:50176
    ds_read_b128 v[104:107], v11 offset:17408
    ds_read_b128 v[108:111], v11 offset:50176
    s_waitcnt vmcnt(44)
    s_waitcnt lgkmcnt(7)
    v_mfma_f32_32x32x16_bf16 v[16:31], a[64:67], v[80:83], v[16:31]
    s_waitcnt lgkmcnt(6)
    v_mfma_f32_32x32x16_bf16 v[32:47], a[64:67], v[84:87], v[32:47]
    s_waitcnt lgkmcnt(5)
    v_mfma_f32_32x32x16_bf16 v[48:63], a[64:67], v[88:91], v[48:63]
    s_waitcnt lgkmcnt(4)
    v_mfma_f32_32x32x16_bf16 v[64:79], a[64:67], v[92:95], v[64:79]
    ds_read_b128 v[80:83], v1 offset:18432
    ds_read_b128 v[84:87], v1 offset:51200
    ds_read_b128 v[88:91], v11 offset:18432
    ds_read_b128 v[92:95], v11 offset:51200
    s_waitcnt lgkmcnt(7)
    v_mfma_f32_32x32x16_bf16 v[16:31], a[68:71], v[96:99], v[16:31]
    s_waitcnt lgkmcnt(6)
    v_mfma_f32_32x32x16_bf16 v[32:47], a[68:71], v[100:103], v[32:47]
    s_waitcnt lgkmcnt(5)
    v_mfma_f32_32x32x16_bf16 v[48:63], a[68:71], v[104:107], v[48:63]
    s_waitcnt lgkmcnt(4)
    v_mfma_f32_32x32x16_bf16 v[64:79], a[68:71], v[108:111], v[64:79]
    ds_read_b128 v[96:99], v1 offset:19456
    ds_read_b128 v[100:103], v1 offset:52224
    ds_read_b128 v[104:107], v11 offset:19456
    ds_read_b128 v[108:111], v11 offset:52224
    s_waitcnt lgkmcnt(7)
    v_mfma_f32_32x32x16_bf16 v[16:31], a[72:75], v[80:83], v[16:31]
    s_waitcnt lgkmcnt(6)
    v_mfma_f32_32x32x16_bf16 v[32:47], a[72:75], v[84:87], v[32:47]
    s_waitcnt lgkmcnt(5)
    v_mfma_f32_32x32x16_bf16 v[48:63], a[72:75], v[88:91], v[48:63]
    s_waitcnt lgkmcnt(4)
    v_mfma_f32_32x32x16_bf16 v[64:79], a[72:75], v[92:95], v[64:79]
    s_waitcnt vmcnt(20)
    s_barrier
    ds_read_b128 v[80:83], v1 offset:20480
    ds_read_b128 v[84:87], v1 offset:53248
    ds_read_b128 v[88:91], v11 offset:20480
    ds_read_b128 v[92:95], v11 offset:53248
    s_waitcnt lgkmcnt(7)
    v_mfma_f32_32x32x16_bf16 v[16:31], a[76:79], v[96:99], v[16:31]
    s_waitcnt lgkmcnt(6)
    v_mfma_f32_32x32x16_bf16 v[32:47], a[76:79], v[100:103], v[32:47]
    s_waitcnt lgkmcnt(5)
    v_mfma_f32_32x32x16_bf16 v[48:63], a[76:79], v[104:107], v[48:63]
    s_waitcnt lgkmcnt(4)
    v_mfma_f32_32x32x16_bf16 v[64:79], a[76:79], v[108:111], v[64:79]
    ds_read_b128 v[96:99], v1 offset:21504
    ds_read_b128 v[100:103], v1 offset:54272
    ds_read_b128 v[104:107], v11 offset:21504
    ds_read_b128 v[108:111], v11 offset:54272
    s_waitcnt vmcnt(44)
    s_waitcnt lgkmcnt(7)
    v_mfma_f32_32x32x16_bf16 v[16:31], a[80:83], v[80:83], v[16:31]
    s_waitcnt vmcnt(8)
    v_add_f32 v168, v168, v170
    v_add_f32 v169, v169, v171
    s_waitcnt lgkmcnt(6)
    v_mfma_f32_32x32x16_bf16 v[32:47], a[80:83], v[84:87], v[32:47]
    v_add_f32 v168, v168, v172
    v_add_f32 v169, v169, v173
    v_add_f32 v168, v168, v174
    s_waitcnt lgkmcnt(5)
    v_mfma_f32_32x32x16_bf16 v[48:63], a[80:83], v[88:91], v[48:63]
    v_add_f32 v169, v169, v175
    v_add_f32 v168, v168, v176
    v_add_f32 v169, v169, v177
    s_waitcnt lgkmcnt(4)
    v_mfma_f32_32x32x16_bf16 v[64:79], a[80:83], v[92:95], v[64:79]
    v_add_f32 v168, v168, v178
    v_add_f32 v169, v169, v179
    v_add_f32 v168, v168, v180
    ds_read_b128 v[80:83], v1 offset:22528
    ds_read_b128 v[84:87], v1 offset:55296
    ds_read_b128 v[88:91], v11 offset:22528
    ds_read_b128 v[92:95], v11 offset:55296
    s_waitcnt lgkmcnt(7)
    v_mfma_f32_32x32x16_bf16 v[16:31], a[84:87], v[96:99], v[16:31]
    v_add_f32 v169, v169, v181
    v_add_f32 v168, v168, v182
    v_add_f32 v169, v169, v183
    s_waitcnt lgkmcnt(6)
    v_mfma_f32_32x32x16_bf16 v[32:47], a[84:87], v[100:103], v[32:47]
    v_mov_b32 v170, v168
    s_nop 1
    v_permlane32_swap_b32 v168, v170
    s_waitcnt lgkmcnt(5)
    v_mfma_f32_32x32x16_bf16 v[48:63], a[84:87], v[104:107], v[48:63]
    s_nop 1
    v_add_f32 v168, v168, v170
    s_waitcnt lgkmcnt(4)
    v_mfma_f32_32x32x16_bf16 v[64:79], a[84:87], v[108:111], v[64:79]
    v_mov_b32 v170, v169
    s_nop 1
    ds_read_b128 v[96:99], v1 offset:23552
    ds_read_b128 v[100:103], v1 offset:56320
    ds_read_b128 v[104:107], v11 offset:23552
    ds_read_b128 v[108:111], v11 offset:56320
    s_waitcnt lgkmcnt(7)
    v_mfma_f32_32x32x16_bf16 v[16:31], a[88:91], v[80:83], v[16:31]
    v_permlane32_swap_b32 v169, v170
    s_nop 1
    s_waitcnt lgkmcnt(6)
    v_mfma_f32_32x32x16_bf16 v[32:47], a[88:91], v[84:87], v[32:47]
    v_add_f32 v169, v169, v170
    v_mul_f32 v168, 0x3b000000, v168
    s_waitcnt lgkmcnt(5)
    v_mfma_f32_32x32x16_bf16 v[48:63], a[88:91], v[88:91], v[48:63]
    v_mul_f32 v169, 0x3b000000, v169
    v_fma_f32 v169, -v168, v168, v169
    s_waitcnt lgkmcnt(4)
    v_mfma_f32_32x32x16_bf16 v[64:79], a[88:91], v[92:95], v[64:79]
    v_max_f32 v169, 0, v169
    v_add_f32 v169, 0x3727c5ac, v169
    s_waitcnt vmcnt(4)
    s_barrier
    ds_read_b128 v[80:83], v1 offset:24576
    ds_read_b128 v[84:87], v1 offset:57344
    ds_read_b128 v[88:91], v11 offset:24576
    ds_read_b128 v[92:95], v11 offset:57344
    s_waitcnt lgkmcnt(7)
    v_mfma_f32_32x32x16_bf16 v[16:31], a[92:95], v[96:99], v[16:31]
    v_rsq_f32 v169, v169
    s_nop 0
    s_waitcnt lgkmcnt(6)
    v_mfma_f32_32x32x16_bf16 v[32:47], a[92:95], v[100:103], v[32:47]
    v_mul_f32 v168, v168, v169
    ds_write_b64 v12, v[168:169]
    s_waitcnt lgkmcnt(6)
    v_mfma_f32_32x32x16_bf16 v[48:63], a[92:95], v[104:107], v[48:63]
    s_waitcnt lgkmcnt(5)
    v_mfma_f32_32x32x16_bf16 v[64:79], a[92:95], v[108:111], v[64:79]
    ds_read_b128 v[96:99], v1 offset:25600
    ds_read_b128 v[100:103], v1 offset:58368
    ds_read_b128 v[104:107], v11 offset:25600
    ds_read_b128 v[108:111], v11 offset:58368
    s_waitcnt vmcnt(44)
    s_waitcnt lgkmcnt(8)
    v_mfma_f32_32x32x16_bf16 v[16:31], a[96:99], v[80:83], v[16:31]
    s_waitcnt lgkmcnt(7)
    v_mfma_f32_32x32x16_bf16 v[32:47], a[96:99], v[84:87], v[32:47]
    s_waitcnt lgkmcnt(6)
    v_mfma_f32_32x32x16_bf16 v[48:63], a[96:99], v[88:91], v[48:63]
    s_waitcnt lgkmcnt(5)
    v_mfma_f32_32x32x16_bf16 v[64:79], a[96:99], v[92:95], v[64:79]
    ds_read_b128 v[80:83], v1 offset:26624
    ds_read_b128 v[84:87], v1 offset:59392
    ds_read_b128 v[88:91], v11 offset:26624
    ds_read_b128 v[92:95], v11 offset:59392
    s_waitcnt lgkmcnt(7)
    v_mfma_f32_32x32x16_bf16 v[16:31], a[100:103], v[96:99], v[16:31]
    s_waitcnt lgkmcnt(6)
    v_mfma_f32_32x32x16_bf16 v[32:47], a[100:103], v[100:103], v[32:47]
    s_waitcnt lgkmcnt(5)
    v_mfma_f32_32x32x16_bf16 v[48:63], a[100:103], v[104:107], v[48:63]
    s_waitcnt lgkmcnt(4)
    v_mfma_f32_32x32x16_bf16 v[64:79], a[100:103], v[108:111], v[64:79]
    ds_read_b128 v[96:99], v1 offset:27648
    ds_read_b128 v[100:103], v1 offset:60416
    ds_read_b128 v[104:107], v11 offset:27648
    ds_read_b128 v[108:111], v11 offset:60416
    s_waitcnt lgkmcnt(7)
    v_mfma_f32_32x32x16_bf16 v[16:31], a[104:107], v[80:83], v[16:31]
    s_waitcnt lgkmcnt(6)
    v_mfma_f32_32x32x16_bf16 v[32:47], a[104:107], v[84:87], v[32:47]
    s_waitcnt lgkmcnt(5)
    v_mfma_f32_32x32x16_bf16 v[48:63], a[104:107], v[88:91], v[48:63]
    s_waitcnt lgkmcnt(4)
    v_mfma_f32_32x32x16_bf16 v[64:79], a[104:107], v[92:95], v[64:79]
    s_waitcnt vmcnt(0)
    s_waitcnt lgkmcnt(12)
    s_barrier
    ds_read_b64 v[144:145], v13 offset:0
    ds_read_b64 v[146:147], v13 offset:256
    ds_read_b64 v[148:149], v13 offset:512
    ds_read_b64 v[150:151], v13 offset:768
    ds_read_b128 v[80:83], v1 offset:28672
    ds_read_b128 v[84:87], v1 offset:61440
    ds_read_b128 v[88:91], v11 offset:28672
    ds_read_b128 v[92:95], v11 offset:61440
    s_waitcnt lgkmcnt(11)
    v_mfma_f32_32x32x16_bf16 v[16:31], a[108:111], v[96:99], v[16:31]
    s_waitcnt lgkmcnt(10)
    v_mfma_f32_32x32x16_bf16 v[32:47], a[108:111], v[100:103], v[32:47]
    s_waitcnt lgkmcnt(9)
    v_mfma_f32_32x32x16_bf16 v[48:63], a[108:111], v[104:107], v[48:63]
    s_waitcnt lgkmcnt(8)
    v_mfma_f32_32x32x16_bf16 v[64:79], a[108:111], v[108:111], v[64:79]
    ds_read_b128 v[96:99], v1 offset:29696
    ds_read_b128 v[100:103], v1 offset:62464
    ds_read_b128 v[104:107], v11 offset:29696
    ds_read_b128 v[108:111], v11 offset:62464
    s_waitcnt vmcnt(44)
    s_waitcnt lgkmcnt(7)
    v_mfma_f32_32x32x16_bf16 v[16:31], a[112:115], v[80:83], v[16:31]
    s_waitcnt lgkmcnt(6)
    v_mfma_f32_32x32x16_bf16 v[32:47], a[112:115], v[84:87], v[32:47]
    s_waitcnt lgkmcnt(5)
    v_mfma_f32_32x32x16_bf16 v[48:63], a[112:115], v[88:91], v[48:63]
    s_waitcnt lgkmcnt(4)
    v_mfma_f32_32x32x16_bf16 v[64:79], a[112:115], v[92:95], v[64:79]
    ds_read_b128 v[80:83], v1 offset:30720
    ds_read_b128 v[84:87], v1 offset:63488
    ds_read_b128 v[88:91], v11 offset:30720
    ds_read_b128 v[92:95], v11 offset:63488
    s_waitcnt lgkmcnt(7)
    v_mfma_f32_32x32x16_bf16 v[16:31], a[116:119], v[96:99], v[16:31]
    s_waitcnt lgkmcnt(6)
    v_mfma_f32_32x32x16_bf16 v[32:47], a[116:119], v[100:103], v[32:47]
    s_waitcnt lgkmcnt(5)
    v_mfma_f32_32x32x16_bf16 v[48:63], a[116:119], v[104:107], v[48:63]
    s_waitcnt lgkmcnt(4)
    v_mfma_f32_32x32x16_bf16 v[64:79], a[116:119], v[108:111], v[64:79]
    ds_read_b128 v[96:99], v1 offset:31744
    ds_read_b128 v[100:103], v1 offset:64512
    ds_read_b128 v[104:107], v11 offset:31744
    ds_read_b128 v[108:111], v11 offset:64512
    s_waitcnt lgkmcnt(7)
    v_mfma_f32_32x32x16_bf16 v[16:31], a[120:123], v[80:83], v[16:31]
    s_waitcnt lgkmcnt(6)
    v_mfma_f32_32x32x16_bf16 v[32:47], a[120:123], v[84:87], v[32:47]
    s_waitcnt lgkmcnt(5)
    v_mfma_f32_32x32x16_bf16 v[48:63], a[120:123], v[88:91], v[48:63]
    s_waitcnt lgkmcnt(4)
    v_mfma_f32_32x32x16_bf16 v[64:79], a[120:123], v[92:95], v[64:79]
    s_waitcnt lgkmcnt(3)
    v_mfma_f32_32x32x16_bf16 v[16:31], a[124:127], v[96:99], v[16:31]
    s_waitcnt lgkmcnt(2)
    v_mfma_f32_32x32x16_bf16 v[32:47], a[124:127], v[100:103], v[32:47]
    s_waitcnt lgkmcnt(1)
    v_mfma_f32_32x32x16_bf16 v[48:63], a[124:127], v[104:107], v[48:63]
    s_waitcnt lgkmcnt(0)
    v_mfma_f32_32x32x16_bf16 v[64:79], a[124:127], v[108:111], v[64:79]
    s_barrier
    s_lshr_b32 s44, s62, 2
    s_lshl_b32 s44, s44, 1
    s_lshl_b32 s45, s60, 2
    s_add_u32 s44, s44, s45
    s_and_b32 s45, s62, 3
    s_lshl_b32 s46, s61, 2
    s_add_u32 s45, s45, s46
    s_lshl_b32 s45, s45, 1
    s_and_b32 s46, s3, 1
    s_mov_b32 s47, 16539648
    s_mov_b32 s48, 3932160
    s_cmp_lt_u32 s3, 2
    s_cselect_b32 s49, s44, s45
    s_cselect_b32 s47, s47, s48
    s_add_u32 s49, s49, s46
    s_mul_i32 s49, s49, 114688
    s_add_u32 s50, s47, s49
    s_add_u32 s51, s50, 4096
    s_lshl_b32 s52, s3, 13
    s_add_u32 s53, s52, 4096
    s_cmp_lt_u32 s3, 2
    s_cbranch_scc1 L_pre_9
    s_add_u32 m0, s52, 0
    s_nop 0
    buffer_load_dwordx4 v1, s[4:7], s50 offen offset:0 sc1 lds
    buffer_load_dwordx4 v1, s[4:7], s50 offen offset:1024 sc1 lds
    buffer_load_dwordx4 v1, s[4:7], s50 offen offset:2048 sc1 lds
    buffer_load_dwordx4 v1, s[4:7], s50 offen offset:3072 sc1 lds
    s_add_u32 m0, s53, 0
    s_nop 0
    buffer_load_dwordx4 v1, s[4:7], s51 offen offset:0 sc1 lds
    buffer_load_dwordx4 v1, s[4:7], s51 offen offset:1024 sc1 lds
    buffer_load_dwordx4 v1, s[4:7], s51 offen offset:2048 sc1 lds
    buffer_load_dwordx4 v1, s[4:7], s51 offen offset:3072 sc1 lds
    s_add_u32 s50, s50, 8192
    s_add_u32 s51, s51, 8192
    s_add_u32 m0, s52, 32768
    s_nop 0
    buffer_load_dwordx4 v1, s[4:7], s50 offen offset:0 sc1 lds
    buffer_load_dwordx4 v1, s[4:7], s50 offen offset:1024 sc1 lds
    buffer_load_dwordx4 v1, s[4:7], s50 offen offset:2048 sc1 lds
    buffer_load_dwordx4 v1, s[4:7], s50 offen offset:3072 sc1 lds
    s_add_u32 m0, s53, 32768
    s_nop 0
    buffer_load_dwordx4 v1, s[4:7], s51 offen offset:0 sc1 lds
    buffer_load_dwordx4 v1, s[4:7], s51 offen offset:1024 sc1 lds
    buffer_load_dwordx4 v1, s[4:7], s51 offen offset:2048 sc1 lds
    buffer_load_dwordx4 v1, s[4:7], s51 offen offset:3072 sc1 lds
    s_add_u32 s50, s50, 8192
    s_add_u32 s51, s51, 8192
    s_add_u32 m0, s52, 65536
    s_nop 0
    buffer_load_dwordx4 v1, s[4:7], s50 offen offset:0 sc1 lds
    buffer_load_dwordx4 v1, s[4:7], s50 offen offset:1024 sc1 lds
    buffer_load_dwordx4 v1, s[4:7], s50 offen offset:2048 sc1 lds
    buffer_load_dwordx4 v1, s[4:7], s50 offen offset:3072 sc1 lds
    s_add_u32 m0, s53, 65536
    s_nop 0
    buffer_load_dwordx4 v1, s[4:7], s51 offen offset:0 sc1 lds
    buffer_load_dwordx4 v1, s[4:7], s51 offen offset:1024 sc1 lds
    buffer_load_dwordx4 v1, s[4:7], s51 offen offset:2048 sc1 lds
    buffer_load_dwordx4 v1, s[4:7], s51 offen offset:3072 sc1 lds
    s_add_u32 s50, s50, 8192
    s_add_u32 s51, s51, 8192
L_pre_9:
    s_nop 15
    s_nop 3
    s_waitcnt lgkmcnt(15)
    v_pk_fma_f32 v[152:153], v[144:145], v[112:113], v[128:129] op_sel:[0,0,0] op_sel_hi:[0,1,1] neg_lo:[1,0,0] neg_hi:[1,0,0]
    v_pk_fma_f32 v[16:17], v[16:17], v[144:145], v[152:153] op_sel:[0,1,0] op_sel_hi:[1,1,1]
    v_pk_mul_f32 v[152:153], v[16:17], s[32:33]
    v_pk_fma_f32 v[156:157], v[144:145], v[114:115], v[130:131] op_sel:[0,0,0] op_sel_hi:[0,1,1] neg_lo:[1,0,0] neg_hi:[1,0,0]
    v_pk_fma_f32 v[18:19], v[18:19], v[144:145], v[156:157] op_sel:[0,1,0] op_sel_hi:[1,1,1]
    v_pk_mul_f32 v[156:157], v[18:19], s[32:33]
    v_pk_fma_f32 v[160:161], v[144:145], v[116:117], v[132:133] op_sel:[0,0,0] op_sel_hi:[0,1,1] neg_lo:[1,0,0] neg_hi:[1,0,0]
    v_pk_fma_f32 v[20:21], v[20:21], v[144:145], v[160:161] op_sel:[0,1,0] op_sel_hi:[1,1,1]
    v_pk_mul_f32 v[160:161], v[20:21], s[32:33]
    v_pk_fma_f32 v[164:165], v[144:145], v[118:119], v[134:135] op_sel:[0,0,0] op_sel_hi:[0,1,1] neg_lo:[1,0,0] neg_hi:[1,0,0]
    v_pk_fma_f32 v[22:23], v[22:23], v[144:145], v[164:165] op_sel:[0,1,0] op_sel_hi:[1,1,1]
    v_pk_mul_f32 v[164:165], v[22:23], s[32:33]
    v_exp_f32 v152, v152
    v_exp_f32 v153, v153
    v_exp_f32 v156, v156
    v_exp_f32 v157, v157
    v_exp_f32 v160, v160
    v_exp_f32 v161, v161
    v_exp_f32 v164, v164
    v_exp_f32 v165, v165
    v_pk_add_f32 v[154:155], v[152:153], s[34:35]
    v_pk_fma_f32 v[152:153], v[152:153], v[154:155], s[34:35]
    v_pk_add_f32 v[158:159], v[156:157], s[34:35]
    v_pk_fma_f32 v[156:157], v[156:157], v[158:159], s[34:35]
    v_pk_add_f32 v[162:163], v[160:161], s[34:35]
    v_pk_fma_f32 v[160:161], v[160:161], v[162:163], s[34:35]
    v_pk_add_f32 v[166:167], v[164:165], s[34:35]
    v_pk_fma_f32 v[164:165], v[164:165], v[166:167], s[34:35]
    v_rcp_f32 v152, v152
    v_rcp_f32 v153, v153
    v_rcp_f32 v156, v156
    v_rcp_f32 v157, v157
    v_rcp_f32 v160, v160
    v_rcp_f32 v161, v161
    v_rcp_f32 v164, v164
    v_rcp_f32 v165, v165
    v_pk_mul_f32 v[152:153], v[16:17], v[152:153]
    v_pk_mul_f32 v[156:157], v[18:19], v[156:157]
    v_pk_mul_f32 v[160:161], v[20:21], v[160:161]
    v_pk_mul_f32 v[164:165], v[22:23], v[164:165]
    v_pk_fma_f32 v[16:17], v[152:153], s[36:37], v[16:17]
    v_pk_fma_f32 v[18:19], v[156:157], s[36:37], v[18:19]
    v_pk_fma_f32 v[20:21], v[160:161], s[36:37], v[20:21]
    v_pk_fma_f32 v[22:23], v[164:165], s[36:37], v[22:23]
    v_pk_fma_f32 v[152:153], v[144:145], v[120:121], v[136:137] op_sel:[0,0,0] op_sel_hi:[0,1,1] neg_lo:[1,0,0] neg_hi:[1,0,0]
    v_pk_fma_f32 v[24:25], v[24:25], v[144:145], v[152:153] op_sel:[0,1,0] op_sel_hi:[1,1,1]
    v_pk_mul_f32 v[152:153], v[24:25], s[32:33]
    v_pk_fma_f32 v[156:157], v[144:145], v[122:123], v[138:139] op_sel:[0,0,0] op_sel_hi:[0,1,1] neg_lo:[1,0,0] neg_hi:[1,0,0]
    v_pk_fma_f32 v[26:27], v[26:27], v[144:145], v[156:157] op_sel:[0,1,0] op_sel_hi:[1,1,1]
    v_pk_mul_f32 v[156:157], v[26:27], s[32:33]
    v_pk_fma_f32 v[160:161], v[144:145], v[124:125], v[140:141] op_sel:[0,0,0] op_sel_hi:[0,1,1] neg_lo:[1,0,0] neg_hi:[1,0,0]
    v_pk_fma_f32 v[28:29], v[28:29], v[144:145], v[160:161] op_sel:[0,1,0] op_sel_hi:[1,1,1]
    v_pk_mul_f32 v[160:161], v[28:29], s[32:33]
    v_pk_fma_f32 v[164:165], v[144:145], v[126:127], v[142:143] op_sel:[0,0,0] op_sel_hi:[0,1,1] neg_lo:[1,0,0] neg_hi:[1,0,0]
    v_pk_fma_f32 v[30:31], v[30:31], v[144:145], v[164:165] op_sel:[0,1,0] op_sel_hi:[1,1,1]
    v_pk_mul_f32 v[164:165], v[30:31], s[32:33]
    v_exp_f32 v152, v152
    v_exp_f32 v153, v153
    v_exp_f32 v156, v156
    v_exp_f32 v157, v157
    v_exp_f32 v160, v160
    v_exp_f32 v161, v161
    v_exp_f32 v164, v164
    v_exp_f32 v165, v165
    v_pk_add_f32 v[154:155], v[152:153], s[34:35]
    v_pk_fma_f32 v[152:153], v[152:153], v[154:155], s[34:35]
    v_pk_add_f32 v[158:159], v[156:157], s[34:35]
    v_pk_fma_f32 v[156:157], v[156:157], v[158:159], s[34:35]
    v_pk_add_f32 v[162:163], v[160:161], s[34:35]
    v_pk_fma_f32 v[160:161], v[160:161], v[162:163], s[34:35]
    v_pk_add_f32 v[166:167], v[164:165], s[34:35]
    v_pk_fma_f32 v[164:165], v[164:165], v[166:167], s[34:35]
    v_rcp_f32 v152, v152
    v_rcp_f32 v153, v153
    v_rcp_f32 v156, v156
    v_rcp_f32 v157, v157
    v_rcp_f32 v160, v160
    v_rcp_f32 v161, v161
    v_rcp_f32 v164, v164
    v_rcp_f32 v165, v165
    v_pk_mul_f32 v[152:153], v[24:25], v[152:153]
    v_pk_mul_f32 v[156:157], v[26:27], v[156:157]
    v_pk_mul_f32 v[160:161], v[28:29], v[160:161]
    v_pk_mul_f32 v[164:165], v[30:31], v[164:165]
    v_pk_fma_f32 v[24:25], v[152:153], s[36:37], v[24:25]
    v_pk_fma_f32 v[26:27], v[156:157], s[36:37], v[26:27]
    v_pk_fma_f32 v[28:29], v[160:161], s[36:37], v[28:29]
    v_pk_fma_f32 v[30:31], v[164:165], s[36:37], v[30:31]
    v_cvt_pk_bf16_f32 v16, v16, v17
    v_cvt_pk_bf16_f32 v17, v18, v19
    v_cvt_pk_bf16_f32 v18, v20, v21
    v_cvt_pk_bf16_f32 v19, v22, v23
    v_cvt_pk_bf16_f32 v20, v24, v25
    v_cvt_pk_bf16_f32 v21, v26, v27
    v_cvt_pk_bf16_f32 v22, v28, v29
    v_cvt_pk_bf16_f32 v23, v30, v31
    buffer_store_dwordx4 v[16:19], v1, s[4:7], s30 offen sc1
    buffer_store_dwordx4 v[20:23], v1, s[4:7], s30 offen offset:1024 sc1
    s_add_u32 s30, s30, 114688
    s_waitcnt lgkmcnt(15)
    v_pk_fma_f32 v[152:153], v[146:147], v[112:113], v[128:129] op_sel:[0,0,0] op_sel_hi:[0,1,1] neg_lo:[1,0,0] neg_hi:[1,0,0]
    v_pk_fma_f32 v[32:33], v[32:33], v[146:147], v[152:153] op_sel:[0,1,0] op_sel_hi:[1,1,1]
    v_pk_mul_f32 v[152:153], v[32:33], s[32:33]
    v_pk_fma_f32 v[156:157], v[146:147], v[114:115], v[130:131] op_sel:[0,0,0] op_sel_hi:[0,1,1] neg_lo:[1,0,0] neg_hi:[1,0,0]
    v_pk_fma_f32 v[34:35], v[34:35], v[146:147], v[156:157] op_sel:[0,1,0] op_sel_hi:[1,1,1]
    v_pk_mul_f32 v[156:157], v[34:35], s[32:33]
    v_pk_fma_f32 v[160:161], v[146:147], v[116:117], v[132:133] op_sel:[0,0,0] op_sel_hi:[0,1,1] neg_lo:[1,0,0] neg_hi:[1,0,0]
    v_pk_fma_f32 v[36:37], v[36:37], v[146:147], v[160:161] op_sel:[0,1,0] op_sel_hi:[1,1,1]
    v_pk_mul_f32 v[160:161], v[36:37], s[32:33]
    v_pk_fma_f32 v[164:165], v[146:147], v[118:119], v[134:135] op_sel:[0,0,0] op_sel_hi:[0,1,1] neg_lo:[1,0,0] neg_hi:[1,0,0]
    v_pk_fma_f32 v[38:39], v[38:39], v[146:147], v[164:165] op_sel:[0,1,0] op_sel_hi:[1,1,1]
    v_pk_mul_f32 v[164:165], v[38:39], s[32:33]
    v_exp_f32 v152, v152
    v_exp_f32 v153, v153
    v_exp_f32 v156, v156
    v_exp_f32 v157, v157
    v_exp_f32 v160, v160
    v_exp_f32 v161, v161
    v_exp_f32 v164, v164
    v_exp_f32 v165, v165
    v_pk_add_f32 v[154:155], v[152:153], s[34:35]
    v_pk_fma_f32 v[152:153], v[152:153], v[154:155], s[34:35]
    v_pk_add_f32 v[158:159], v[156:157], s[34:35]
    v_pk_fma_f32 v[156:157], v[156:157], v[158:159], s[34:35]
    v_pk_add_f32 v[162:163], v[160:161], s[34:35]
    v_pk_fma_f32 v[160:161], v[160:161], v[162:163], s[34:35]
    v_pk_add_f32 v[166:167], v[164:165], s[34:35]
    v_pk_fma_f32 v[164:165], v[164:165], v[166:167], s[34:35]
    v_rcp_f32 v152, v152
    v_rcp_f32 v153, v153
    v_rcp_f32 v156, v156
    v_rcp_f32 v157, v157
    v_rcp_f32 v160, v160
    v_rcp_f32 v161, v161
    v_rcp_f32 v164, v164
    v_rcp_f32 v165, v165
    v_pk_mul_f32 v[152:153], v[32:33], v[152:153]
    v_pk_mul_f32 v[156:157], v[34:35], v[156:157]
    v_pk_mul_f32 v[160:161], v[36:37], v[160:161]
    v_pk_mul_f32 v[164:165], v[38:39], v[164:165]
    v_pk_fma_f32 v[32:33], v[152:153], s[36:37], v[32:33]
    v_pk_fma_f32 v[34:35], v[156:157], s[36:37], v[34:35]
    v_pk_fma_f32 v[36:37], v[160:161], s[36:37], v[36:37]
    v_pk_fma_f32 v[38:39], v[164:165], s[36:37], v[38:39]
    v_pk_fma_f32 v[152:153], v[146:147], v[120:121], v[136:137] op_sel:[0,0,0] op_sel_hi:[0,1,1] neg_lo:[1,0,0] neg_hi:[1,0,0]
    v_pk_fma_f32 v[40:41], v[40:41], v[146:147], v[152:153] op_sel:[0,1,0] op_sel_hi:[1,1,1]
    v_pk_mul_f32 v[152:153], v[40:41], s[32:33]
    v_pk_fma_f32 v[156:157], v[146:147], v[122:123], v[138:139] op_sel:[0,0,0] op_sel_hi:[0,1,1] neg_lo:[1,0,0] neg_hi:[1,0,0]
    v_pk_fma_f32 v[42:43], v[42:43], v[146:147], v[156:157] op_sel:[0,1,0] op_sel_hi:[1,1,1]
    v_pk_mul_f32 v[156:157], v[42:43], s[32:33]
    v_pk_fma_f32 v[160:161], v[146:147], v[124:125], v[140:141] op_sel:[0,0,0] op_sel_hi:[0,1,1] neg_lo:[1,0,0] neg_hi:[1,0,0]
    v_pk_fma_f32 v[44:45], v[44:45], v[146:147], v[160:161] op_sel:[0,1,0] op_sel_hi:[1,1,1]
    v_pk_mul_f32 v[160:161], v[44:45], s[32:33]
    v_pk_fma_f32 v[164:165], v[146:147], v[126:127], v[142:143] op_sel:[0,0,0] op_sel_hi:[0,1,1] neg_lo:[1,0,0] neg_hi:[1,0,0]
    v_pk_fma_f32 v[46:47], v[46:47], v[146:147], v[164:165] op_sel:[0,1,0] op_sel_hi:[1,1,1]
    v_pk_mul_f32 v[164:165], v[46:47], s[32:33]
    v_exp_f32 v152, v152
    v_exp_f32 v153, v153
    v_exp_f32 v156, v156
    v_exp_f32 v157, v157
    v_exp_f32 v160, v160
    v_exp_f32 v161, v161
    v_exp_f32 v164, v164
    v_exp_f32 v165, v165
    v_pk_add_f32 v[154:155], v[152:153], s[34:35]
    v_pk_fma_f32 v[152:153], v[152:153], v[154:155], s[34:35]
    v_pk_add_f32 v[158:159], v[156:157], s[34:35]
    v_pk_fma_f32 v[156:157], v[156:157], v[158:159], s[34:35]
    v_pk_add_f32 v[162:163], v[160:161], s[34:35]
    v_pk_fma_f32 v[160:161], v[160:161], v[162:163], s[34:35]
    v_pk_add_f32 v[166:167], v[164:165], s[34:35]
    v_pk_fma_f32 v[164:165], v[164:165], v[166:167], s[34:35]
    v_rcp_f32 v152, v152
    v_rcp_f32 v153, v153
    v_rcp_f32 v156, v156
    v_rcp_f32 v157, v157
    v_rcp_f32 v160, v160
    v_rcp_f32 v161, v161
    v_rcp_f32 v164, v164
    v_rcp_f32 v165, v165
    v_pk_mul_f32 v[152:153], v[40:41], v[152:153]
    v_pk_mul_f32 v[156:157], v[42:43], v[156:157]
    v_pk_mul_f32 v[160:161], v[44:45], v[160:161]
    v_pk_mul_f32 v[164:165], v[46:47], v[164:165]
    v_pk_fma_f32 v[40:41], v[152:153], s[36:37], v[40:41]
    v_pk_fma_f32 v[42:43], v[156:157], s[36:37], v[42:43]
    v_pk_fma_f32 v[44:45], v[160:161], s[36:37], v[44:45]
    v_pk_fma_f32 v[46:47], v[164:165], s[36:37], v[46:47]
    v_cvt_pk_bf16_f32 v32, v32, v33
    v_cvt_pk_bf16_f32 v33, v34, v35
    v_cvt_pk_bf16_f32 v34, v36, v37
    v_cvt_pk_bf16_f32 v35, v38, v39
    v_cvt_pk_bf16_f32 v36, v40, v41
    v_cvt_pk_bf16_f32 v37, v42, v43
    v_cvt_pk_bf16_f32 v38, v44, v45
    v_cvt_pk_bf16_f32 v39, v46, v47
    buffer_store_dwordx4 v[32:35], v1, s[4:7], s30 offen sc1
    buffer_store_dwordx4 v[36:39], v1, s[4:7], s30 offen offset:1024 sc1
    s_add_u32 s30, s30, 114688
    s_waitcnt lgkmcnt(15)
    v_pk_fma_f32 v[152:153], v[148:149], v[112:113], v[128:129] op_sel:[0,0,0] op_sel_hi:[0,1,1] neg_lo:[1,0,0] neg_hi:[1,0,0]
    v_pk_fma_f32 v[48:49], v[48:49], v[148:149], v[152:153] op_sel:[0,1,0] op_sel_hi:[1,1,1]
    v_pk_mul_f32 v[152:153], v[48:49], s[32:33]
    v_pk_fma_f32 v[156:157], v[148:149], v[114:115], v[130:131] op_sel:[0,0,0] op_sel_hi:[0,1,1] neg_lo:[1,0,0] neg_hi:[1,0,0]
    v_pk_fma_f32 v[50:51], v[50:51], v[148:149], v[156:157] op_sel:[0,1,0] op_sel_hi:[1,1,1]
    v_pk_mul_f32 v[156:157], v[50:51], s[32:33]
    v_pk_fma_f32 v[160:161], v[148:149], v[116:117], v[132:133] op_sel:[0,0,0] op_sel_hi:[0,1,1] neg_lo:[1,0,0] neg_hi:[1,0,0]
    v_pk_fma_f32 v[52:53], v[52:53], v[148:149], v[160:161] op_sel:[0,1,0] op_sel_hi:[1,1,1]
    v_pk_mul_f32 v[160:161], v[52:53], s[32:33]
    v_pk_fma_f32 v[164:165], v[148:149], v[118:119], v[134:135] op_sel:[0,0,0] op_sel_hi:[0,1,1] neg_lo:[1,0,0] neg_hi:[1,0,0]
    v_pk_fma_f32 v[54:55], v[54:55], v[148:149], v[164:165] op_sel:[0,1,0] op_sel_hi:[1,1,1]
    v_pk_mul_f32 v[164:165], v[54:55], s[32:33]
    v_exp_f32 v152, v152
    v_exp_f32 v153, v153
    v_exp_f32 v156, v156
    v_exp_f32 v157, v157
    v_exp_f32 v160, v160
    v_exp_f32 v161, v161
    v_exp_f32 v164, v164
    v_exp_f32 v165, v165
    v_pk_add_f32 v[154:155], v[152:153], s[34:35]
    v_pk_fma_f32 v[152:153], v[152:153], v[154:155], s[34:35]
    v_pk_add_f32 v[158:159], v[156:157], s[34:35]
    v_pk_fma_f32 v[156:157], v[156:157], v[158:159], s[34:35]
    v_pk_add_f32 v[162:163], v[160:161], s[34:35]
    v_pk_fma_f32 v[160:161], v[160:161], v[162:163], s[34:35]
    v_pk_add_f32 v[166:167], v[164:165], s[34:35]
    v_pk_fma_f32 v[164:165], v[164:165], v[166:167], s[34:35]
    v_rcp_f32 v152, v152
    v_rcp_f32 v153, v153
    v_rcp_f32 v156, v156
    v_rcp_f32 v157, v157
    v_rcp_f32 v160, v160
    v_rcp_f32 v161, v161
    v_rcp_f32 v164, v164
    v_rcp_f32 v165, v165
    v_pk_mul_f32 v[152:153], v[48:49], v[152:153]
    v_pk_mul_f32 v[156:157], v[50:51], v[156:157]
    v_pk_mul_f32 v[160:161], v[52:53], v[160:161]
    v_pk_mul_f32 v[164:165], v[54:55], v[164:165]
    v_pk_fma_f32 v[48:49], v[152:153], s[36:37], v[48:49]
    v_pk_fma_f32 v[50:51], v[156:157], s[36:37], v[50:51]
    v_pk_fma_f32 v[52:53], v[160:161], s[36:37], v[52:53]
    v_pk_fma_f32 v[54:55], v[164:165], s[36:37], v[54:55]
    v_pk_fma_f32 v[152:153], v[148:149], v[120:121], v[136:137] op_sel:[0,0,0] op_sel_hi:[0,1,1] neg_lo:[1,0,0] neg_hi:[1,0,0]
    v_pk_fma_f32 v[56:57], v[56:57], v[148:149], v[152:153] op_sel:[0,1,0] op_sel_hi:[1,1,1]
    v_pk_mul_f32 v[152:153], v[56:57], s[32:33]
    v_pk_fma_f32 v[156:157], v[148:149], v[122:123], v[138:139] op_sel:[0,0,0] op_sel_hi:[0,1,1] neg_lo:[1,0,0] neg_hi:[1,0,0]
    v_pk_fma_f32 v[58:59], v[58:59], v[148:149], v[156:157] op_sel:[0,1,0] op_sel_hi:[1,1,1]
    v_pk_mul_f32 v[156:157], v[58:59], s[32:33]
    v_pk_fma_f32 v[160:161], v[148:149], v[124:125], v[140:141] op_sel:[0,0,0] op_sel_hi:[0,1,1] neg_lo:[1,0,0] neg_hi:[1,0,0]
    v_pk_fma_f32 v[60:61], v[60:61], v[148:149], v[160:161] op_sel:[0,1,0] op_sel_hi:[1,1,1]
    v_pk_mul_f32 v[160:161], v[60:61], s[32:33]
    v_pk_fma_f32 v[164:165], v[148:149], v[126:127], v[142:143] op_sel:[0,0,0] op_sel_hi:[0,1,1] neg_lo:[1,0,0] neg_hi:[1,0,0]
    v_pk_fma_f32 v[62:63], v[62:63], v[148:149], v[164:165] op_sel:[0,1,0] op_sel_hi:[1,1,1]
    v_pk_mul_f32 v[164:165], v[62:63], s[32:33]
    v_exp_f32 v152, v152
    v_exp_f32 v153, v153
    v_exp_f32 v156, v156
    v_exp_f32 v157, v157
    v_exp_f32 v160, v160
    v_exp_f32 v161, v161
    v_exp_f32 v164, v164
    v_exp_f32 v165, v165
    v_pk_add_f32 v[154:155], v[152:153], s[34:35]
    v_pk_fma_f32 v[152:153], v[152:153], v[154:155], s[34:35]
    v_pk_add_f32 v[158:159], v[156:157], s[34:35]
    v_pk_fma_f32 v[156:157], v[156:157], v[158:159], s[34:35]
    v_pk_add_f32 v[162:163], v[160:161], s[34:35]
    v_pk_fma_f32 v[160:161], v[160:161], v[162:163], s[34:35]
    v_pk_add_f32 v[166:167], v[164:165], s[34:35]
    v_pk_fma_f32 v[164:165], v[164:165], v[166:167], s[34:35]
    v_rcp_f32 v152, v152
    v_rcp_f32 v153, v153
    v_rcp_f32 v156, v156
    v_rcp_f32 v157, v157
    v_rcp_f32 v160, v160
    v_rcp_f32 v161, v161
    v_rcp_f32 v164, v164
    v_rcp_f32 v165, v165
    v_pk_mul_f32 v[152:153], v[56:57], v[152:153]
    v_pk_mul_f32 v[156:157], v[58:59], v[156:157]
    v_pk_mul_f32 v[160:161], v[60:61], v[160:161]
    v_pk_mul_f32 v[164:165], v[62:63], v[164:165]
    v_pk_fma_f32 v[56:57], v[152:153], s[36:37], v[56:57]
    v_pk_fma_f32 v[58:59], v[156:157], s[36:37], v[58:59]
    v_pk_fma_f32 v[60:61], v[160:161], s[36:37], v[60:61]
    v_pk_fma_f32 v[62:63], v[164:165], s[36:37], v[62:63]
    v_cvt_pk_bf16_f32 v48, v48, v49
    v_cvt_pk_bf16_f32 v49, v50, v51
    v_cvt_pk_bf16_f32 v50, v52, v53
    v_cvt_pk_bf16_f32 v51, v54, v55
    v_cvt_pk_bf16_f32 v52, v56, v57
    v_cvt_pk_bf16_f32 v53, v58, v59
    v_cvt_pk_bf16_f32 v54, v60, v61
    v_cvt_pk_bf16_f32 v55, v62, v63
    buffer_store_dwordx4 v[48:51], v1, s[4:7], s30 offen sc1
    buffer_store_dwordx4 v[52:55], v1, s[4:7], s30 offen offset:1024 sc1
    s_add_u32 s30, s30, 114688
    s_waitcnt lgkmcnt(15)
    v_pk_fma_f32 v[152:153], v[150:151], v[112:113], v[128:129] op_sel:[0,0,0] op_sel_hi:[0,1,1] neg_lo:[1,0,0] neg_hi:[1,0,0]
    v_pk_fma_f32 v[64:65], v[64:65], v[150:151], v[152:153] op_sel:[0,1,0] op_sel_hi:[1,1,1]
    v_pk_mul_f32 v[152:153], v[64:65], s[32:33]
    v_pk_fma_f32 v[156:157], v[150:151], v[114:115], v[130:131] op_sel:[0,0,0] op_sel_hi:[0,1,1] neg_lo:[1,0,0] neg_hi:[1,0,0]
    v_pk_fma_f32 v[66:67], v[66:67], v[150:151], v[156:157] op_sel:[0,1,0] op_sel_hi:[1,1,1]
    v_pk_mul_f32 v[156:157], v[66:67], s[32:33]
    v_pk_fma_f32 v[160:161], v[150:151], v[116:117], v[132:133] op_sel:[0,0,0] op_sel_hi:[0,1,1] neg_lo:[1,0,0] neg_hi:[1,0,0]
    v_pk_fma_f32 v[68:69], v[68:69], v[150:151], v[160:161] op_sel:[0,1,0] op_sel_hi:[1,1,1]
    v_pk_mul_f32 v[160:161], v[68:69], s[32:33]
    v_pk_fma_f32 v[164:165], v[150:151], v[118:119], v[134:135] op_sel:[0,0,0] op_sel_hi:[0,1,1] neg_lo:[1,0,0] neg_hi:[1,0,0]
    v_pk_fma_f32 v[70:71], v[70:71], v[150:151], v[164:165] op_sel:[0,1,0] op_sel_hi:[1,1,1]
    v_pk_mul_f32 v[164:165], v[70:71], s[32:33]
    v_exp_f32 v152, v152
    v_exp_f32 v153, v153
    v_exp_f32 v156, v156
    v_exp_f32 v157, v157
    v_exp_f32 v160, v160
    v_exp_f32 v161, v161
    v_exp_f32 v164, v164
    v_exp_f32 v165, v165
    v_pk_add_f32 v[154:155], v[152:153], s[34:35]
    v_pk_fma_f32 v[152:153], v[152:153], v[154:155], s[34:35]
    v_pk_add_f32 v[158:159], v[156:157], s[34:35]
    v_pk_fma_f32 v[156:157], v[156:157], v[158:159], s[34:35]
    v_pk_add_f32 v[162:163], v[160:161], s[34:35]
    v_pk_fma_f32 v[160:161], v[160:161], v[162:163], s[34:35]
    v_pk_add_f32 v[166:167], v[164:165], s[34:35]
    v_pk_fma_f32 v[164:165], v[164:165], v[166:167], s[34:35]
    v_rcp_f32 v152, v152
    v_rcp_f32 v153, v153
    v_rcp_f32 v156, v156
    v_rcp_f32 v157, v157
    v_rcp_f32 v160, v160
    v_rcp_f32 v161, v161
    v_rcp_f32 v164, v164
    v_rcp_f32 v165, v165
    v_pk_mul_f32 v[152:153], v[64:65], v[152:153]
    v_pk_mul_f32 v[156:157], v[66:67], v[156:157]
    v_pk_mul_f32 v[160:161], v[68:69], v[160:161]
    v_pk_mul_f32 v[164:165], v[70:71], v[164:165]
    v_pk_fma_f32 v[64:65], v[152:153], s[36:37], v[64:65]
    v_pk_fma_f32 v[66:67], v[156:157], s[36:37], v[66:67]
    v_pk_fma_f32 v[68:69], v[160:161], s[36:37], v[68:69]
    v_pk_fma_f32 v[70:71], v[164:165], s[36:37], v[70:71]
    v_pk_fma_f32 v[152:153], v[150:151], v[120:121], v[136:137] op_sel:[0,0,0] op_sel_hi:[0,1,1] neg_lo:[1,0,0] neg_hi:[1,0,0]
    v_pk_fma_f32 v[72:73], v[72:73], v[150:151], v[152:153] op_sel:[0,1,0] op_sel_hi:[1,1,1]
    v_pk_mul_f32 v[152:153], v[72:73], s[32:33]
    v_pk_fma_f32 v[156:157], v[150:151], v[122:123], v[138:139] op_sel:[0,0,0] op_sel_hi:[0,1,1] neg_lo:[1,0,0] neg_hi:[1,0,0]
    v_pk_fma_f32 v[74:75], v[74:75], v[150:151], v[156:157] op_sel:[0,1,0] op_sel_hi:[1,1,1]
    v_pk_mul_f32 v[156:157], v[74:75], s[32:33]
    v_pk_fma_f32 v[160:161], v[150:151], v[124:125], v[140:141] op_sel:[0,0,0] op_sel_hi:[0,1,1] neg_lo:[1,0,0] neg_hi:[1,0,0]
    v_pk_fma_f32 v[76:77], v[76:77], v[150:151], v[160:161] op_sel:[0,1,0] op_sel_hi:[1,1,1]
    v_pk_mul_f32 v[160:161], v[76:77], s[32:33]
    v_pk_fma_f32 v[164:165], v[150:151], v[126:127], v[142:143] op_sel:[0,0,0] op_sel_hi:[0,1,1] neg_lo:[1,0,0] neg_hi:[1,0,0]
    v_pk_fma_f32 v[78:79], v[78:79], v[150:151], v[164:165] op_sel:[0,1,0] op_sel_hi:[1,1,1]
    v_pk_mul_f32 v[164:165], v[78:79], s[32:33]
    v_exp_f32 v152, v152
    v_exp_f32 v153, v153
    v_exp_f32 v156, v156
    v_exp_f32 v157, v157
    v_exp_f32 v160, v160
    v_exp_f32 v161, v161
    v_exp_f32 v164, v164
    v_exp_f32 v165, v165
    v_pk_add_f32 v[154:155], v[152:153], s[34:35]
    v_pk_fma_f32 v[152:153], v[152:153], v[154:155], s[34:35]
    v_pk_add_f32 v[158:159], v[156:157], s[34:35]
    v_pk_fma_f32 v[156:157], v[156:157], v[158:159], s[34:35]
    v_pk_add_f32 v[162:163], v[160:161], s[34:35]
    v_pk_fma_f32 v[160:161], v[160:161], v[162:163], s[34:35]
    v_pk_add_f32 v[166:167], v[164:165], s[34:35]
    v_pk_fma_f32 v[164:165], v[164:165], v[166:167], s[34:35]
    v_rcp_f32 v152, v152
    v_rcp_f32 v153, v153
    v_rcp_f32 v156, v156
    v_rcp_f32 v157, v157
    v_rcp_f32 v160, v160
    v_rcp_f32 v161, v161
    v_rcp_f32 v164, v164
    v_rcp_f32 v165, v165
    v_pk_mul_f32 v[152:153], v[72:73], v[152:153]
    v_pk_mul_f32 v[156:157], v[74:75], v[156:157]
    v_pk_mul_f32 v[160:161], v[76:77], v[160:161]
    v_pk_mul_f32 v[164:165], v[78:79], v[164:165]
    v_pk_fma_f32 v[72:73], v[152:153], s[36:37], v[72:73]
    v_pk_fma_f32 v[74:75], v[156:157], s[36:37], v[74:75]
    v_pk_fma_f32 v[76:77], v[160:161], s[36:37], v[76:77]
    v_pk_fma_f32 v[78:79], v[164:165], s[36:37], v[78:79]
    v_cvt_pk_bf16_f32 v64, v64, v65
    v_cvt_pk_bf16_f32 v65, v66, v67
    v_cvt_pk_bf16_f32 v66, v68, v69
    v_cvt_pk_bf16_f32 v67, v70, v71
    v_cvt_pk_bf16_f32 v68, v72, v73
    v_cvt_pk_bf16_f32 v69, v74, v75
    v_cvt_pk_bf16_f32 v70, v76, v77
    v_cvt_pk_bf16_f32 v71, v78, v79
    buffer_store_dwordx4 v[64:67], v1, s[4:7], s30 offen sc1
    buffer_store_dwordx4 v[68:71], v1, s[4:7], s30 offen offset:1024 sc1
    s_add_u32 s30, s30, 114688
    s_waitcnt vmcnt(0)
    s_barrier
    s_cmp_lg_u32 s3, 0
    s_cbranch_scc1 L_pub_10
    s_lshl_b32 s64, s60, 7
    s_lshl_b32 s65, s61, 5
    s_add_u32 s64, s64, s65
    s_lshl_b32 s65, s62, 2
    s_add_u32 s64, s64, s65
    s_add_u32 s64, s64, 28600320
    v_mov_b32 v2, 0
    v_mov_b32 v3, 1
    s_mov_b64 exec, 1
    buffer_store_dword v3, v2, s[4:7], s64 offen sc1
    s_mov_b64 exec, -1
L_pub_10:
    s_branch L_joinw1_4
L_skipw1_3:
    s_lshr_b32 s44, s62, 2
    s_lshl_b32 s44, s44, 1
    s_lshl_b32 s45, s60, 2
    s_add_u32 s44, s44, s45
    s_and_b32 s45, s62, 3
    s_lshl_b32 s46, s61, 2
    s_add_u32 s45, s45, s46
    s_lshl_b32 s45, s45, 1
    s_and_b32 s46, s3, 1
    s_mov_b32 s47, 16539648
    s_mov_b32 s48, 3932160
    s_cmp_lt_u32 s3, 2
    s_cselect_b32 s49, s44, s45
    s_cselect_b32 s47, s47, s48
    s_add_u32 s49, s49, s46
    s_mul_i32 s49, s49, 114688
    s_add_u32 s50, s47, s49
    s_add_u32 s51, s50, 4096
    s_lshl_b32 s52, s3, 13
    s_add_u32 s53, s52, 4096
    s_cmp_lt_u32 s3, 2
    s_cbranch_scc1 L_pre_11
    s_add_u32 m0, s52, 0
    s_nop 0
    buffer_load_dwordx4 v1, s[4:7], s50 offen offset:0 sc1 lds
    buffer_load_dwordx4 v1, s[4:7], s50 offen offset:1024 sc1 lds
    buffer_load_dwordx4 v1, s[4:7], s50 offen offset:2048 sc1 lds
    buffer_load_dwordx4 v1, s[4:7], s50 offen offset:3072 sc1 lds
    s_add_u32 m0, s53, 0
    s_nop 0
    buffer_load_dwordx4 v1, s[4:7], s51 offen offset:0 sc1 lds
    buffer_load_dwordx4 v1, s[4:7], s51 offen offset:1024 sc1 lds
    buffer_load_dwordx4 v1, s[4:7], s51 offen offset:2048 sc1 lds
    buffer_load_dwordx4 v1, s[4:7], s51 offen offset:3072 sc1 lds
    s_add_u32 s50, s50, 8192
    s_add_u32 s51, s51, 8192
    s_add_u32 m0, s52, 32768
    s_nop 0
    buffer_load_dwordx4 v1, s[4:7], s50 offen offset:0 sc1 lds
    buffer_load_dwordx4 v1, s[4:7], s50 offen offset:1024 sc1 lds
    buffer_load_dwordx4 v1, s[4:7], s50 offen offset:2048 sc1 lds
    buffer_load_dwordx4 v1, s[4:7], s50 offen offset:3072 sc1 lds
    s_add_u32 m0, s53, 32768
    s_nop 0
    buffer_load_dwordx4 v1, s[4:7], s51 offen offset:0 sc1 lds
    buffer_load_dwordx4 v1, s[4:7], s51 offen offset:1024 sc1 lds
    buffer_load_dwordx4 v1, s[4:7], s51 offen offset:2048 sc1 lds
    buffer_load_dwordx4 v1, s[4:7], s51 offen offset:3072 sc1 lds
    s_add_u32 s50, s50, 8192
    s_add_u32 s51, s51, 8192
    s_add_u32 m0, s52, 65536
    s_nop 0
    buffer_load_dwordx4 v1, s[4:7], s50 offen offset:0 sc1 lds
    buffer_load_dwordx4 v1, s[4:7], s50 offen offset:1024 sc1 lds
    buffer_load_dwordx4 v1, s[4:7], s50 offen offset:2048 sc1 lds
    buffer_load_dwordx4 v1, s[4:7], s50 offen offset:3072 sc1 lds
    s_add_u32 m0, s53, 65536
    s_nop 0
    buffer_load_dwordx4 v1, s[4:7], s51 offen offset:0 sc1 lds
    buffer_load_dwordx4 v1, s[4:7], s51 offen offset:1024 sc1 lds
    buffer_load_dwordx4 v1, s[4:7], s51 offen offset:2048 sc1 lds
    buffer_load_dwordx4 v1, s[4:7], s51 offen offset:3072 sc1 lds
    s_add_u32 s50, s50, 8192
    s_add_u32 s51, s51, 8192
L_pre_11:
L_joinw1_4:
    s_cmp_lg_u32 s3, 0
    s_cbranch_scc1 L_aw_12
    s_lshl_b32 s64, s60, 7
    s_add_u32 s64, s64, 28600320
    v_lshrrev_b32 v2, 2, v1
    v_and_b32 v2, 60, v2
    s_mov_b32 s66, 0x20000
L_poll_13:
    buffer_load_dword v3, v2, s[4:7], s64 offen sc1
    s_waitcnt vmcnt(0)
    v_cmp_eq_u32 vcc, 1, v3
    s_nop 3
    s_and_b32 s65, vcc_lo, 0x7f7f
    s_cmp_eq_u32 s65, 0x7f7f
    s_cbranch_scc1 L_done_14
    s_sub_u32 s66, s66, 1
    s_cmp_lg_u32 s66, 0
    s_cbranch_scc1 L_poll_13
L_done_14:
    s_waitcnt vmcnt(0)
L_aw_12:
    s_barrier
    s_cmp_ge_u32 s3, 2
    s_cbranch_scc1 L_pre_15
    s_add_u32 m0, s52, 0
    s_nop 0
    buffer_load_dwordx4 v1, s[4:7], s50 offen offset:0 sc1 lds
    buffer_load_dwordx4 v1, s[4:7], s50 offen offset:1024 sc1 lds
    buffer_load_dwordx4 v1, s[4:7], s50 offen offset:2048 sc1 lds
    buffer_load_dwordx4 v1, s[4:7], s50 offen offset:3072 sc1 lds
    s_add_u32 m0, s53, 0
    s_nop 0
    buffer_load_dwordx4 v1, s[4:7], s51 offen offset:0 sc1 lds
    buffer_load_dwordx4 v1, s[4:7], s51 offen offset:1024 sc1 lds
    buffer_load_dwordx4 v1, s[4:7], s51 offen offset:2048 sc1 lds
    buffer_load_dwordx4 v1, s[4:7], s51 offen offset:3072 sc1 lds
    s_add_u32 s50, s50, 8192
    s_add_u32 s51, s51, 8192
    s_add_u32 m0, s52, 32768
    s_nop 0
    buffer_load_dwordx4 v1, s[4:7], s50 offen offset:0 sc1 lds
    buffer_load_dwordx4 v1, s[4:7], s50 offen offset:1024 sc1 lds
    buffer_load_dwordx4 v1, s[4:7], s50 offen offset:2048 sc1 lds
    buffer_load_dwordx4 v1, s[4:7], s50 offen offset:3072 sc1 lds
    s_add_u32 m0, s53, 32768
    s_nop 0
    buffer_load_dwordx4 v1, s[4:7], s51 offen offset:0 sc1 lds
    buffer_load_dwordx4 v1, s[4:7], s51 offen offset:1024 sc1 lds
    buffer_load_dwordx4 v1, s[4:7], s51 offen offset:2048 sc1 lds
    buffer_load_dwordx4 v1, s[4:7], s51 offen offset:3072 sc1 lds
    s_add_u32 s50, s50, 8192
    s_add_u32 s51, s51, 8192
    s_add_u32 m0, s52, 65536
    s_nop 0
    buffer_load_dwordx4 v1, s[4:7], s50 offen offset:0 sc1 lds
    buffer_load_dwordx4 v1, s[4:7], s50 offen offset:1024 sc1 lds
    buffer_load_dwordx4 v1, s[4:7], s50 offen offset:2048 sc1 lds
    buffer_load_dwordx4 v1, s[4:7], s50 offen offset:3072 sc1 lds
    s_add_u32 m0, s53, 65536
    s_nop 0
    buffer_load_dwordx4 v1, s[4:7], s51 offen offset:0 sc1 lds
    buffer_load_dwordx4 v1, s[4:7], s51 offen offset:1024 sc1 lds
    buffer_load_dwordx4 v1, s[4:7], s51 offen offset:2048 sc1 lds
    buffer_load_dwordx4 v1, s[4:7], s51 offen offset:3072 sc1 lds
    s_add_u32 s50, s50, 8192
    s_add_u32 s51, s51, 8192
L_pre_15:
    s_mul_i32 s70, s61, 6
    s_add_u32 s70, s70, s62
    s_lshl_b32 s70, s70, 2
    s_add_u32 s70, s70, s3
    s_lshl_b32 s70, s70, 15
    s_add_u32 s70, s70, 0
    s_lshr_b32 s16, s3, 1
    s_and_b32 s17, s3, 1
    s_add_u32 s18, s16, s44
    s_add_u32 s19, s17, s45
    s_lshl_b32 s20, s18, 5
    s_lshl_b32 s21, s19, 1
    s_add_u32 s20, s20, s21
    s_lshl_b32 s20, s20, 10
    s_lshl_b32 s26, s16, 13
    v_add_u32 v10, s26, v1
    s_lshl_b32 s26, s17, 13
    s_add_u32 s26, s26, 16384
    v_add_u32 v11, s26, v1
    v_add_u32 v12, 0x10000, v10
    v_add_u32 v13, 0x10000, v11
    s_waitcnt vmcnt(16)
    s_barrier
    s_add_u32 m0, s52, 98304
    s_nop 0
    buffer_load_dwordx4 v1, s[4:7], s50 offen offset:0 sc1 lds
    buffer_load_dwordx4 v1, s[4:7], s50 offen offset:1024 sc1 lds
    buffer_load_dwordx4 v1, s[4:7], s50 offen offset:2048 sc1 lds
    buffer_load_dwordx4 v1, s[4:7], s50 offen offset:3072 sc1 lds
    s_add_u32 m0, s53, 98304
    s_nop 0
    buffer_load_dwordx4 v1, s[4:7], s51 offen offset:0 sc1 lds
    buffer_load_dwordx4 v1, s[4:7], s51 offen offset:1024 sc1 lds
    buffer_load_dwordx4 v1, s[4:7], s51 offen offset:2048 sc1 lds
    buffer_load_dwordx4 v1, s[4:7], s51 offen offset:3072 sc1 lds
    s_add_u32 s50, s50, 8192
    s_add_u32 s51, s51, 8192
    ds_read_b128 v[32:35], v10 offset:0
    ds_read_b128 v[36:39], v11 offset:0
    ds_read_b128 v[40:43], v10 offset:1024
    ds_read_b128 v[44:47], v11 offset:1024
    ds_read_b128 v[48:51], v10 offset:2048
    ds_read_b128 v[52:55], v11 offset:2048
    s_waitcnt lgkmcnt(4)
    v_mfma_f32_32x32x16_bf16 v[16:31], v[36:39], v[32:35], 0
    ds_read_b128 v[32:35], v10 offset:3072
    ds_read_b128 v[36:39], v11 offset:3072
    s_waitcnt lgkmcnt(4)
    v_mfma_f32_32x32x16_bf16 v[16:31], v[44:47], v[40:43], v[16:31]
    ds_read_b128 v[40:43], v10 offset:4096
    ds_read_b128 v[44:47], v11 offset:4096
    s_waitcnt lgkmcnt(4)
    v_mfma_f32_32x32x16_bf16 v[16:31], v[52:55], v[48:51], v[16:31]
    ds_read_b128 v[48:51], v10 offset:5120
    ds_read_b128 v[52:55], v11 offset:5120
    s_waitcnt lgkmcnt(4)
    v_mfma_f32_32x32x16_bf16 v[16:31], v[36:39], v[32:35], v[16:31]
    ds_read_b128 v[32:35], v10 offset:6144
    ds_read_b128 v[36:39], v11 offset:6144
    s_waitcnt lgkmcnt(4)
    v_mfma_f32_32x32x16_bf16 v[16:31], v[44:47], v[40:43], v[16:31]
    ds_read_b128 v[40:43], v10 offset:7168
    ds_read_b128 v[44:47], v11 offset:7168
    s_waitcnt lgkmcnt(4)
    v_mfma_f32_32x32x16_bf16 v[16:31], v[52:55], v[48:51], v[16:31]
    s_waitcnt lgkmcnt(2)
    v_mfma_f32_32x32x16_bf16 v[16:31], v[36:39], v[32:35], v[16:31]
    s_waitcnt lgkmcnt(0)
    v_mfma_f32_32x32x16_bf16 v[16:31], v[44:47], v[40:43], v[16:31]
    s_waitcnt vmcnt(16)
    s_barrier
    s_add_u32 m0, s52, 0
    s_nop 0
    buffer_load_dwordx4 v1, s[4:7], s50 offen offset:0 sc1 lds
    buffer_load_dwordx4 v1, s[4:7], s50 offen offset:1024 sc1 lds
    buffer_load_dwordx4 v1, s[4:7], s50 offen offset:2048 sc1 lds
    buffer_load_dwordx4 v1, s[4:7], s50 offen offset:3072 sc1 lds
    s_add_u32 m0, s53, 0
    s_nop 0
    buffer_load_dwordx4 v1, s[4:7], s51 offen offset:0 sc1 lds
    buffer_load_dwordx4 v1, s[4:7], s51 offen offset:1024 sc1 lds
    buffer_load_dwordx4 v1, s[4:7], s51 offen offset:2048 sc1 lds
    buffer_load_dwordx4 v1, s[4:7], s51 offen offset:3072 sc1 lds
    s_add_u32 s50, s50, 8192
    s_add_u32 s51, s51, 8192
    ds_read_b128 v[32:35], v10 offset:32768
    ds_read_b128 v[36:39], v11 offset:32768
    ds_read_b128 v[40:43], v10 offset:33792
    ds_read_b128 v[44:47], v11 offset:33792
    ds_read_b128 v[48:51], v10 offset:34816
    ds_read_b128 v[52:55], v11 offset:34816
    s_waitcnt lgkmcnt(4)
    v_mfma_f32_32x32x16_bf16 v[16:31], v[36:39], v[32:35], v[16:31]
    ds_read_b128 v[32:35], v10 offset:35840
    ds_read_b128 v[36:39], v11 offset:35840
    s_waitcnt lgkmcnt(4)
    v_mfma_f32_32x32x16_bf16 v[16:31], v[44:47], v[40:43], v[16:31]
    ds_read_b128 v[40:43], v10 offset:36864
    ds_read_b128 v[44:47], v11 offset:36864
    s_waitcnt lgkmcnt(4)
    v_mfma_f32_32x32x16_bf16 v[16:31], v[52:55], v[48:51], v[16:31]
    ds_read_b128 v[48:51], v10 offset:37888
    ds_read_b128 v[52:55], v11 offset:37888
    s_waitcnt lgkmcnt(4)
    v_mfma_f32_32x32x16_bf16 v[16:31], v[36:39], v[32:35], v[16:31]
    ds_read_b128 v[32:35], v10 offset:38912
    ds_read_b128 v[36:39], v11 offset:38912
    s_waitcnt lgkmcnt(4)
    v_mfma_f32_32x32x16_bf16 v[16:31], v[44:47], v[40:43], v[16:31]
    ds_read_b128 v[40:43], v10 offset:39936
    ds_read_b128 v[44:47], v11 offset:39936
    s_waitcnt lgkmcnt(4)
    v_mfma_f32_32x32x16_bf16 v[16:31], v[52:55], v[48:51], v[16:31]
    s_waitcnt lgkmcnt(2)
    v_mfma_f32_32x32x16_bf16 v[16:31], v[36:39], v[32:35], v[16:31]
    s_waitcnt lgkmcnt(0)
    v_mfma_f32_32x32x16_bf16 v[16:31], v[44:47], v[40:43], v[16:31]
    s_waitcnt vmcnt(16)
    s_barrier
    s_add_u32 m0, s52, 32768
    s_nop 0
    buffer_load_dwordx4 v1, s[4:7], s50 offen offset:0 sc1 lds
    buffer_load_dwordx4 v1, s[4:7], s50 offen offset:1024 sc1 lds
    buffer_load_dwordx4 v1, s[4:7], s50 offen offset:2048 sc1 lds
    buffer_load_dwordx4 v1, s[4:7], s50 offen offset:3072 sc1 lds
    s_add_u32 m0, s53, 32768
    s_nop 0
    buffer_load_dwordx4 v1, s[4:7], s51 offen offset:0 sc1 lds
    buffer_load_dwordx4 v1, s[4:7], s51 offen offset:1024 sc1 lds
    buffer_load_dwordx4 v1, s[4:7], s51 offen offset:2048 sc1 lds
    buffer_load_dwordx4 v1, s[4:7], s51 offen offset:3072 sc1 lds
    s_add_u32 s50, s50, 8192
    s_add_u32 s51, s51, 8192
    ds_read_b128 v[32:35], v12 offset:0
    ds_read_b128 v[36:39], v13 offset:0
    ds_read_b128 v[40:43], v12 offset:1024
    ds_read_b128 v[44:47], v13 offset:1024
    ds_read_b128 v[48:51], v12 offset:2048
    ds_read_b128 v[52:55], v13 offset:2048
    s_waitcnt lgkmcnt(4)
    v_mfma_f32_32x32x16_bf16 v[16:31], v[36:39], v[32:35], v[16:31]
    ds_read_b128 v[32:35], v12 offset:3072
    ds_read_b128 v[36:39], v13 offset:3072
    s_waitcnt lgkmcnt(4)
    v_mfma_f32_32x32x16_bf16 v[16:31], v[44:47], v[40:43], v[16:31]
    ds_read_b128 v[40:43], v12 offset:4096
    ds_read_b128 v[44:47], v13 offset:4096
    s_waitcnt lgkmcnt(4)
    v_mfma_f32_32x32x16_bf16 v[16:31], v[52:55], v[48:51], v[16:31]
    ds_read_b128 v[48:51], v12 offset:5120
    ds_read_b128 v[52:55], v13 offset:5120
    s_waitcnt lgkmcnt(4)
    v_mfma_f32_32x32x16_bf16 v[16:31], v[36:39], v[32:35], v[16:31]
    ds_read_b128 v[32:35], v12 offset:6144
    ds_read_b128 v[36:39], v13 offset:6144
    s_waitcnt lgkmcnt(4)
    v_mfma_f32_32x32x16_bf16 v[16:31], v[44:47], v[40:43], v[16:31]
    ds_read_b128 v[40:43], v12 offset:7168
    ds_read_b128 v[44:47], v13 offset:7168
    s_waitcnt lgkmcnt(4)
    v_mfma_f32_32x32x16_bf16 v[16:31], v[52:55], v[48:51], v[16:31]
    s_waitcnt lgkmcnt(2)
    v_mfma_f32_32x32x16_bf16 v[16:31], v[36:39], v[32:35], v[16:31]
    s_waitcnt lgkmcnt(0)
    v_mfma_f32_32x32x16_bf16 v[16:31], v[44:47], v[40:43], v[16:31]
    s_waitcnt vmcnt(16)
    s_barrier
    s_add_u32 m0, s52, 65536
    s_nop 0
    buffer_load_dwordx4 v1, s[4:7], s50 offen offset:0 sc1 lds
    buffer_load_dwordx4 v1, s[4:7], s50 offen offset:1024 sc1 lds
    buffer_load_dwordx4 v1, s[4:7], s50 offen offset:2048 sc1 lds
    buffer_load_dwordx4 v1, s[4:7], s50 offen offset:3072 sc1 lds
    s_add_u32 m0, s53, 65536
    s_nop 0
    buffer_load_dwordx4 v1, s[4:7], s51 offen offset:0 sc1 lds
    buffer_load_dwordx4 v1, s[4:7], s51 offen offset:1024 sc1 lds
    buffer_load_dwordx4 v1, s[4:7], s51 offen offset:2048 sc1 lds
    buffer_load_dwordx4 v1, s[4:7], s51 offen offset:3072 sc1 lds
    s_add_u32 s50, s50, 8192
    s_add_u32 s51, s51, 8192
    ds_read_b128 v[32:35], v12 offset:32768
    ds_read_b128 v[36:39], v13 offset:32768
    ds_read_b128 v[40:43], v12 offset:33792
    ds_read_b128 v[44:47], v13 offset:33792
    ds_read_b128 v[48:51], v12 offset:34816
    ds_read_b128 v[52:55], v13 offset:34816
    s_waitcnt lgkmcnt(4)
    v_mfma_f32_32x32x16_bf16 v[16:31], v[36:39], v[32:35], v[16:31]
    ds_read_b128 v[32:35], v12 offset:35840
    ds_read_b128 v[36:39], v13 offset:35840
    s_waitcnt lgkmcnt(4)
    v_mfma_f32_32x32x16_bf16 v[16:31], v[44:47], v[40:43], v[16:31]
    ds_read_b128 v[40:43], v12 offset:36864
    ds_read_b128 v[44:47], v13 offset:36864
    s_waitcnt lgkmcnt(4)
    v_mfma_f32_32x32x16_bf16 v[16:31], v[52:55], v[48:51], v[16:31]
    ds_read_b128 v[48:51], v12 offset:37888
    ds_read_b128 v[52:55], v13 offset:37888
    s_waitcnt lgkmcnt(4)
    v_mfma_f32_32x32x16_bf16 v[16:31], v[36:39], v[32:35], v[16:31]
    ds_read_b128 v[32:35], v12 offset:38912
    ds_read_b128 v[36:39], v13 offset:38912
    s_waitcnt lgkmcnt(4)
    v_mfma_f32_32x32x16_bf16 v[16:31], v[44:47], v[40:43], v[16:31]
    ds_read_b128 v[40:43], v12 offset:39936
    ds_read_b128 v[44:47], v13 offset:39936
    s_waitcnt lgkmcnt(4)
    v_mfma_f32_32x32x16_bf16 v[16:31], v[52:55], v[48:51], v[16:31]
    s_waitcnt lgkmcnt(2)
    v_mfma_f32_32x32x16_bf16 v[16:31], v[36:39], v[32:35], v[16:31]
    s_waitcnt lgkmcnt(0)
    v_mfma_f32_32x32x16_bf16 v[16:31], v[44:47], v[40:43], v[16:31]
    s_waitcnt vmcnt(16)
    s_barrier
    s_add_u32 m0, s52, 98304
    s_nop 0
    buffer_load_dwordx4 v1, s[4:7], s50 offen offset:0 sc1 lds
    buffer_load_dwordx4 v1, s[4:7], s50 offen offset:1024 sc1 lds
    buffer_load_dwordx4 v1, s[4:7], s50 offen offset:2048 sc1 lds
    buffer_load_dwordx4 v1, s[4:7], s50 offen offset:3072 sc1 lds
    s_add_u32 m0, s53, 98304
    s_nop 0
    buffer_load_dwordx4 v1, s[4:7], s51 offen offset:0 sc1 lds
    buffer_load_dwordx4 v1, s[4:7], s51 offen offset:1024 sc1 lds
    buffer_load_dwordx4 v1, s[4:7], s51 offen offset:2048 sc1 lds
    buffer_load_dwordx4 v1, s[4:7], s51 offen offset:3072 sc1 lds
    s_add_u32 s50, s50, 8192
    s_add_u32 s51, s51, 8192
    ds_read_b128 v[32:35], v10 offset:0
    ds_read_b128 v[36:39], v11 offset:0
    ds_read_b128 v[40:43], v10 offset:1024
    ds_read_b128 v[44:47], v11 offset:1024
    ds_read_b128 v[48:51], v10 offset:2048
    ds_read_b128 v[52:55], v11 offset:2048
    s_waitcnt lgkmcnt(4)
    v_mfma_f32_32x32x16_bf16 v[16:31], v[36:39], v[32:35], v[16:31]
    ds_read_b128 v[32:35], v10 offset:3072
    ds_read_b128 v[36:39], v11 offset:3072
    s_waitcnt lgkmcnt(4)
    v_mfma_f32_32x32x16_bf16 v[16:31], v[44:47], v[40:43], v[16:31]
    ds_read_b128 v[40:43], v10 offset:4096
    ds_read_b128 v[44:47], v11 offset:4096
    s_waitcnt lgkmcnt(4)
    v_mfma_f32_32x32x16_bf16 v[16:31], v[52:55], v[48:51], v[16:31]
    ds_read_b128 v[48:51], v10 offset:5120
    ds_read_b128 v[52:55], v11 offset:5120
    s_waitcnt lgkmcnt(4)
    v_mfma_f32_32x32x16_bf16 v[16:31], v[36:39], v[32:35], v[16:31]
    ds_read_b128 v[32:35], v10 offset:6144
    ds_read_b128 v[36:39], v11 offset:6144
    s_waitcnt lgkmcnt(4)
    v_mfma_f32_32x32x16_bf16 v[16:31], v[44:47], v[40:43], v[16:31]
    ds_read_b128 v[40:43], v10 offset:7168
    ds_read_b128 v[44:47], v11 offset:7168
    s_waitcnt lgkmcnt(4)
    v_mfma_f32_32x32x16_bf16 v[16:31], v[52:55], v[48:51], v[16:31]
    s_waitcnt lgkmcnt(2)
    v_mfma_f32_32x32x16_bf16 v[16:31], v[36:39], v[32:35], v[16:31]
    s_waitcnt lgkmcnt(0)
    v_mfma_f32_32x32x16_bf16 v[16:31], v[44:47], v[40:43], v[16:31]
    s_waitcnt vmcnt(16)
    s_barrier
    s_add_u32 m0, s52, 0
    s_nop 0
    buffer_load_dwordx4 v1, s[4:7], s50 offen offset:0 sc1 lds
    buffer_load_dwordx4 v1, s[4:7], s50 offen offset:1024 sc1 lds
    buffer_load_dwordx4 v1, s[4:7], s50 offen offset:2048 sc1 lds
    buffer_load_dwordx4 v1, s[4:7], s50 offen offset:3072 sc1 lds
    s_add_u32 m0, s53, 0
    s_nop 0
    buffer_load_dwordx4 v1, s[4:7], s51 offen offset:0 sc1 lds
    buffer_load_dwordx4 v1, s[4:7], s51 offen offset:1024 sc1 lds
    buffer_load_dwordx4 v1, s[4:7], s51 offen offset:2048 sc1 lds
    buffer_load_dwordx4 v1, s[4:7], s51 offen offset:3072 sc1 lds
    s_add_u32 s50, s50, 8192
    s_add_u32 s51, s51, 8192
    ds_read_b128 v[32:35], v10 offset:32768
    ds_read_b128 v[36:39], v11 offset:32768
    ds_read_b128 v[40:43], v10 offset:33792
    ds_read_b128 v[44:47], v11 offset:33792
    ds_read_b128 v[48:51], v10 offset:34816
    ds_read_b128 v[52:55], v11 offset:34816
    s_waitcnt lgkmcnt(4)
    v_mfma_f32_32x32x16_bf16 v[16:31], v[36:39], v[32:35], v[16:31]
    ds_read_b128 v[32:35], v10 offset:35840
    ds_read_b128 v[36:39], v11 offset:35840
    s_waitcnt lgkmcnt(4)
    v_mfma_f32_32x32x16_bf16 v[16:31], v[44:47], v[40:43], v[16:31]
    ds_read_b128 v[40:43], v10 offset:36864
    ds_read_b128 v[44:47], v11 offset:36864
    s_waitcnt lgkmcnt(4)
    v_mfma_f32_32x32x16_bf16 v[16:31], v[52:55], v[48:51], v[16:31]
    ds_read_b128 v[48:51], v10 offset:37888
    ds_read_b128 v[52:55], v11 offset:37888
    s_waitcnt lgkmcnt(4)
    v_mfma_f32_32x32x16_bf16 v[16:31], v[36:39], v[32:35], v[16:31]
    ds_read_b128 v[32:35], v10 offset:38912
    ds_read_b128 v[36:39], v11 offset:38912
    s_waitcnt lgkmcnt(4)
    v_mfma_f32_32x32x16_bf16 v[16:31], v[44:47], v[40:43], v[16:31]
    ds_read_b128 v[40:43], v10 offset:39936
    ds_read_b128 v[44:47], v11 offset:39936
    s_waitcnt lgkmcnt(4)
    v_mfma_f32_32x32x16_bf16 v[16:31], v[52:55], v[48:51], v[16:31]
    s_waitcnt lgkmcnt(2)
    v_mfma_f32_32x32x16_bf16 v[16:31], v[36:39], v[32:35], v[16:31]
    s_waitcnt lgkmcnt(0)
    v_mfma_f32_32x32x16_bf16 v[16:31], v[44:47], v[40:43], v[16:31]
    s_waitcnt vmcnt(16)
    s_barrier
    s_add_u32 m0, s52, 32768
    s_nop 0
    buffer_load_dwordx4 v1, s[4:7], s50 offen offset:0 sc1 lds
    buffer_load_dwordx4 v1, s[4:7], s50 offen offset:1024 sc1 lds
    buffer_load_dwordx4 v1, s[4:7], s50 offen offset:2048 sc1 lds
    buffer_load_dwordx4 v1, s[4:7], s50 offen offset:3072 sc1 lds
    s_add_u32 m0, s53, 32768
    s_nop 0
    buffer_load_dwordx4 v1, s[4:7], s51 offen offset:0 sc1 lds
    buffer_load_dwordx4 v1, s[4:7], s51 offen offset:1024 sc1 lds
    buffer_load_dwordx4 v1, s[4:7], s51 offen offset:2048 sc1 lds
    buffer_load_dwordx4 v1, s[4:7], s51 offen offset:3072 sc1 lds
    s_add_u32 s50, s50, 8192
    s_add_u32 s51, s51, 8192
    ds_read_b128 v[32:35], v12 offset:0
    ds_read_b128 v[36:39], v13 offset:0
    ds_read_b128 v[40:43], v12 offset:1024
    ds_read_b128 v[44:47], v13 offset:1024
    ds_read_b128 v[48:51], v12 offset:2048
    ds_read_b128 v[52:55], v13 offset:2048
    s_waitcnt lgkmcnt(4)
    v_mfma_f32_32x32x16_bf16 v[16:31], v[36:39], v[32:35], v[16:31]
    buffer_load_dwordx4 a[0:3], v1, s[4:7], s70 offen offset:0
    ds_read_b128 v[32:35], v12 offset:3072
    ds_read_b128 v[36:39], v13 offset:3072
    s_waitcnt lgkmcnt(4)
    v_mfma_f32_32x32x16_bf16 v[16:31], v[44:47], v[40:43], v[16:31]
    buffer_load_dwordx4 a[4:7], v1, s[4:7], s70 offen offset:1024
    ds_read_b128 v[40:43], v12 offset:4096
    ds_read_b128 v[44:47], v13 offset:4096
    s_waitcnt lgkmcnt(4)
    v_mfma_f32_32x32x16_bf16 v[16:31], v[52:55], v[48:51], v[16:31]
    buffer_load_dwordx4 a[8:11], v1, s[4:7], s70 offen offset:2048
    ds_read_b128 v[48:51], v12 offset:5120
    ds_read_b128 v[52:55], v13 offset:5120
    s_waitcnt lgkmcnt(4)
    v_mfma_f32_32x32x16_bf16 v[16:31], v[36:39], v[32:35], v[16:31]
    buffer_load_dwordx4 a[12:15], v1, s[4:7], s70 offen offset:3072
    ds_read_b128 v[32:35], v12 offset:6144
    ds_read_b128 v[36:39], v13 offset:6144
    s_waitcnt lgkmcnt(4)
    v_mfma_f32_32x32x16_bf16 v[16:31], v[44:47], v[40:43], v[16:31]
    s_add_u32 s70, s70, 4096
    ds_read_b128 v[40:43], v12 offset:7168
    ds_read_b128 v[44:47], v13 offset:7168
    s_waitcnt lgkmcnt(4)
    v_mfma_f32_32x32x16_bf16 v[16:31], v[52:55], v[48:51], v[16:31]
    s_waitcnt lgkmcnt(2)
    v_mfma_f32_32x32x16_bf16 v[16:31], v[36:39], v[32:35], v[16:31]
    s_waitcnt lgkmcnt(0)
    v_mfma_f32_32x32x16_bf16 v[16:31], v[44:47], v[40:43], v[16:31]
    s_waitcnt vmcnt(20)
    s_barrier
    s_add_u32 m0, s52, 65536
    s_nop 0
    buffer_load_dwordx4 v1, s[4:7], s50 offen offset:0 sc1 lds
    buffer_load_dwordx4 v1, s[4:7], s50 offen offset:1024 sc1 lds
    buffer_load_dwordx4 v1, s[4:7], s50 offen offset:2048 sc1 lds
    buffer_load_dwordx4 v1, s[4:7], s50 offen offset:3072 sc1 lds
    s_add_u32 m0, s53, 65536
    s_nop 0
    buffer_load_dwordx4 v1, s[4:7], s51 offen offset:0 sc1 lds
    buffer_load_dwordx4 v1, s[4:7], s51 offen offset:1024 sc1 lds
    buffer_load_dwordx4 v1, s[4:7], s51 offen offset:2048 sc1 lds
    buffer_load_dwordx4 v1, s[4:7], s51 offen offset:3072 sc1 lds
    s_add_u32 s50, s50, 8192
    s_add_u32 s51, s51, 8192
    ds_read_b128 v[32:35], v12 offset:32768
    ds_read_b128 v[36:39], v13 offset:32768
    ds_read_b128 v[40:43], v12 offset:33792
    ds_read_b128 v[44:47], v13 offset:33792
    ds_read_b128 v[48:51], v12 offset:34816
    ds_read_b128 v[52:55], v13 offset:34816
    s_waitcnt lgkmcnt(4)
    v_mfma_f32_32x32x16_bf16 v[16:31], v[36:39], v[32:35], v[16:31]
    buffer_load_dwordx4 a[16:19], v1, s[4:7], s70 offen offset:0
    ds_read_b128 v[32:35], v12 offset:35840
    ds_read_b128 v[36:39], v13 offset:35840
    s_waitcnt lgkmcnt(4)
    v_mfma_f32_32x32x16_bf16 v[16:31], v[44:47], v[40:43], v[16:31]
    buffer_load_dwordx4 a[20:23], v1, s[4:7], s70 offen offset:1024
    ds_read_b128 v[40:43], v12 offset:36864
    ds_read_b128 v[44:47], v13 offset:36864
    s_waitcnt lgkmcnt(4)
    v_mfma_f32_32x32x16_bf16 v[16:31], v[52:55], v[48:51], v[16:31]
    buffer_load_dwordx4 a[24:27], v1, s[4:7], s70 offen offset:2048
    ds_read_b128 v[48:51], v12 offset:37888
    ds_read_b128 v[52:55], v13 offset:37888
    s_waitcnt lgkmcnt(4)
    v_mfma_f32_32x32x16_bf16 v[16:31], v[36:39], v[32:35], v[16:31]
    buffer_load_dwordx4 a[28:31], v1, s[4:7], s70 offen offset:3072
    ds_read_b128 v[32:35], v12 offset:38912
    ds_read_b128 v[36:39], v13 offset:38912
    s_waitcnt lgkmcnt(4)
    v_mfma_f32_32x32x16_bf16 v[16:31], v[44:47], v[40:43], v[16:31]
    s_add_u32 s70, s70, 4096
    ds_read_b128 v[40:43], v12 offset:39936
    ds_read_b128 v[44:47], v13 offset:39936
    s_waitcnt lgkmcnt(4)
    v_mfma_f32_32x32x16_bf16 v[16:31], v[52:55], v[48:51], v[16:31]
    s_waitcnt lgkmcnt(2)
    v_mfma_f32_32x32x16_bf16 v[16:31], v[36:39], v[32:35], v[16:31]
    s_waitcnt lgkmcnt(0)
    v_mfma_f32_32x32x16_bf16 v[16:31], v[44:47], v[40:43], v[16:31]
    s_waitcnt vmcnt(24)
    s_barrier
    s_add_u32 m0, s52, 98304
    s_nop 0
    buffer_load_dwordx4 v1, s[4:7], s50 offen offset:0 sc1 lds
    buffer_load_dwordx4 v1, s[4:7], s50 offen offset:1024 sc1 lds
    buffer_load_dwordx4 v1, s[4:7], s50 offen offset:2048 sc1 lds
    buffer_load_dwordx4 v1, s[4:7], s50 offen offset:3072 sc1 lds
    s_add_u32 m0, s53, 98304
    s_nop 0
    buffer_load_dwordx4 v1, s[4:7], s51 offen offset:0 sc1 lds
    buffer_load_dwordx4 v1, s[4:7], s51 offen offset:1024 sc1 lds
    buffer_load_dwordx4 v1, s[4:7], s51 offen offset:2048 sc1 lds
    buffer_load_dwordx4 v1, s[4:7], s51 offen offset:3072 sc1 lds
    s_add_u32 s50, s50, 8192
    s_add_u32 s51, s51, 8192
    ds_read_b128 v[32:35], v10 offset:0
    ds_read_b128 v[36:39], v11 offset:0
    ds_read_b128 v[40:43], v10 offset:1024
    ds_read_b128 v[44:47], v11 offset:1024
    ds_read_b128 v[48:51], v10 offset:2048
    ds_read_b128 v[52:55], v11 offset:2048
    s_waitcnt lgkmcnt(4)
    v_mfma_f32_32x32x16_bf16 v[16:31], v[36:39], v[32:35], v[16:31]
    buffer_load_dwordx4 a[32:35], v1, s[4:7], s70 offen offset:0
    ds_read_b128 v[32:35], v10 offset:3072
    ds_read_b128 v[36:39], v11 offset:3072
    s_waitcnt lgkmcnt(4)
    v_mfma_f32_32x32x16_bf16 v[16:31], v[44:47], v[40:43], v[16:31]
    buffer_load_dwordx4 a[36:39], v1, s[4:7], s70 offen offset:1024
    ds_read_b128 v[40:43], v10 offset:4096
    ds_read_b128 v[44:47], v11 offset:4096
    s_waitcnt lgkmcnt(4)
    v_mfma_f32_32x32x16_bf16 v[16:31], v[52:55], v[48:51], v[16:31]
    buffer_load_dwordx4 a[40:43], v1, s[4:7], s70 offen offset:2048
    ds_read_b128 v[48:51], v10 offset:5120
    ds_read_b128 v[52:55], v11 offset:5120
    s_waitcnt lgkmcnt(4)
    v_mfma_f32_32x32x16_bf16 v[16:31], v[36:39], v[32:35], v[16:31]
    buffer_load_dwordx4 a[44:47], v1, s[4:7], s70 offen offset:3072
    ds_read_b128 v[32:35], v10 offset:6144
    ds_read_b128 v[36:39], v11 offset:6144
    s_waitcnt lgkmcnt(4)
    v_mfma_f32_32x32x16_bf16 v[16:31], v[44:47], v[40:43], v[16:31]
    s_add_u32 s70, s70, 4096
    ds_read_b128 v[40:43], v10 offset:7168
    ds_read_b128 v[44:47], v11 offset:7168
    s_waitcnt lgkmcnt(4)
    v_mfma_f32_32x32x16_bf16 v[16:31], v[52:55], v[48:51], v[16:31]
    s_waitcnt lgkmcnt(2)
    v_mfma_f32_32x32x16_bf16 v[16:31], v[36:39], v[32:35], v[16:31]
    s_waitcnt lgkmcnt(0)
    v_mfma_f32_32x32x16_bf16 v[16:31], v[44:47], v[40:43], v[16:31]
    s_waitcnt vmcnt(28)
    s_barrier
    s_add_u32 m0, s52, 0
    s_nop 0
    buffer_load_dwordx4 v1, s[4:7], s50 offen offset:0 sc1 lds
    buffer_load_dwordx4 v1, s[4:7], s50 offen offset:1024 sc1 lds
    buffer_load_dwordx4 v1, s[4:7], s50 offen offset:2048 sc1 lds
    buffer_load_dwordx4 v1, s[4:7], s50 offen offset:3072 sc1 lds
    s_add_u32 m0, s53, 0
    s_nop 0
    buffer_load_dwordx4 v1, s[4:7], s51 offen offset:0 sc1 lds
    buffer_load_dwordx4 v1, s[4:7], s51 offen offset:1024 sc1 lds
    buffer_load_dwordx4 v1, s[4:7], s51 offen offset:2048 sc1 lds
    buffer_load_dwordx4 v1, s[4:7], s51 offen offset:3072 sc1 lds
    s_add_u32 s50, s50, 8192
    s_add_u32 s51, s51, 8192
    ds_read_b128 v[32:35], v10 offset:32768
    ds_read_b128 v[36:39], v11 offset:32768
    ds_read_b128 v[40:43], v10 offset:33792
    ds_read_b128 v[44:47], v11 offset:33792
    ds_read_b128 v[48:51], v10 offset:34816
    ds_read_b128 v[52:55], v11 offset:34816
    s_waitcnt lgkmcnt(4)
    v_mfma_f32_32x32x16_bf16 v[16:31], v[36:39], v[32:35], v[16:31]
    buffer_load_dwordx4 a[48:51], v1, s[4:7], s70 offen offset:0
    ds_read_b128 v[32:35], v10 offset:35840
    ds_read_b128 v[36:39], v11 offset:35840
    s_waitcnt lgkmcnt(4)
    v_mfma_f32_32x32x16_bf16 v[16:31], v[44:47], v[40:43], v[16:31]
    buffer_load_dwordx4 a[52:55], v1, s[4:7], s70 offen offset:1024
    ds_read_b128 v[40:43], v10 offset:36864
    ds_read_b128 v[44:47], v11 offset:36864
    s_waitcnt lgkmcnt(4)
    v_mfma_f32_32x32x16_bf16 v[16:31], v[52:55], v[48:51], v[16:31]
    buffer_load_dwordx4 a[56:59], v1, s[4:7], s70 offen offset:2048
    ds_read_b128 v[48:51], v10 offset:37888
    ds_read_b128 v[52:55], v11 offset:37888
    s_waitcnt lgkmcnt(4)
    v_mfma_f32_32x32x16_bf16 v[16:31], v[36:39], v[32:35], v[16:31]
    buffer_load_dwordx4 a[60:63], v1, s[4:7], s70 offen offset:3072
    ds_read_b128 v[32:35], v10 offset:38912
    ds_read_b128 v[36:39], v11 offset:38912
    s_waitcnt lgkmcnt(4)
    v_mfma_f32_32x32x16_bf16 v[16:31], v[44:47], v[40:43], v[16:31]
    s_add_u32 s70, s70, 4096
    ds_read_b128 v[40:43], v10 offset:39936
    ds_read_b128 v[44:47], v11 offset:39936
    s_waitcnt lgkmcnt(4)
    v_mfma_f32_32x32x16_bf16 v[16:31], v[52:55], v[48:51], v[16:31]
    s_waitcnt lgkmcnt(2)
    v_mfma_f32_32x32x16_bf16 v[16:31], v[36:39], v[32:35], v[16:31]
    s_waitcnt lgkmcnt(0)
    v_mfma_f32_32x32x16_bf16 v[16:31], v[44:47], v[40:43], v[16:31]
    s_waitcnt vmcnt(28)
    s_barrier
    s_add_u32 m0, s52, 32768
    s_nop 0
    buffer_load_dwordx4 v1, s[4:7], s50 offen offset:0 sc1 lds
    buffer_load_dwordx4 v1, s[4:7], s50 offen offset:1024 sc1 lds
    buffer_load_dwordx4 v1, s[4:7], s50 offen offset:2048 sc1 lds
    buffer_load_dwordx4 v1, s[4:7], s50 offen offset:3072 sc1 lds
    s_add_u32 m0, s53, 32768
    s_nop 0
    buffer_load_dwordx4 v1, s[4:7], s51 offen offset:0 sc1 lds
    buffer_load_dwordx4 v1, s[4:7], s51 offen offset:1024 sc1 lds
    buffer_load_dwordx4 v1, s[4:7], s51 offen offset:2048 sc1 lds
    buffer_load_dwordx4 v1, s[4:7], s51 offen offset:3072 sc1 lds
    s_add_u32 s50, s50, 8192
    s_add_u32 s51, s51, 8192
    ds_read_b128 v[32:35], v12 offset:0
    ds_read_b128 v[36:39], v13 offset:0
    ds_read_b128 v[40:43], v12 offset:1024
    ds_read_b128 v[44:47], v13 offset:1024
    ds_read_b128 v[48:51], v12 offset:2048
    ds_read_b128 v[52:55], v13 offset:2048
    s_waitcnt lgkmcnt(4)
    v_mfma_f32_32x32x16_bf16 v[16:31], v[36:39], v[32:35], v[16:31]
    buffer_load_dwordx4 a[64:67], v1, s[4:7], s70 offen offset:0
    ds_read_b128 v[32:35], v12 offset:3072
    ds_read_b128 v[36:39], v13 offset:3072
    s_waitcnt lgkmcnt(4)
    v_mfma_f32_32x32x16_bf16 v[16:31], v[44:47], v[40:43], v[16:31]
    buffer_load_dwordx4 a[68:71], v1, s[4:7], s70 offen offset:1024
    ds_read_b128 v[40:43], v12 offset:4096
    ds_read_b128 v[44:47], v13 offset:4096
    s_waitcnt lgkmcnt(4)
    v_mfma_f32_32x32x16_bf16 v[16:31], v[52:55], v[48:51], v[16:31]
    buffer_load_dwordx4 a[72:75], v1, s[4:7], s70 offen offset:2048
    ds_read_b128 v[48:51], v12 offset:5120
    ds_read_b128 v[52:55], v13 offset:5120
    s_waitcnt lgkmcnt(4)
    v_mfma_f32_32x32x16_bf16 v[16:31], v[36:39], v[32:35], v[16:31]
    buffer_load_dwordx4 a[76:79], v1, s[4:7], s70 offen offset:3072
    ds_read_b128 v[32:35], v12 offset:6144
    ds_read_b128 v[36:39], v13 offset:6144
    s_waitcnt lgkmcnt(4)
    v_mfma_f32_32x32x16_bf16 v[16:31], v[44:47], v[40:43], v[16:31]
    s_add_u32 s70, s70, 4096
    ds_read_b128 v[40:43], v12 offset:7168
    ds_read_b128 v[44:47], v13 offset:7168
    s_waitcnt lgkmcnt(4)
    v_mfma_f32_32x32x16_bf16 v[16:31], v[52:55], v[48:51], v[16:31]
    s_waitcnt lgkmcnt(2)
    v_mfma_f32_32x32x16_bf16 v[16:31], v[36:39], v[32:35], v[16:31]
    s_waitcnt lgkmcnt(0)
    v_mfma_f32_32x32x16_bf16 v[16:31], v[44:47], v[40:43], v[16:31]
    s_waitcnt vmcnt(28)
    s_barrier
    ds_read_b128 v[32:35], v12 offset:32768
    ds_read_b128 v[36:39], v13 offset:32768
    ds_read_b128 v[40:43], v12 offset:33792
    ds_read_b128 v[44:47], v13 offset:33792
    ds_read_b128 v[48:51], v12 offset:34816
    ds_read_b128 v[52:55], v13 offset:34816
    s_waitcnt lgkmcnt(4)
    v_mfma_f32_32x32x16_bf16 v[16:31], v[36:39], v[32:35], v[16:31]
    buffer_load_dwordx4 a[80:83], v1, s[4:7], s70 offen offset:0
    ds_read_b128 v[32:35], v12 offset:35840
    ds_read_b128 v[36:39], v13 offset:35840
    s_waitcnt lgkmcnt(4)
    v_mfma_f32_32x32x16_bf16 v[16:31], v[44:47], v[40:43], v[16:31]
    buffer_load_dwordx4 a[84:87], v1, s[4:7], s70 offen offset:1024
    ds_read_b128 v[40:43], v12 offset:36864
    ds_read_b128 v[44:47], v13 offset:36864
    s_waitcnt lgkmcnt(4)
    v_mfma_f32_32x32x16_bf16 v[16:31], v[52:55], v[48:51], v[16:31]
    buffer_load_dwordx4 a[88:91], v1, s[4:7], s70 offen offset:2048
    ds_read_b128 v[48:51], v12 offset:37888
    ds_read_b128 v[52:55], v13 offset:37888
    s_waitcnt lgkmcnt(4)
    v_mfma_f32_32x32x16_bf16 v[16:31], v[36:39], v[32:35], v[16:31]
    buffer_load_dwordx4 a[92:95], v1, s[4:7], s70 offen offset:3072
    ds_read_b128 v[32:35], v12 offset:38912
    ds_read_b128 v[36:39], v13 offset:38912
    s_waitcnt lgkmcnt(4)
    v_mfma_f32_32x32x16_bf16 v[16:31], v[44:47], v[40:43], v[16:31]
    s_add_u32 s70, s70, 4096
    ds_read_b128 v[40:43], v12 offset:39936
    ds_read_b128 v[44:47], v13 offset:39936
    s_waitcnt lgkmcnt(4)
    v_mfma_f32_32x32x16_bf16 v[16:31], v[52:55], v[48:51], v[16:31]
    s_waitcnt lgkmcnt(2)
    v_mfma_f32_32x32x16_bf16 v[16:31], v[36:39], v[32:35], v[16:31]
    s_waitcnt lgkmcnt(0)
    v_mfma_f32_32x32x16_bf16 v[16:31], v[44:47], v[40:43], v[16:31]
    s_waitcnt vmcnt(20)
    s_barrier
    ds_read_b128 v[32:35], v10 offset:0
    ds_read_b128 v[36:39], v11 offset:0
    ds_read_b128 v[40:43], v10 offset:1024
    ds_read_b128 v[44:47], v11 offset:1024
    ds_read_b128 v[48:51], v10 offset:2048
    ds_read_b128 v[52:55], v11 offset:2048
    s_waitcnt lgkmcnt(4)
    v_mfma_f32_32x32x16_bf16 v[16:31], v[36:39], v[32:35], v[16:31]
    buffer_load_dwordx4 a[96:99], v1, s[4:7], s70 offen offset:0
    ds_read_b128 v[32:35], v10 offset:3072
    ds_read_b128 v[36:39], v11 offset:3072
    s_waitcnt lgkmcnt(4)
    v_mfma_f32_32x32x16_bf16 v[16:31], v[44:47], v[40:43], v[16:31]
    buffer_load_dwordx4 a[100:103], v1, s[4:7], s70 offen offset:1024
    ds_read_b128 v[40:43], v10 offset:4096
    ds_read_b128 v[44:47], v11 offset:4096
    s_waitcnt lgkmcnt(4)
    v_mfma_f32_32x32x16_bf16 v[16:31], v[52:55], v[48:51], v[16:31]
    buffer_load_dwordx4 a[104:107], v1, s[4:7], s70 offen offset:2048
    ds_read_b128 v[48:51], v10 offset:5120
    ds_read_b128 v[52:55], v11 offset:5120
    s_waitcnt lgkmcnt(4)
    v_mfma_f32_32x32x16_bf16 v[16:31], v[36:39], v[32:35], v[16:31]
    buffer_load_dwordx4 a[108:111], v1, s[4:7], s70 offen offset:3072
    ds_read_b128 v[32:35], v10 offset:6144
    ds_read_b128 v[36:39], v11 offset:6144
    s_waitcnt lgkmcnt(4)
    v_mfma_f32_32x32x16_bf16 v[16:31], v[44:47], v[40:43], v[16:31]
    s_add_u32 s70, s70, 4096
    ds_read_b128 v[40:43], v10 offset:7168
    ds_read_b128 v[44:47], v11 offset:7168
    s_waitcnt lgkmcnt(4)
    v_mfma_f32_32x32x16_bf16 v[16:31], v[52:55], v[48:51], v[16:31]
    s_waitcnt lgkmcnt(2)
    v_mfma_f32_32x32x16_bf16 v[16:31], v[36:39], v[32:35], v[16:31]
    s_waitcnt lgkmcnt(0)
    v_mfma_f32_32x32x16_bf16 v[16:31], v[44:47], v[40:43], v[16:31]
    s_waitcnt vmcnt(12)
    s_barrier
    ds_read_b128 v[32:35], v10 offset:32768
    ds_read_b128 v[36:39], v11 offset:32768
    ds_read_b128 v[40:43], v10 offset:33792
    ds_read_b128 v[44:47], v11 offset:33792
    ds_read_b128 v[48:51], v10 offset:34816
    ds_read_b128 v[52:55], v11 offset:34816
    s_waitcnt lgkmcnt(4)
    v_mfma_f32_32x32x16_bf16 v[16:31], v[36:39], v[32:35], v[16:31]
    buffer_load_dwordx4 a[112:115], v1, s[4:7], s70 offen offset:0
    ds_read_b128 v[32:35], v10 offset:35840
    ds_read_b128 v[36:39], v11 offset:35840
    s_waitcnt lgkmcnt(4)
    v_mfma_f32_32x32x16_bf16 v[16:31], v[44:47], v[40:43], v[16:31]
    buffer_load_dwordx4 a[116:119], v1, s[4:7], s70 offen offset:1024
    ds_read_b128 v[40:43], v10 offset:36864
    ds_read_b128 v[44:47], v11 offset:36864
    s_waitcnt lgkmcnt(4)
    v_mfma_f32_32x32x16_bf16 v[16:31], v[52:55], v[48:51], v[16:31]
    buffer_load_dwordx4 a[120:123], v1, s[4:7], s70 offen offset:2048
    ds_read_b128 v[48:51], v10 offset:37888
    ds_read_b128 v[52:55], v11 offset:37888
    s_waitcnt lgkmcnt(4)
    v_mfma_f32_32x32x16_bf16 v[16:31], v[36:39], v[32:35], v[16:31]
    buffer_load_dwordx4 a[124:127], v1, s[4:7], s70 offen offset:3072
    ds_read_b128 v[32:35], v10 offset:38912
    ds_read_b128 v[36:39], v11 offset:38912
    s_waitcnt lgkmcnt(4)
    v_mfma_f32_32x32x16_bf16 v[16:31], v[44:47], v[40:43], v[16:31]
    s_add_u32 s70, s70, 4096
    ds_read_b128 v[40:43], v10 offset:39936
    ds_read_b128 v[44:47], v11 offset:39936
    s_waitcnt lgkmcnt(4)
    v_mfma_f32_32x32x16_bf16 v[16:31], v[52:55], v[48:51], v[16:31]
    s_waitcnt lgkmcnt(2)
    v_mfma_f32_32x32x16_bf16 v[16:31], v[36:39], v[32:35], v[16:31]
    s_waitcnt lgkmcnt(0)
    v_mfma_f32_32x32x16_bf16 v[16:31], v[44:47], v[40:43], v[16:31]
    s_nop 15
    s_nop 3
    v_lshlrev_b32 v6, 16, v216
    v_and_b32 v7, 0xffff0000, v216
    v_add_f32 v16, v16, v6
    v_add_f32 v17, v17, v7
    v_lshlrev_b32 v6, 16, v217
    v_and_b32 v7, 0xffff0000, v217
    v_add_f32 v18, v18, v6
    v_add_f32 v19, v19, v7
    v_lshlrev_b32 v6, 16, v218
    v_and_b32 v7, 0xffff0000, v218
    v_add_f32 v20, v20, v6
    v_add_f32 v21, v21, v7
    v_lshlrev_b32 v6, 16, v219
    v_and_b32 v7, 0xffff0000, v219
    v_add_f32 v22, v22, v6
    v_add_f32 v23, v23, v7
    v_lshlrev_b32 v6, 16, v220
    v_and_b32 v7, 0xffff0000, v220
    v_add_f32 v24, v24, v6
    v_add_f32 v25, v25, v7
    v_lshlrev_b32 v6, 16, v221
    v_and_b32 v7, 0xffff0000, v221
    v_add_f32 v26, v26, v6
    v_add_f32 v27, v27, v7
    v_lshlrev_b32 v6, 16, v222
    v_and_b32 v7, 0xffff0000, v222
    v_add_f32 v28, v28, v6
    v_add_f32 v29, v29, v7
    v_lshlrev_b32 v6, 16, v223
    v_and_b32 v7, 0xffff0000, v223
    v_add_f32 v30, v30, v6
    v_add_f32 v31, v31, v7
    v_cvt_pk_bf16_f32 v216, v16, v17
    v_cvt_pk_bf16_f32 v217, v18, v19
    v_cvt_pk_bf16_f32 v218, v20, v21
    v_cvt_pk_bf16_f32 v219, v22, v23
    v_cvt_pk_bf16_f32 v220, v24, v25
    v_cvt_pk_bf16_f32 v221, v26, v27
    v_cvt_pk_bf16_f32 v222, v28, v29
    v_cvt_pk_bf16_f32 v223, v30, v31
    s_add_u32 s21, s20, 25976832
    buffer_store_dwordx4 v[216:219], v1, s[4:7], s21 offen sc1
    buffer_store_dwordx4 v[220:223], v1, s[4:7], s21 offen offset:1024 sc1
    v_lshlrev_b32 v6, 16, v216
    v_and_b32 v7, 0xffff0000, v216
    v_add_f32 v64, v6, v7
    v_mul_f32 v65, v6, v6
    v_fmac_f32 v65, v7, v7
    v_lshlrev_b32 v6, 16, v217
    v_and_b32 v7, 0xffff0000, v217
    v_add_f32 v64, v64, v6
    v_add_f32 v64, v64, v7
    v_fmac_f32 v65, v6, v6
    v_fmac_f32 v65, v7, v7
    v_lshlrev_b32 v6, 16, v218
    v_and_b32 v7, 0xffff0000, v218
    v_add_f32 v64, v64, v6
    v_add_f32 v64, v64, v7
    v_fmac_f32 v65, v6, v6
    v_fmac_f32 v65, v7, v7
    v_lshlrev_b32 v6, 16, v219
    v_and_b32 v7, 0xffff0000, v219
    v_add_f32 v64, v64, v6
    v_add_f32 v64, v64, v7
    v_fmac_f32 v65, v6, v6
    v_fmac_f32 v65, v7, v7
    v_lshlrev_b32 v6, 16, v220
    v_and_b32 v7, 0xffff0000, v220
    v_add_f32 v64, v64, v6
    v_add_f32 v64, v64, v7
    v_fmac_f32 v65, v6, v6
    v_fmac_f32 v65, v7, v7
    v_lshlrev_b32 v6, 16, v221
    v_and_b32 v7, 0xffff0000, v221
    v_add_f32 v64, v64, v6
    v_add_f32 v64, v64, v7
    v_fmac_f32 v65, v6, v6
    v_fmac_f32 v65, v7, v7
    v_lshlrev_b32 v6, 16, v222
    v_and_b32 v7, 0xffff0000, v222
    v_add_f32 v64, v64, v6
    v_add_f32 v64, v64, v7
    v_fmac_f32 v65, v6, v6
    v_fmac_f32 v65, v7, v7
    v_lshlrev_b32 v6, 16, v223
    v_and_b32 v7, 0xffff0000, v223
    v_add_f32 v64, v64, v6
    v_add_f32 v64, v64, v7
    v_fmac_f32 v65, v6, v6
    v_fmac_f32 v65, v7, v7
    v_mov_b32 v6, v64
    s_nop 1
    v_permlane32_swap_b32 v64, v6
    s_nop 1
    v_add_f32 v64, v64, v6
    v_mov_b32 v6, v65
    s_nop 1
    v_permlane32_swap_b32 v65, v6
    s_nop 1
    v_add_f32 v65, v65, v6
    v_lshlrev_b32 v6, 4, v4
    s_lshl_b32 s30, s18, 3
    s_lshr_b32 s31, s19, 1
    s_add_u32 s30, s30, s31
    s_lshl_b32 s30, s30, 9
    s_and_b32 s31, s19, 1
    s_lshl_b32 s31, s31, 3
    s_add_u32 s31, s31, s30
    s_add_u32 s31, s31, 28336128
    buffer_store_dwordx2 v[64:65], v6, s[4:7], s31 offen sc1
    s_waitcnt vmcnt(0)
    s_barrier
    s_cmp_lg_u32 s3, 0
    s_cbranch_scc1 L_pub_16
    s_lshl_b32 s64, s60, 7
    s_lshl_b32 s65, s61, 5
    s_add_u32 s64, s64, s65
    s_lshl_b32 s65, s62, 2
    s_add_u32 s64, s64, s65
    s_add_u32 s64, s64, 28602368
    v_mov_b32 v2, 0
    v_mov_b32 v3, 1
    s_mov_b64 exec, 1
    buffer_store_dword v3, v2, s[4:7], s64 offen sc1
    s_mov_b64 exec, -1
L_pub_16:
    s_cmp_ge_u32 s62, 6
    s_cbranch_scc1 L_chain1_kernel_end
    s_lshl_b32 s8, s60, 2
    s_mul_i32 s9, s61, 6
    s_add_u32 s9, s9, s62
    s_lshl_b32 s9, s9, 2
    s_add_u32 s19, s9, s3
    s_add_u32 s10, s8, s3
    s_lshl_b32 s10, s10, 15
    s_add_u32 s10, s10, 25976832
    s_lshl_b32 s12, s3, 15
    s_cmp_lg_u32 s3, 0
    s_cbranch_scc1 L_aw_18
    s_lshl_b32 s64, s60, 7
    s_add_u32 s64, s64, 28602368
    v_lshrrev_b32 v2, 2, v1
    v_and_b32 v2, 60, v2
    s_mov_b32 s66, 0x20000
L_poll_19:
    buffer_load_dword v3, v2, s[4:7], s64 offen sc1
    s_waitcnt vmcnt(0)
    v_cmp_eq_u32 vcc, 1, v3
    s_nop 3
    s_and_b32 s65, vcc_lo, 0xffff
    s_cmp_eq_u32 s65, 0xffff
    s_cbranch_scc1 L_done_20
    s_sub_u32 s66, s66, 1
    s_cmp_lg_u32 s66, 0
    s_cbranch_scc1 L_poll_19
L_done_20:
    s_waitcnt vmcnt(0)
L_aw_18:
    s_barrier
    s_add_u32 m0, s12, 0
    s_nop 0
    buffer_load_dwordx4 v1, s[4:7], s10 offen offset:0 sc1 lds
    buffer_load_dwordx4 v1, s[4:7], s10 offen offset:1024 sc1 lds
    buffer_load_dwordx4 v1, s[4:7], s10 offen offset:2048 sc1 lds
    buffer_load_dwordx4 v1, s[4:7], s10 offen offset:3072 sc1 lds
    s_add_u32 s10, s10, 4096
    s_add_u32 m0, s12, 4096
    s_nop 0
    buffer_load_dwordx4 v1, s[4:7], s10 offen offset:0 sc1 lds
    buffer_load_dwordx4 v1, s[4:7], s10 offen offset:1024 sc1 lds
    buffer_load_dwordx4 v1, s[4:7], s10 offen offset:2048 sc1 lds
    buffer_load_dwordx4 v1, s[4:7], s10 offen offset:3072 sc1 lds
    s_add_u32 s10, s10, 4096
    s_add_u32 m0, s12, 8192
    s_nop 0
    buffer_load_dwordx4 v1, s[4:7], s10 offen offset:0 sc1 lds
    buffer_load_dwordx4 v1, s[4:7], s10 offen offset:1024 sc1 lds
    buffer_load_dwordx4 v1, s[4:7], s10 offen offset:2048 sc1 lds
    buffer_load_dwordx4 v1, s[4:7], s10 offen offset:3072 sc1 lds
    s_add_u32 s10, s10, 4096
    s_add_u32 m0, s12, 12288
    s_nop 0
    buffer_load_dwordx4 v1, s[4:7], s10 offen offset:0 sc1 lds
    buffer_load_dwordx4 v1, s[4:7], s10 offen offset:1024 sc1 lds
    buffer_load_dwordx4 v1, s[4:7], s10 offen offset:2048 sc1 lds
    buffer_load_dwordx4 v1, s[4:7], s10 offen offset:3072 sc1 lds
    s_add_u32 s10, s10, 4096
    v_add_u32 v11, 0x10000, v1
    s_lshl_b32 s26, s3, 8
    v_lshlrev_b32 v12, 3, v4
    v_add_u32 v13, 131072, v12
    v_add_u32 v12, s26, v13
    s_cmp_ge_u32 s9, 32
    s_cbranch_scc1 L_qkv_17_v
    s_cmp_lt_u32 s9, 16
    s_cselect_b32 s27, 0x3eb8aa3b, 1.0
    s_mov_b32 s28, 8151040
    s_mov_b32 s29, 8151040
    s_cselect_b32 s28, s28, s29
    s_lshl_b32 s30, s19, 7
    s_add_u32 s30, s30, s8
    s_lshl_b32 s30, s30, 10
    s_add_u32 s30, s30, s28
    s_add_u32 s31, s30, 65536
    s_waitcnt vmcnt(12)
    s_barrier
    ds_read_b128 v[80:83], v1 offset:0
    ds_read_b128 v[84:87], v1 offset:32768
    ds_read_b128 v[88:91], v11 offset:0
    ds_read_b128 v[92:95], v11 offset:32768
    ds_read_b128 v[96:99], v1 offset:1024
    ds_read_b128 v[100:103], v1 offset:33792
    ds_read_b128 v[104:107], v11 offset:1024
    ds_read_b128 v[108:111], v11 offset:33792
    s_waitcnt vmcnt(16)
    s_waitcnt lgkmcnt(7)
    v_mfma_f32_32x32x16_bf16 v[16:31], a[0:3], v[80:83], 0
    s_add_u32 m0, s12, 16384
    s_waitcnt lgkmcnt(6)
    v_mfma_f32_32x32x16_bf16 v[32:47], a[0:3], v[84:87], 0
    s_nop 0
    s_waitcnt lgkmcnt(5)
    v_mfma_f32_32x32x16_bf16 v[48:63], a[0:3], v[88:91], 0
    buffer_load_dwordx4 v1, s[4:7], s10 offen offset:0 sc1 lds
    s_waitcnt lgkmcnt(4)
    v_mfma_f32_32x32x16_bf16 v[64:79], a[0:3], v[92:95], 0
    buffer_load_dwordx4 v1, s[4:7], s10 offen offset:1024 sc1 lds
    ds_read_b128 v[80:83], v1 offset:2048
    ds_read_b128 v[84:87], v1 offset:34816
    ds_read_b128 v[88:91], v11 offset:2048
    ds_read_b128 v[92:95], v11 offset:34816
    s_waitcnt lgkmcnt(7)
    v_mfma_f32_32x32x16_bf16 v[16:31], a[4:7], v[96:99], v[16:31]
    buffer_load_dwordx4 v1, s[4:7], s10 offen offset:2048 sc1 lds
    s_waitcnt lgkmcnt(6)
    v_mfma_f32_32x32x16_bf16 v[32:47], a[4:7], v[100:103], v[32:47]
    buffer_load_dwordx4 v1, s[4:7], s10 offen offset:3072 sc1 lds
    s_waitcnt lgkmcnt(5)
    v_mfma_f32_32x32x16_bf16 v[48:63], a[4:7], v[104:107], v[48:63]
    s_add_u32 s10, s10, 4096
    s_waitcnt lgkmcnt(4)
    v_mfma_f32_32x32x16_bf16 v[64:79], a[4:7], v[108:111], v[64:79]
    ds_read_b128 v[96:99], v1 offset:3072
    ds_read_b128 v[100:103], v1 offset:35840
    ds_read_b128 v[104:107], v11 offset:3072
    ds_read_b128 v[108:111], v11 offset:35840
    s_waitcnt lgkmcnt(7)
    v_mfma_f32_32x32x16_bf16 v[16:31], a[8:11], v[80:83], v[16:31]
    s_waitcnt lgkmcnt(6)
    v_mfma_f32_32x32x16_bf16 v[32:47], a[8:11], v[84:87], v[32:47]
    s_waitcnt lgkmcnt(5)
    v_mfma_f32_32x32x16_bf16 v[48:63], a[8:11], v[88:91], v[48:63]
    s_waitcnt lgkmcnt(4)
    v_mfma_f32_32x32x16_bf16 v[64:79], a[8:11], v[92:95], v[64:79]
    s_waitcnt vmcnt(12)
    s_barrier
    ds_read_b128 v[80:83], v1 offset:4096
    ds_read_b128 v[84:87], v1 offset:36864
    ds_read_b128 v[88:91], v11 offset:4096
    ds_read_b128 v[92:95], v11 offset:36864
    s_waitcnt lgkmcnt(7)
    v_mfma_f32_32x32x16_bf16 v[16:31], a[12:15], v[96:99], v[16:31]
    s_waitcnt lgkmcnt(6)
    v_mfma_f32_32x32x16_bf16 v[32:47], a[12:15], v[100:103], v[32:47]
    s_waitcnt lgkmcnt(5)
    v_mfma_f32_32x32x16_bf16 v[48:63], a[12:15], v[104:107], v[48:63]
    s_waitcnt lgkmcnt(4)
    v_mfma_f32_32x32x16_bf16 v[64:79], a[12:15], v[108:111], v[64:79]
    ds_read_b128 v[96:99], v1 offset:5120
    ds_read_b128 v[100:103], v1 offset:37888
    ds_read_b128 v[104:107], v11 offset:5120
    ds_read_b128 v[108:111], v11 offset:37888
    s_waitcnt vmcnt(20)
    s_waitcnt lgkmcnt(7)
    v_mfma_f32_32x32x16_bf16 v[16:31], a[16:19], v[80:83], v[16:31]
    s_add_u32 m0, s12, 20480
    s_nop 0
    buffer_load_dwordx4 v1, s[4:7], s10 offen offset:0 sc1 lds
    s_waitcnt lgkmcnt(6)
    v_mfma_f32_32x32x16_bf16 v[32:47], a[16:19], v[84:87], v[32:47]
    buffer_load_dwordx4 v1, s[4:7], s10 offen offset:1024 sc1 lds
    buffer_load_dwordx4 v1, s[4:7], s10 offen offset:2048 sc1 lds
    s_waitcnt lgkmcnt(5)
    v_mfma_f32_32x32x16_bf16 v[48:63], a[16:19], v[88:91], v[48:63]
    buffer_load_dwordx4 v1, s[4:7], s10 offen offset:3072 sc1 lds
    s_add_u32 s10, s10, 4096
    s_waitcnt lgkmcnt(4)
    v_mfma_f32_32x32x16_bf16 v[64:79], a[16:19], v[92:95], v[64:79]
    s_add_u32 s21, s8, s3
    s_lshl_b32 s21, s21, 12
    ds_read_b128 v[80:83], v1 offset:6144
    ds_read_b128 v[84:87], v1 offset:38912
    ds_read_b128 v[88:91], v11 offset:6144
    ds_read_b128 v[92:95], v11 offset:38912
    s_waitcnt lgkmcnt(7)
    v_mfma_f32_32x32x16_bf16 v[16:31], a[20:23], v[96:99], v[16:31]
    s_add_u32 s21, s21, 28336128
    buffer_load_dwordx4 v[168:171], v1, s[4:7], s21 offen offset:0 sc1
    s_waitcnt lgkmcnt(6)
    v_mfma_f32_32x32x16_bf16 v[32:47], a[20:23], v[100:103], v[32:47]
    buffer_load_dwordx4 v[172:175], v1, s[4:7], s21 offen offset:1024 sc1
    buffer_load_dwordx4 v[176:179], v1, s[4:7], s21 offen offset:2048 sc1
    s_waitcnt lgkmcnt(5)
    v_mfma_f32_32x32x16_bf16 v[48:63], a[20:23], v[104:107], v[48:63]
    buffer_load_dwordx4 v[180:183], v1, s[4:7], s21 offen offset:3072 sc1
    v_lshlrev_b32 v14, 6, v5
    s_waitcnt lgkmcnt(4)
    v_mfma_f32_32x32x16_bf16 v[64:79], a[20:23], v[108:111], v[64:79]
    s_lshl_b32 s22, s19, 7
    s_add_u32 s22, s22, 5767168
    ds_read_b128 v[96:99], v1 offset:7168
    ds_read_b128 v[100:103], v1 offset:39936
    ds_read_b128 v[104:107], v11 offset:7168
    ds_read_b128 v[108:111], v11 offset:39936
    s_waitcnt lgkmcnt(7)
    v_mfma_f32_32x32x16_bf16 v[16:31], a[24:27], v[80:83], v[16:31]
    buffer_load_dwordx4 v[112:115], v14, s[4:7], s22 offen offset:0
    buffer_load_dwordx4 v[116:119], v14, s[4:7], s22 offen offset:16
    s_waitcnt lgkmcnt(6)
    v_mfma_f32_32x32x16_bf16 v[32:47], a[24:27], v[84:87], v[32:47]
    buffer_load_dwordx4 v[120:123], v14, s[4:7], s22 offen offset:32
    buffer_load_dwordx4 v[124:127], v14, s[4:7], s22 offen offset:48
    s_waitcnt lgkmcnt(5)
    v_mfma_f32_32x32x16_bf16 v[48:63], a[24:27], v[88:91], v[48:63]
    v_bfe_u32 v15, v4, 2, 1
    v_lshlrev_b32 v15, 4, v15
    s_waitcnt lgkmcnt(4)
    v_mfma_f32_32x32x16_bf16 v[64:79], a[24:27], v[92:95], v[64:79]
    v_lshrrev_b32 v3, 3, v4
    v_lshl_add_u32 v15, v3, 2, v15
    s_waitcnt vmcnt(20)
    s_barrier
    ds_read_b128 v[80:83], v1 offset:8192
    ds_read_b128 v[84:87], v1 offset:40960
    ds_read_b128 v[88:91], v11 offset:8192
    ds_read_b128 v[92:95], v11 offset:40960
    s_waitcnt lgkmcnt(7)
    v_mfma_f32_32x32x16_bf16 v[16:31], a[28:31], v[96:99], v[16:31]
    v_and_b32 v3, 3, v4
    v_add_u32 v15, v15, v3
    s_waitcnt lgkmcnt(6)
    v_mfma_f32_32x32x16_bf16 v[32:47], a[28:31], v[100:103], v[32:47]
    v_lshlrev_b32 v15, 2, v15
    buffer_load_dword v128, v15, s[4:7], s22 offen
    s_waitcnt lgkmcnt(5)
    v_mfma_f32_32x32x16_bf16 v[48:63], a[28:31], v[104:107], v[48:63]
    s_waitcnt lgkmcnt(4)
    v_mfma_f32_32x32x16_bf16 v[64:79], a[28:31], v[108:111], v[64:79]
    ds_read_b128 v[96:99], v1 offset:9216
    ds_read_b128 v[100:103], v1 offset:41984
    ds_read_b128 v[104:107], v11 offset:9216
    ds_read_b128 v[108:111], v11 offset:41984
    s_waitcnt vmcnt(33)
    s_waitcnt lgkmcnt(7)
    v_mfma_f32_32x32x16_bf16 v[16:31], a[32:35], v[80:83], v[16:31]
    s_add_u32 m0, s12, 24576
    s_waitcnt lgkmcnt(6)
    v_mfma_f32_32x32x16_bf16 v[32:47], a[32:35], v[84:87], v[32:47]
    s_nop 0
    s_waitcnt lgkmcnt(5)
    v_mfma_f32_32x32x16_bf16 v[48:63], a[32:35], v[88:91], v[48:63]
    buffer_load_dwordx4 v1, s[4:7], s10 offen offset:0 sc1 lds
    s_waitcnt lgkmcnt(4)
    v_mfma_f32_32x32x16_bf16 v[64:79], a[32:35], v[92:95], v[64:79]
    buffer_load_dwordx4 v1, s[4:7], s10 offen offset:1024 sc1 lds
    ds_read_b128 v[80:83], v1 offset:10240
    ds_read_b128 v[84:87], v1 offset:43008
    ds_read_b128 v[88:91], v11 offset:10240
    ds_read_b128 v[92:95], v11 offset:43008
    s_waitcnt lgkmcnt(7)
    v_mfma_f32_32x32x16_bf16 v[16:31], a[36:39], v[96:99], v[16:31]
    buffer_load_dwordx4 v1, s[4:7], s10 offen offset:2048 sc1 lds
    s_waitcnt lgkmcnt(6)
    v_mfma_f32_32x32x16_bf16 v[32:47], a[36:39], v[100:103], v[32:47]
    buffer_load_dwordx4 v1, s[4:7], s10 offen offset:3072 sc1 lds
    s_waitcnt lgkmcnt(5)
    v_mfma_f32_32x32x16_bf16 v[48:63], a[36:39], v[104:107], v[48:63]
    s_add_u32 s10, s10, 4096
    s_waitcnt lgkmcnt(4)
    v_mfma_f32_32x32x16_bf16 v[64:79], a[36:39], v[108:111], v[64:79]
    ds_read_b128 v[96:99], v1 offset:11264
    ds_read_b128 v[100:103], v1 offset:44032
    ds_read_b128 v[104:107], v11 offset:11264
    ds_read_b128 v[108:111], v11 offset:44032
    s_waitcnt lgkmcnt(7)
    v_mfma_f32_32x32x16_bf16 v[16:31], a[40:43], v[80:83], v[16:31]
    s_waitcnt lgkmcnt(6)
    v_mfma_f32_32x32x16_bf16 v[32:47], a[40:43], v[84:87], v[32:47]
    s_waitcnt lgkmcnt(5)
    v_mfma_f32_32x32x16_bf16 v[48:63], a[40:43], v[88:91], v[48:63]
    s_waitcnt lgkmcnt(4)
    v_mfma_f32_32x32x16_bf16 v[64:79], a[40:43], v[92:95], v[64:79]
    s_waitcnt vmcnt(21)
    s_barrier
    ds_read_b128 v[80:83], v1 offset:12288
    ds_read_b128 v[84:87], v1 offset:45056
    ds_read_b128 v[88:91], v11 offset:12288
    ds_read_b128 v[92:95], v11 offset:45056
    s_waitcnt lgkmcnt(7)
    v_mfma_f32_32x32x16_bf16 v[16:31], a[44:47], v[96:99], v[16:31]
    s_waitcnt lgkmcnt(6)
    v_mfma_f32_32x32x16_bf16 v[32:47], a[44:47], v[100:103], v[32:47]
    s_waitcnt lgkmcnt(5)
    v_mfma_f32_32x32x16_bf16 v[48:63], a[44:47], v[104:107], v[48:63]
    s_waitcnt lgkmcnt(4)
    v_mfma_f32_32x32x16_bf16 v[64:79], a[44:47], v[108:111], v[64:79]
    ds_read_b128 v[96:99], v1 offset:13312
    ds_read_b128 v[100:103], v1 offset:46080
    ds_read_b128 v[104:107], v11 offset:13312
    ds_read_b128 v[108:111], v11 offset:46080
    s_waitcnt vmcnt(37)
    s_waitcnt lgkmcnt(7)
    v_mfma_f32_32x32x16_bf16 v[16:31], a[48:51], v[80:83], v[16:31]
    s_add_u32 m0, s12, 28672
    s_waitcnt lgkmcnt(6)
    v_mfma_f32_32x32x16_bf16 v[32:47], a[48:51], v[84:87], v[32:47]
    s_nop 0
    s_waitcnt lgkmcnt(5)
    v_mfma_f32_32x32x16_bf16 v[48:63], a[48:51], v[88:91], v[48:63]
    buffer_load_dwordx4 v1, s[4:7], s10 offen offset:0 sc1 lds
    s_waitcnt lgkmcnt(4)
    v_mfma_f32_32x32x16_bf16 v[64:79], a[48:51], v[92:95], v[64:79]
    buffer_load_dwordx4 v1, s[4:7], s10 offen offset:1024 sc1 lds
    ds_read_b128 v[80:83], v1 offset:14336
    ds_read_b128 v[84:87], v1 offset:47104
    ds_read_b128 v[88:91], v11 offset:14336
    ds_read_b128 v[92:95], v11 offset:47104
    s_waitcnt lgkmcnt(7)
    v_mfma_f32_32x32x16_bf16 v[16:31], a[52:55], v[96:99], v[16:31]
    buffer_load_dwordx4 v1, s[4:7], s10 offen offset:2048 sc1 lds
    s_waitcnt lgkmcnt(6)
    v_mfma_f32_32x32x16_bf16 v[32:47], a[52:55], v[100:103], v[32:47]
    buffer_load_dwordx4 v1, s[4:7], s10 offen offset:3072 sc1 lds
    s_waitcnt lgkmcnt(5)
    v_mfma_f32_32x32x16_bf16 v[48:63], a[52:55], v[104:107], v[48:63]
    s_add_u32 s10, s10, 4096
    s_waitcnt lgkmcnt(4)
    v_mfma_f32_32x32x16_bf16 v[64:79], a[52:55], v[108:111], v[64:79]
    ds_read_b128 v[96:99], v1 offset:15360
    ds_read_b128 v[100:103], v1 offset:48128
    ds_read_b128 v[104:107], v11 offset:15360
    ds_read_b128 v[108:111], v11 offset:48128
    s_waitcnt lgkmcnt(7)
    v_mfma_f32_32x32x16_bf16 v[16:31], a[56:59], v[80:83], v[16:31]
    s_waitcnt lgkmcnt(6)
    v_mfma_f32_32x32x16_bf16 v[32:47], a[56:59], v[84:87], v[32:47]
    s_waitcnt lgkmcnt(5)
    v_mfma_f32_32x32x16_bf16 v[48:63], a[56:59], v[88:91], v[48:63]
    s_waitcnt lgkmcnt(4)
    v_mfma_f32_32x32x16_bf16 v[64:79], a[56:59], v[92:95], v[64:79]
    s_waitcnt vmcnt(21)
    s_barrier
    ds_read_b128 v[80:83], v1 offset:16384
    ds_read_b128 v[84:87], v1 offset:49152
    ds_read_b128 v[88:91], v11 offset:16384
    ds_read_b128 v[92:95], v11 offset:49152
    s_waitcnt lgkmcnt(7)
    v_mfma_f32_32x32x16_bf16 v[16:31], a[60:63], v[96:99], v[16:31]
    s_waitcnt lgkmcnt(6)
    v_mfma_f32_32x32x16_bf16 v[32:47], a[60:63], v[100:103], v[32:47]
    s_waitcnt lgkmcnt(5)
    v_mfma_f32_32x32x16_bf16 v[48:63], a[60:63], v[104:107], v[48:63]
    s_waitcnt lgkmcnt(4)
    v_mfma_f32_32x32x16_bf16 v[64:79], a[60:63], v[108:111], v[64:79]
    ds_read_b128 v[96:99], v1 offset:17408
    ds_read_b128 v[100:103], v1 offset:50176
    ds_read_b128 v[104:107], v11 offset:17408
    ds_read_b128 v[108:111], v11 offset:50176
    s_waitcnt vmcnt(41)
    s_waitcnt lgkmcnt(7)
    v_mfma_f32_32x32x16_bf16 v[16:31], a[64:67], v[80:83], v[16:31]
    s_waitcnt lgkmcnt(6)
    v_mfma_f32_32x32x16_bf16 v[32:47], a[64:67], v[84:87], v[32:47]
    s_waitcnt lgkmcnt(5)
    v_mfma_f32_32x32x16_bf16 v[48:63], a[64:67], v[88:91], v[48:63]
    s_waitcnt lgkmcnt(4)
    v_mfma_f32_32x32x16_bf16 v[64:79], a[64:67], v[92:95], v[64:79]
    ds_read_b128 v[80:83], v1 offset:18432
    ds_read_b128 v[84:87], v1 offset:51200
    ds_read_b128 v[88:91], v11 offset:18432
    ds_read_b128 v[92:95], v11 offset:51200
    s_waitcnt lgkmcnt(7)
    v_mfma_f32_32x32x16_bf16 v[16:31], a[68:71], v[96:99], v[16:31]
    s_waitcnt lgkmcnt(6)
    v_mfma_f32_32x32x16_bf16 v[32:47], a[68:71], v[100:103], v[32:47]
    s_waitcnt lgkmcnt(5)
    v_mfma_f32_32x32x16_bf16 v[48:63], a[68:71], v[104:107], v[48:63]
    s_waitcnt lgkmcnt(4)
    v_mfma_f32_32x32x16_bf16 v[64:79], a[68:71], v[108:111], v[64:79]
    ds_read_b128 v[96:99], v1 offset:19456
    ds_read_b128 v[100:103], v1 offset:52224
    ds_read_b128 v[104:107], v11 offset:19456
    ds_read_b128 v[108:111], v11 offset:52224
    s_waitcnt lgkmcnt(7)
    v_mfma_f32_32x32x16_bf16 v[16:31], a[72:75], v[80:83], v[16:31]
    s_waitcnt lgkmcnt(6)
    v_mfma_f32_32x32x16_bf16 v[32:47], a[72:75], v[84:87], v[32:47]
    s_waitcnt lgkmcnt(5)
    v_mfma_f32_32x32x16_bf16 v[48:63], a[72:75], v[88:91], v[48:63]
    s_waitcnt lgkmcnt(4)
    v_mfma_f32_32x32x16_bf16 v[64:79], a[72:75], v[92:95], v[64:79]
    s_waitcnt vmcnt(17)
    s_barrier
    ds_read_b128 v[80:83], v1 offset:20480
    ds_read_b128 v[84:87], v1 offset:53248
    ds_read_b128 v[88:91], v11 offset:20480
    ds_read_b128 v[92:95], v11 offset:53248
    s_waitcnt lgkmcnt(7)
    v_mfma_f32_32x32x16_bf16 v[16:31], a[76:79], v[96:99], v[16:31]
    s_waitcnt lgkmcnt(6)
    v_mfma_f32_32x32x16_bf16 v[32:47], a[76:79], v[100:103], v[32:47]
    s_waitcnt lgkmcnt(5)
    v_mfma_f32_32x32x16_bf16 v[48:63], a[76:79], v[104:107], v[48:63]
    s_waitcnt lgkmcnt(4)
    v_mfma_f32_32x32x16_bf16 v[64:79], a[76:79], v[108:111], v[64:79]
    ds_read_b128 v[96:99], v1 offset:21504
    ds_read_b128 v[100:103], v1 offset:54272
    ds_read_b128 v[104:107], v11 offset:21504
    ds_read_b128 v[108:111], v11 offset:54272
    s_waitcnt vmcnt(41)
    s_waitcnt lgkmcnt(7)
    v_mfma_f32_32x32x16_bf16 v[16:31], a[80:83], v[80:83], v[16:31]
    s_waitcnt vmcnt(8)
    v_add_f32 v168, v168, v170
    v_add_f32 v169, v169, v171
    s_waitcnt lgkmcnt(6)
    v_mfma_f32_32x32x16_bf16 v[32:47], a[80:83], v[84:87], v[32:47]
    v_add_f32 v168, v168, v172
    v_add_f32 v169, v169, v173
    v_add_f32 v168, v168, v174
    s_waitcnt lgkmcnt(5)
    v_mfma_f32_32x32x16_bf16 v[48:63], a[80:83], v[88:91], v[48:63]
    v_add_f32 v169, v169, v175
    v_add_f32 v168, v168, v176
    v_add_f32 v169, v169, v177
    s_waitcnt lgkmcnt(4)
    v_mfma_f32_32x32x16_bf16 v[64:79], a[80:83], v[92:95], v[64:79]
    v_add_f32 v168, v168, v178
    v_add_f32 v169, v169, v179
    v_add_f32 v168, v168, v180
    ds_read_b128 v[80:83], v1 offset:22528
    ds_read_b128 v[84:87], v1 offset:55296
    ds_read_b128 v[88:91], v11 offset:22528
    ds_read_b128 v[92:95], v11 offset:55296
    s_waitcnt lgkmcnt(7)
    v_mfma_f32_32x32x16_bf16 v[16:31], a[84:87], v[96:99], v[16:31]
    v_add_f32 v169, v169, v181
    v_add_f32 v168, v168, v182
    v_add_f32 v169, v169, v183
    s_waitcnt lgkmcnt(6)
    v_mfma_f32_32x32x16_bf16 v[32:47], a[84:87], v[100:103], v[32:47]
    v_mov_b32 v170, v168
    s_nop 1
    v_permlane32_swap_b32 v168, v170
    s_waitcnt lgkmcnt(5)
    v_mfma_f32_32x32x16_bf16 v[48:63], a[84:87], v[104:107], v[48:63]
    s_nop 1
    v_add_f32 v168, v168, v170
    s_waitcnt lgkmcnt(4)
    v_mfma_f32_32x32x16_bf16 v[64:79], a[84:87], v[108:111], v[64:79]
    v_mov_b32 v170, v169
    s_nop 1
    ds_read_b128 v[96:99], v1 offset:23552
    ds_read_b128 v[100:103], v1 offset:56320
    ds_read_b128 v[104:107], v11 offset:23552
    ds_read_b128 v[108:111], v11 offset:56320
    s_waitcnt lgkmcnt(7)
    v_mfma_f32_32x32x16_bf16 v[16:31], a[88:91], v[80:83], v[16:31]
    v_permlane32_swap_b32 v169, v170
    s_nop 1
    s_waitcnt lgkmcnt(6)
    v_mfma_f32_32x32x16_bf16 v[32:47], a[88:91], v[84:87], v[32:47]
    v_add_f32 v169, v169, v170
    v_mul_f32 v168, 0x3b000000, v168
    s_waitcnt lgkmcnt(5)
    v_mfma_f32_32x32x16_bf16 v[48:63], a[88:91], v[88:91], v[48:63]
    v_mul_f32 v169, 0x3b000000, v169
    v_fma_f32 v169, -v168, v168, v169
    s_waitcnt lgkmcnt(4)
    v_mfma_f32_32x32x16_bf16 v[64:79], a[88:91], v[92:95], v[64:79]
    v_max_f32 v169, 0, v169
    v_add_f32 v169, 0x3727c5ac, v169
    s_waitcnt vmcnt(4)
    s_barrier
    ds_read_b128 v[80:83], v1 offset:24576
    ds_read_b128 v[84:87], v1 offset:57344
    ds_read_b128 v[88:91], v11 offset:24576
    ds_read_b128 v[92:95], v11 offset:57344
    s_waitcnt lgkmcnt(7)
    v_mfma_f32_32x32x16_bf16 v[16:31], a[92:95], v[96:99], v[16:31]
    v_rsq_f32 v169, v169
    s_nop 0
    s_waitcnt lgkmcnt(6)
    v_mfma_f32_32x32x16_bf16 v[32:47], a[92:95], v[100:103], v[32:47]
    v_mul_f32 v168, v168, v169
    ds_write_b64 v12, v[168:169]
    s_waitcnt lgkmcnt(6)
    v_mfma_f32_32x32x16_bf16 v[48:63], a[92:95], v[104:107], v[48:63]
    s_waitcnt lgkmcnt(5)
    v_mfma_f32_32x32x16_bf16 v[64:79], a[92:95], v[108:111], v[64:79]
    ds_read_b128 v[96:99], v1 offset:25600
    ds_read_b128 v[100:103], v1 offset:58368
    ds_read_b128 v[104:107], v11 offset:25600
    ds_read_b128 v[108:111], v11 offset:58368
    s_waitcnt vmcnt(41)
    s_waitcnt lgkmcnt(8)
    v_mfma_f32_32x32x16_bf16 v[16:31], a[96:99], v[80:83], v[16:31]
    s_waitcnt lgkmcnt(7)
    v_mfma_f32_32x32x16_bf16 v[32:47], a[96:99], v[84:87], v[32:47]
    s_waitcnt lgkmcnt(6)
    v_mfma_f32_32x32x16_bf16 v[48:63], a[96:99], v[88:91], v[48:63]
    s_waitcnt lgkmcnt(5)
    v_mfma_f32_32x32x16_bf16 v[64:79], a[96:99], v[92:95], v[64:79]
    ds_read_b128 v[80:83], v1 offset:26624
    ds_read_b128 v[84:87], v1 offset:59392
    ds_read_b128 v[88:91], v11 offset:26624
    ds_read_b128 v[92:95], v11 offset:59392
    s_waitcnt lgkmcnt(7)
    v_mfma_f32_32x32x16_bf16 v[16:31], a[100:103], v[96:99], v[16:31]
    s_waitcnt lgkmcnt(6)
    v_mfma_f32_32x32x16_bf16 v[32:47], a[100:103], v[100:103], v[32:47]
    s_waitcnt lgkmcnt(5)
    v_mfma_f32_32x32x16_bf16 v[48:63], a[100:103], v[104:107], v[48:63]
    s_waitcnt lgkmcnt(4)
    v_mfma_f32_32x32x16_bf16 v[64:79], a[100:103], v[108:111], v[64:79]
    ds_read_b128 v[96:99], v1 offset:27648
    ds_read_b128 v[100:103], v1 offset:60416
    ds_read_b128 v[104:107], v11 offset:27648
    ds_read_b128 v[108:111], v11 offset:60416
    s_waitcnt lgkmcnt(7)
    v_mfma_f32_32x32x16_bf16 v[16:31], a[104:107], v[80:83], v[16:31]
    s_waitcnt lgkmcnt(6)
    v_mfma_f32_32x32x16_bf16 v[32:47], a[104:107], v[84:87], v[32:47]
    s_waitcnt lgkmcnt(5)
    v_mfma_f32_32x32x16_bf16 v[48:63], a[104:107], v[88:91], v[48:63]
    s_waitcnt lgkmcnt(4)
    v_mfma_f32_32x32x16_bf16 v[64:79], a[104:107], v[92:95], v[64:79]
    s_waitcnt vmcnt(0)
    s_waitcnt lgkmcnt(12)
    s_barrier
    ds_read_b64 v[144:145], v13 offset:0
    ds_read_b64 v[146:147], v13 offset:256
    ds_read_b64 v[148:149], v13 offset:512
    ds_read_b64 v[150:151], v13 offset:768
    ds_read_b128 v[80:83], v1 offset:28672
    ds_read_b128 v[84:87], v1 offset:61440
    ds_read_b128 v[88:91], v11 offset:28672
    ds_read_b128 v[92:95], v11 offset:61440
    s_waitcnt lgkmcnt(11)
    v_mfma_f32_32x32x16_bf16 v[16:31], a[108:111], v[96:99], v[16:31]
    s_waitcnt lgkmcnt(10)
    v_mfma_f32_32x32x16_bf16 v[32:47], a[108:111], v[100:103], v[32:47]
    s_waitcnt lgkmcnt(9)
    v_mfma_f32_32x32x16_bf16 v[48:63], a[108:111], v[104:107], v[48:63]
    s_waitcnt lgkmcnt(8)
    v_mfma_f32_32x32x16_bf16 v[64:79], a[108:111], v[108:111], v[64:79]
    ds_read_b128 v[96:99], v1 offset:29696
    ds_read_b128 v[100:103], v1 offset:62464
    ds_read_b128 v[104:107], v11 offset:29696
    ds_read_b128 v[108:111], v11 offset:62464
    s_waitcnt vmcnt(41)
    s_waitcnt lgkmcnt(7)
    v_mfma_f32_32x32x16_bf16 v[16:31], a[112:115], v[80:83], v[16:31]
    s_waitcnt lgkmcnt(6)
    v_mfma_f32_32x32x16_bf16 v[32:47], a[112:115], v[84:87], v[32:47]
    s_waitcnt lgkmcnt(5)
    v_mfma_f32_32x32x16_bf16 v[48:63], a[112:115], v[88:91], v[48:63]
    s_waitcnt lgkmcnt(4)
    v_mfma_f32_32x32x16_bf16 v[64:79], a[112:115], v[92:95], v[64:79]
    ds_read_b128 v[80:83], v1 offset:30720
    ds_read_b128 v[84:87], v1 offset:63488
    ds_read_b128 v[88:91], v11 offset:30720
    ds_read_b128 v[92:95], v11 offset:63488
    s_waitcnt lgkmcnt(7)
    v_mfma_f32_32x32x16_bf16 v[16:31], a[116:119], v[96:99], v[16:31]
    s_waitcnt lgkmcnt(6)
    v_mfma_f32_32x32x16_bf16 v[32:47], a[116:119], v[100:103], v[32:47]
    s_waitcnt lgkmcnt(5)
    v_mfma_f32_32x32x16_bf16 v[48:63], a[116:119], v[104:107], v[48:63]
    s_waitcnt lgkmcnt(4)
    v_mfma_f32_32x32x16_bf16 v[64:79], a[116:119], v[108:111], v[64:79]
    ds_read_b128 v[96:99], v1 offset:31744
    ds_read_b128 v[100:103], v1 offset:64512
    ds_read_b128 v[104:107], v11 offset:31744
    ds_read_b128 v[108:111], v11 offset:64512
    s_waitcnt lgkmcnt(7)
    v_mfma_f32_32x32x16_bf16 v[16:31], a[120:123], v[80:83], v[16:31]
    s_waitcnt lgkmcnt(6)
    v_mfma_f32_32x32x16_bf16 v[32:47], a[120:123], v[84:87], v[32:47]
    s_waitcnt lgkmcnt(5)
    v_mfma_f32_32x32x16_bf16 v[48:63], a[120:123], v[88:91], v[48:63]
    s_waitcnt lgkmcnt(4)
    v_mfma_f32_32x32x16_bf16 v[64:79], a[120:123], v[92:95], v[64:79]
    s_waitcnt lgkmcnt(3)
    v_mfma_f32_32x32x16_bf16 v[16:31], a[124:127], v[96:99], v[16:31]
    s_waitcnt lgkmcnt(2)
    v_mfma_f32_32x32x16_bf16 v[32:47], a[124:127], v[100:103], v[32:47]
    s_waitcnt lgkmcnt(1)
    v_mfma_f32_32x32x16_bf16 v[48:63], a[124:127], v[104:107], v[48:63]
    s_waitcnt lgkmcnt(0)
    v_mfma_f32_32x32x16_bf16 v[64:79], a[124:127], v[108:111], v[64:79]
    s_nop 15
    s_nop 3
    s_waitcnt lgkmcnt(15)
    v_mul_f32 v6, s27, v145
    v_mul_f32 v7, s27, v144
    v_pk_mul_f32 v[16:17], v[16:17], v[6:7] op_sel:[0,0] op_sel_hi:[1,0]
    v_pk_fma_f32 v[16:17], v[6:7], v[112:113], v[16:17] op_sel:[1,0,0] op_sel_hi:[1,1,1] neg_lo:[1,0,0] neg_hi:[1,0,0]
    v_pk_mul_f32 v[18:19], v[18:19], v[6:7] op_sel:[0,0] op_sel_hi:[1,0]
    v_pk_fma_f32 v[18:19], v[6:7], v[114:115], v[18:19] op_sel:[1,0,0] op_sel_hi:[1,1,1] neg_lo:[1,0,0] neg_hi:[1,0,0]
    v_pk_mul_f32 v[20:21], v[20:21], v[6:7] op_sel:[0,0] op_sel_hi:[1,0]
    v_pk_fma_f32 v[20:21], v[6:7], v[116:117], v[20:21] op_sel:[1,0,0] op_sel_hi:[1,1,1] neg_lo:[1,0,0] neg_hi:[1,0,0]
    v_pk_mul_f32 v[22:23], v[22:23], v[6:7] op_sel:[0,0] op_sel_hi:[1,0]
    v_pk_fma_f32 v[22:23], v[6:7], v[118:119], v[22:23] op_sel:[1,0,0] op_sel_hi:[1,1,1] neg_lo:[1,0,0] neg_hi:[1,0,0]
    v_pk_mul_f32 v[24:25], v[24:25], v[6:7] op_sel:[0,0] op_sel_hi:[1,0]
    v_pk_fma_f32 v[24:25], v[6:7], v[120:121], v[24:25] op_sel:[1,0,0] op_sel_hi:[1,1,1] neg_lo:[1,0,0] neg_hi:[1,0,0]
    v_pk_mul_f32 v[26:27], v[26:27], v[6:7] op_sel:[0,0] op_sel_hi:[1,0]
    v_pk_fma_f32 v[26:27], v[6:7], v[122:123], v[26:27] op_sel:[1,0,0] op_sel_hi:[1,1,1] neg_lo:[1,0,0] neg_hi:[1,0,0]
    v_pk_mul_f32 v[28:29], v[28:29], v[6:7] op_sel:[0,0] op_sel_hi:[1,0]
    v_pk_fma_f32 v[28:29], v[6:7], v[124:125], v[28:29] op_sel:[1,0,0] op_sel_hi:[1,1,1] neg_lo:[1,0,0] neg_hi:[1,0,0]
    v_pk_mul_f32 v[30:31], v[30:31], v[6:7] op_sel:[0,0] op_sel_hi:[1,0]
    v_pk_fma_f32 v[30:31], v[6:7], v[126:127], v[30:31] op_sel:[1,0,0] op_sel_hi:[1,1,1] neg_lo:[1,0,0] neg_hi:[1,0,0]
    v_cvt_pk_bf16_f32 v16, v16, v17
    v_cvt_pk_bf16_f32 v17, v18, v19
    v_cvt_pk_bf16_f32 v18, v20, v21
    v_cvt_pk_bf16_f32 v19, v22, v23
    v_cvt_pk_bf16_f32 v20, v24, v25
    v_cvt_pk_bf16_f32 v21, v26, v27
    v_cvt_pk_bf16_f32 v22, v28, v29
    v_cvt_pk_bf16_f32 v23, v30, v31
    buffer_store_dwordx4 v[16:19], v1, s[4:7], s30 offen offset:0
    buffer_store_dwordx4 v[20:23], v1, s[4:7], s31 offen offset:0
    s_waitcnt lgkmcnt(15)
    v_mul_f32 v6, s27, v147
    v_mul_f32 v7, s27, v146
    v_pk_mul_f32 v[32:33], v[32:33], v[6:7] op_sel:[0,0] op_sel_hi:[1,0]
    v_pk_fma_f32 v[32:33], v[6:7], v[112:113], v[32:33] op_sel:[1,0,0] op_sel_hi:[1,1,1] neg_lo:[1,0,0] neg_hi:[1,0,0]
    v_pk_mul_f32 v[34:35], v[34:35], v[6:7] op_sel:[0,0] op_sel_hi:[1,0]
    v_pk_fma_f32 v[34:35], v[6:7], v[114:115], v[34:35] op_sel:[1,0,0] op_sel_hi:[1,1,1] neg_lo:[1,0,0] neg_hi:[1,0,0]
    v_pk_mul_f32 v[36:37], v[36:37], v[6:7] op_sel:[0,0] op_sel_hi:[1,0]
    v_pk_fma_f32 v[36:37], v[6:7], v[116:117], v[36:37] op_sel:[1,0,0] op_sel_hi:[1,1,1] neg_lo:[1,0,0] neg_hi:[1,0,0]
    v_pk_mul_f32 v[38:39], v[38:39], v[6:7] op_sel:[0,0] op_sel_hi:[1,0]
    v_pk_fma_f32 v[38:39], v[6:7], v[118:119], v[38:39] op_sel:[1,0,0] op_sel_hi:[1,1,1] neg_lo:[1,0,0] neg_hi:[1,0,0]
    v_pk_mul_f32 v[40:41], v[40:41], v[6:7] op_sel:[0,0] op_sel_hi:[1,0]
    v_pk_fma_f32 v[40:41], v[6:7], v[120:121], v[40:41] op_sel:[1,0,0] op_sel_hi:[1,1,1] neg_lo:[1,0,0] neg_hi:[1,0,0]
    v_pk_mul_f32 v[42:43], v[42:43], v[6:7] op_sel:[0,0] op_sel_hi:[1,0]
    v_pk_fma_f32 v[42:43], v[6:7], v[122:123], v[42:43] op_sel:[1,0,0] op_sel_hi:[1,1,1] neg_lo:[1,0,0] neg_hi:[1,0,0]
    v_pk_mul_f32 v[44:45], v[44:45], v[6:7] op_sel:[0,0] op_sel_hi:[1,0]
    v_pk_fma_f32 v[44:45], v[6:7], v[124:125], v[44:45] op_sel:[1,0,0] op_sel_hi:[1,1,1] neg_lo:[1,0,0] neg_hi:[1,0,0]
    v_pk_mul_f32 v[46:47], v[46:47], v[6:7] op_sel:[0,0] op_sel_hi:[1,0]
    v_pk_fma_f32 v[46:47], v[6:7], v[126:127], v[46:47] op_sel:[1,0,0] op_sel_hi:[1,1,1] neg_lo:[1,0,0] neg_hi:[1,0,0]
    v_cvt_pk_bf16_f32 v32, v32, v33
    v_cvt_pk_bf16_f32 v33, v34, v35
    v_cvt_pk_bf16_f32 v34, v36, v37
    v_cvt_pk_bf16_f32 v35, v38, v39
    v_cvt_pk_bf16_f32 v36, v40, v41
    v_cvt_pk_bf16_f32 v37, v42, v43
    v_cvt_pk_bf16_f32 v38, v44, v45
    v_cvt_pk_bf16_f32 v39, v46, v47
    buffer_store_dwordx4 v[32:35], v1, s[4:7], s30 offen offset:1024
    buffer_store_dwordx4 v[36:39], v1, s[4:7], s31 offen offset:1024
    s_waitcnt lgkmcnt(15)
    v_mul_f32 v6, s27, v149
    v_mul_f32 v7, s27, v148
    v_pk_mul_f32 v[48:49], v[48:49], v[6:7] op_sel:[0,0] op_sel_hi:[1,0]
    v_pk_fma_f32 v[48:49], v[6:7], v[112:113], v[48:49] op_sel:[1,0,0] op_sel_hi:[1,1,1] neg_lo:[1,0,0] neg_hi:[1,0,0]
    v_pk_mul_f32 v[50:51], v[50:51], v[6:7] op_sel:[0,0] op_sel_hi:[1,0]
    v_pk_fma_f32 v[50:51], v[6:7], v[114:115], v[50:51] op_sel:[1,0,0] op_sel_hi:[1,1,1] neg_lo:[1,0,0] neg_hi:[1,0,0]
    v_pk_mul_f32 v[52:53], v[52:53], v[6:7] op_sel:[0,0] op_sel_hi:[1,0]
    v_pk_fma_f32 v[52:53], v[6:7], v[116:117], v[52:53] op_sel:[1,0,0] op_sel_hi:[1,1,1] neg_lo:[1,0,0] neg_hi:[1,0,0]
    v_pk_mul_f32 v[54:55], v[54:55], v[6:7] op_sel:[0,0] op_sel_hi:[1,0]
    v_pk_fma_f32 v[54:55], v[6:7], v[118:119], v[54:55] op_sel:[1,0,0] op_sel_hi:[1,1,1] neg_lo:[1,0,0] neg_hi:[1,0,0]
    v_pk_mul_f32 v[56:57], v[56:57], v[6:7] op_sel:[0,0] op_sel_hi:[1,0]
    v_pk_fma_f32 v[56:57], v[6:7], v[120:121], v[56:57] op_sel:[1,0,0] op_sel_hi:[1,1,1] neg_lo:[1,0,0] neg_hi:[1,0,0]
    v_pk_mul_f32 v[58:59], v[58:59], v[6:7] op_sel:[0,0] op_sel_hi:[1,0]
    v_pk_fma_f32 v[58:59], v[6:7], v[122:123], v[58:59] op_sel:[1,0,0] op_sel_hi:[1,1,1] neg_lo:[1,0,0] neg_hi:[1,0,0]
    v_pk_mul_f32 v[60:61], v[60:61], v[6:7] op_sel:[0,0] op_sel_hi:[1,0]
    v_pk_fma_f32 v[60:61], v[6:7], v[124:125], v[60:61] op_sel:[1,0,0] op_sel_hi:[1,1,1] neg_lo:[1,0,0] neg_hi:[1,0,0]
    v_pk_mul_f32 v[62:63], v[62:63], v[6:7] op_sel:[0,0] op_sel_hi:[1,0]
    v_pk_fma_f32 v[62:63], v[6:7], v[126:127], v[62:63] op_sel:[1,0,0] op_sel_hi:[1,1,1] neg_lo:[1,0,0] neg_hi:[1,0,0]
    v_cvt_pk_bf16_f32 v48, v48, v49
    v_cvt_pk_bf16_f32 v49, v50, v51
    v_cvt_pk_bf16_f32 v50, v52, v53
    v_cvt_pk_bf16_f32 v51, v54, v55
    v_cvt_pk_bf16_f32 v52, v56, v57
    v_cvt_pk_bf16_f32 v53, v58, v59
    v_cvt_pk_bf16_f32 v54, v60, v61
    v_cvt_pk_bf16_f32 v55, v62, v63
    buffer_store_dwordx4 v[48:51], v1, s[4:7], s30 offen offset:2048
    buffer_store_dwordx4 v[52:55], v1, s[4:7], s31 offen offset:2048
    s_waitcnt lgkmcnt(15)
    v_mul_f32 v6, s27, v151
    v_mul_f32 v7, s27, v150
    v_pk_mul_f32 v[64:65], v[64:65], v[6:7] op_sel:[0,0] op_sel_hi:[1,0]
    v_pk_fma_f32 v[64:65], v[6:7], v[112:113], v[64:65] op_sel:[1,0,0] op_sel_hi:[1,1,1] neg_lo:[1,0,0] neg_hi:[1,0,0]
    v_pk_mul_f32 v[66:67], v[66:67], v[6:7] op_sel:[0,0] op_sel_hi:[1,0]
    v_pk_fma_f32 v[66:67], v[6:7], v[114:115], v[66:67] op_sel:[1,0,0] op_sel_hi:[1,1,1] neg_lo:[1,0,0] neg_hi:[1,0,0]
    v_pk_mul_f32 v[68:69], v[68:69], v[6:7] op_sel:[0,0] op_sel_hi:[1,0]
    v_pk_fma_f32 v[68:69], v[6:7], v[116:117], v[68:69] op_sel:[1,0,0] op_sel_hi:[1,1,1] neg_lo:[1,0,0] neg_hi:[1,0,0]
    v_pk_mul_f32 v[70:71], v[70:71], v[6:7] op_sel:[0,0] op_sel_hi:[1,0]
    v_pk_fma_f32 v[70:71], v[6:7], v[118:119], v[70:71] op_sel:[1,0,0] op_sel_hi:[1,1,1] neg_lo:[1,0,0] neg_hi:[1,0,0]
    v_pk_mul_f32 v[72:73], v[72:73], v[6:7] op_sel:[0,0] op_sel_hi:[1,0]
    v_pk_fma_f32 v[72:73], v[6:7], v[120:121], v[72:73] op_sel:[1,0,0] op_sel_hi:[1,1,1] neg_lo:[1,0,0] neg_hi:[1,0,0]
    v_pk_mul_f32 v[74:75], v[74:75], v[6:7] op_sel:[0,0] op_sel_hi:[1,0]
    v_pk_fma_f32 v[74:75], v[6:7], v[122:123], v[74:75] op_sel:[1,0,0] op_sel_hi:[1,1,1] neg_lo:[1,0,0] neg_hi:[1,0,0]
    v_pk_mul_f32 v[76:77], v[76:77], v[6:7] op_sel:[0,0] op_sel_hi:[1,0]
    v_pk_fma_f32 v[76:77], v[6:7], v[124:125], v[76:77] op_sel:[1,0,0] op_sel_hi:[1,1,1] neg_lo:[1,0,0] neg_hi:[1,0,0]
    v_pk_mul_f32 v[78:79], v[78:79], v[6:7] op_sel:[0,0] op_sel_hi:[1,0]
    v_pk_fma_f32 v[78:79], v[6:7], v[126:127], v[78:79] op_sel:[1,0,0] op_sel_hi:[1,1,1] neg_lo:[1,0,0] neg_hi:[1,0,0]
    v_cvt_pk_bf16_f32 v64, v64, v65
    v_cvt_pk_bf16_f32 v65, v66, v67
    v_cvt_pk_bf16_f32 v66, v68, v69
    v_cvt_pk_bf16_f32 v67, v70, v71
    v_cvt_pk_bf16_f32 v68, v72, v73
    v_cvt_pk_bf16_f32 v69, v74, v75
    v_cvt_pk_bf16_f32 v70, v76, v77
    v_cvt_pk_bf16_f32 v71, v78, v79
    buffer_store_dwordx4 v[64:67], v1, s[4:7], s30 offen offset:3072
    buffer_store_dwordx4 v[68:71], v1, s[4:7], s31 offen offset:3072
    s_branch L_chain1_kernel_fin
L_qkv_17_v:
    v_lshlrev_b32 v7, 5, v5
    v_add_u32 v7, 131072, v7
    v_lshrrev_b32 v8, 4, v4
    v_lshlrev_b32 v8, 16, v8
    v_and_b32 v9, 15, v4
    v_lshl_add_u32 v9, v5, 4, v9
    v_lshl_add_u32 v8, v9, 4, v8
    s_sub_u32 s30, s19, 32
    s_lshl_b32 s30, s30, 7
    s_add_u32 s30, s30, s8
    s_lshl_b32 s30, s30, 10
    s_add_u32 s30, s30, 12345344
    s_waitcnt vmcnt(12)
    s_barrier
    ds_read_b128 v[80:83], v1 offset:0
    ds_read_b128 v[84:87], v1 offset:32768
    ds_read_b128 v[88:91], v11 offset:0
    ds_read_b128 v[92:95], v11 offset:32768
    ds_read_b128 v[96:99], v1 offset:1024
    ds_read_b128 v[100:103], v1 offset:33792
    ds_read_b128 v[104:107], v11 offset:1024
    ds_read_b128 v[108:111], v11 offset:33792
    s_waitcnt vmcnt(16)
    s_waitcnt lgkmcnt(7)
    v_mfma_f32_32x32x16_bf16 v[16:31], v[80:83], a[0:3], 0
    s_add_u32 m0, s12, 16384
    s_waitcnt lgkmcnt(6)
    v_mfma_f32_32x32x16_bf16 v[32:47], v[84:87], a[0:3], 0
    s_nop 0
    s_waitcnt lgkmcnt(5)
    v_mfma_f32_32x32x16_bf16 v[48:63], v[88:91], a[0:3], 0
    buffer_load_dwordx4 v1, s[4:7], s10 offen offset:0 sc1 lds
    s_waitcnt lgkmcnt(4)
    v_mfma_f32_32x32x16_bf16 v[64:79], v[92:95], a[0:3], 0
    buffer_load_dwordx4 v1, s[4:7], s10 offen offset:1024 sc1 lds
    ds_read_b128 v[80:83], v1 offset:2048
    ds_read_b128 v[84:87], v1 offset:34816
    ds_read_b128 v[88:91], v11 offset:2048
    ds_read_b128 v[92:95], v11 offset:34816
    s_waitcnt lgkmcnt(7)
    v_mfma_f32_32x32x16_bf16 v[16:31], v[96:99], a[4:7], v[16:31]
    buffer_load_dwordx4 v1, s[4:7], s10 offen offset:2048 sc1 lds
    s_waitcnt lgkmcnt(6)
    v_mfma_f32_32x32x16_bf16 v[32:47], v[100:103], a[4:7], v[32:47]
    buffer_load_dwordx4 v1, s[4:7], s10 offen offset:3072 sc1 lds
    s_waitcnt lgkmcnt(5)
    v_mfma_f32_32x32x16_bf16 v[48:63], v[104:107], a[4:7], v[48:63]
    s_add_u32 s10, s10, 4096
    s_waitcnt lgkmcnt(4)
    v_mfma_f32_32x32x16_bf16 v[64:79], v[108:111], a[4:7], v[64:79]
    ds_read_b128 v[96:99], v1 offset:3072
    ds_read_b128 v[100:103], v1 offset:35840
    ds_read_b128 v[104:107], v11 offset:3072
    ds_read_b128 v[108:111], v11 offset:35840
    s_waitcnt lgkmcnt(7)
    v_mfma_f32_32x32x16_bf16 v[16:31], v[80:83], a[8:11], v[16:31]
    s_waitcnt lgkmcnt(6)
    v_mfma_f32_32x32x16_bf16 v[32:47], v[84:87], a[8:11], v[32:47]
    s_waitcnt lgkmcnt(5)
    v_mfma_f32_32x32x16_bf16 v[48:63], v[88:91], a[8:11], v[48:63]
    s_waitcnt lgkmcnt(4)
    v_mfma_f32_32x32x16_bf16 v[64:79], v[92:95], a[8:11], v[64:79]
    s_waitcnt vmcnt(12)
    s_barrier
    ds_read_b128 v[80:83], v1 offset:4096
    ds_read_b128 v[84:87], v1 offset:36864
    ds_read_b128 v[88:91], v11 offset:4096
    ds_read_b128 v[92:95], v11 offset:36864
    s_waitcnt lgkmcnt(7)
    v_mfma_f32_32x32x16_bf16 v[16:31], v[96:99], a[12:15], v[16:31]
    s_waitcnt lgkmcnt(6)
    v_mfma_f32_32x32x16_bf16 v[32:47], v[100:103], a[12:15], v[32:47]
    s_waitcnt lgkmcnt(5)
    v_mfma_f32_32x32x16_bf16 v[48:63], v[104:107], a[12:15], v[48:63]
    s_waitcnt lgkmcnt(4)
    v_mfma_f32_32x32x16_bf16 v[64:79], v[108:111], a[12:15], v[64:79]
    ds_read_b128 v[96:99], v1 offset:5120
    ds_read_b128 v[100:103], v1 offset:37888
    ds_read_b128 v[104:107], v11 offset:5120
    ds_read_b128 v[108:111], v11 offset:37888
    s_waitcnt vmcnt(20)
    s_waitcnt lgkmcnt(7)
    v_mfma_f32_32x32x16_bf16 v[16:31], v[80:83], a[16:19], v[16:31]
    s_add_u32 m0, s12, 20480
    s_nop 0
    buffer_load_dwordx4 v1, s[4:7], s10 offen offset:0 sc1 lds
    s_waitcnt lgkmcnt(6)
    v_mfma_f32_32x32x16_bf16 v[32:47], v[84:87], a[16:19], v[32:47]
    buffer_load_dwordx4 v1, s[4:7], s10 offen offset:1024 sc1 lds
    buffer_load_dwordx4 v1, s[4:7], s10 offen offset:2048 sc1 lds
    s_waitcnt lgkmcnt(5)
    v_mfma_f32_32x32x16_bf16 v[48:63], v[88:91], a[16:19], v[48:63]
    buffer_load_dwordx4 v1, s[4:7], s10 offen offset:3072 sc1 lds
    s_add_u32 s10, s10, 4096
    s_waitcnt lgkmcnt(4)
    v_mfma_f32_32x32x16_bf16 v[64:79], v[92:95], a[16:19], v[64:79]
    s_add_u32 s21, s8, s3
    s_lshl_b32 s21, s21, 12
    ds_read_b128 v[80:83], v1 offset:6144
    ds_read_b128 v[84:87], v1 offset:38912
    ds_read_b128 v[88:91], v11 offset:6144
    ds_read_b128 v[92:95], v11 offset:38912
    s_waitcnt lgkmcnt(7)
    v_mfma_f32_32x32x16_bf16 v[16:31], v[96:99], a[20:23], v[16:31]
    s_add_u32 s21, s21, 28336128
    buffer_load_dwordx4 v[168:171], v1, s[4:7], s21 offen offset:0 sc1
    s_waitcnt lgkmcnt(6)
    v_mfma_f32_32x32x16_bf16 v[32:47], v[100:103], a[20:23], v[32:47]
    buffer_load_dwordx4 v[172:175], v1, s[4:7], s21 offen offset:1024 sc1
    buffer_load_dwordx4 v[176:179], v1, s[4:7], s21 offen offset:2048 sc1
    s_waitcnt lgkmcnt(5)
    v_mfma_f32_32x32x16_bf16 v[48:63], v[104:107], a[20:23], v[48:63]
    buffer_load_dwordx4 v[180:183], v1, s[4:7], s21 offen offset:3072 sc1
    v_lshlrev_b32 v14, 6, v5
    s_waitcnt lgkmcnt(4)
    v_mfma_f32_32x32x16_bf16 v[64:79], v[108:111], a[20:23], v[64:79]
    s_lshl_b32 s22, s19, 7
    s_add_u32 s22, s22, 5767168
    ds_read_b128 v[96:99], v1 offset:7168
    ds_read_b128 v[100:103], v1 offset:39936
    ds_read_b128 v[104:107], v11 offset:7168
    ds_read_b128 v[108:111], v11 offset:39936
    s_waitcnt lgkmcnt(7)
    v_mfma_f32_32x32x16_bf16 v[16:31], v[80:83], a[24:27], v[16:31]
    buffer_load_dwordx4 v[112:115], v14, s[4:7], s22 offen offset:0
    buffer_load_dwordx4 v[116:119], v14, s[4:7], s22 offen offset:16
    s_waitcnt lgkmcnt(6)
    v_mfma_f32_32x32x16_bf16 v[32:47], v[84:87], a[24:27], v[32:47]
    buffer_load_dwordx4 v[120:123], v14, s[4:7], s22 offen offset:32
    buffer_load_dwordx4 v[124:127], v14, s[4:7], s22 offen offset:48
    s_waitcnt lgkmcnt(5)
    v_mfma_f32_32x32x16_bf16 v[48:63], v[88:91], a[24:27], v[48:63]
    v_bfe_u32 v15, v4, 2, 1
    v_lshlrev_b32 v15, 4, v15
    s_waitcnt lgkmcnt(4)
    v_mfma_f32_32x32x16_bf16 v[64:79], v[92:95], a[24:27], v[64:79]
    v_lshrrev_b32 v3, 3, v4
    v_lshl_add_u32 v15, v3, 2, v15
    s_waitcnt vmcnt(20)
    s_barrier
    ds_read_b128 v[80:83], v1 offset:8192
    ds_read_b128 v[84:87], v1 offset:40960
    ds_read_b128 v[88:91], v11 offset:8192
    ds_read_b128 v[92:95], v11 offset:40960
    s_waitcnt lgkmcnt(7)
    v_mfma_f32_32x32x16_bf16 v[16:31], v[96:99], a[28:31], v[16:31]
    v_and_b32 v3, 3, v4
    v_add_u32 v15, v15, v3
    s_waitcnt lgkmcnt(6)
    v_mfma_f32_32x32x16_bf16 v[32:47], v[100:103], a[28:31], v[32:47]
    v_lshlrev_b32 v15, 2, v15
    buffer_load_dword v128, v15, s[4:7], s22 offen
    s_waitcnt lgkmcnt(5)
    v_mfma_f32_32x32x16_bf16 v[48:63], v[104:107], a[28:31], v[48:63]
    s_waitcnt lgkmcnt(4)
    v_mfma_f32_32x32x16_bf16 v[64:79], v[108:111], a[28:31], v[64:79]
    ds_read_b128 v[96:99], v1 offset:9216
    ds_read_b128 v[100:103], v1 offset:41984
    ds_read_b128 v[104:107], v11 offset:9216
    ds_read_b128 v[108:111], v11 offset:41984
    s_waitcnt vmcnt(33)
    s_waitcnt lgkmcnt(7)
    v_mfma_f32_32x32x16_bf16 v[16:31], v[80:83], a[32:35], v[16:31]
    s_add_u32 m0, s12, 24576
    s_waitcnt lgkmcnt(6)
    v_mfma_f32_32x32x16_bf16 v[32:47], v[84:87], a[32:35], v[32:47]
    s_nop 0
    s_waitcnt lgkmcnt(5)
    v_mfma_f32_32x32x16_bf16 v[48:63], v[88:91], a[32:35], v[48:63]
    buffer_load_dwordx4 v1, s[4:7], s10 offen offset:0 sc1 lds
    s_waitcnt lgkmcnt(4)
    v_mfma_f32_32x32x16_bf16 v[64:79], v[92:95], a[32:35], v[64:79]
    buffer_load_dwordx4 v1, s[4:7], s10 offen offset:1024 sc1 lds
    ds_read_b128 v[80:83], v1 offset:10240
    ds_read_b128 v[84:87], v1 offset:43008
    ds_read_b128 v[88:91], v11 offset:10240
    ds_read_b128 v[92:95], v11 offset:43008
    s_waitcnt lgkmcnt(7)
    v_mfma_f32_32x32x16_bf16 v[16:31], v[96:99], a[36:39], v[16:31]
    buffer_load_dwordx4 v1, s[4:7], s10 offen offset:2048 sc1 lds
    s_waitcnt lgkmcnt(6)
    v_mfma_f32_32x32x16_bf16 v[32:47], v[100:103], a[36:39], v[32:47]
    buffer_load_dwordx4 v1, s[4:7], s10 offen offset:3072 sc1 lds
    s_waitcnt lgkmcnt(5)
    v_mfma_f32_32x32x16_bf16 v[48:63], v[104:107], a[36:39], v[48:63]
    s_add_u32 s10, s10, 4096
    s_waitcnt lgkmcnt(4)
    v_mfma_f32_32x32x16_bf16 v[64:79], v[108:111], a[36:39], v[64:79]
    ds_read_b128 v[96:99], v1 offset:11264
    ds_read_b128 v[100:103], v1 offset:44032
    ds_read_b128 v[104:107], v11 offset:11264
    ds_read_b128 v[108:111], v11 offset:44032
    s_waitcnt lgkmcnt(7)
    v_mfma_f32_32x32x16_bf16 v[16:31], v[80:83], a[40:43], v[16:31]
    s_waitcnt lgkmcnt(6)
    v_mfma_f32_32x32x16_bf16 v[32:47], v[84:87], a[40:43], v[32:47]
    s_waitcnt lgkmcnt(5)
    v_mfma_f32_32x32x16_bf16 v[48:63], v[88:91], a[40:43], v[48:63]
    s_waitcnt lgkmcnt(4)
    v_mfma_f32_32x32x16_bf16 v[64:79], v[92:95], a[40:43], v[64:79]
    s_waitcnt vmcnt(21)
    s_barrier
    ds_read_b128 v[80:83], v1 offset:12288
    ds_read_b128 v[84:87], v1 offset:45056
    ds_read_b128 v[88:91], v11 offset:12288
    ds_read_b128 v[92:95], v11 offset:45056
    s_waitcnt lgkmcnt(7)
    v_mfma_f32_32x32x16_bf16 v[16:31], v[96:99], a[44:47], v[16:31]
    s_waitcnt lgkmcnt(6)
    v_mfma_f32_32x32x16_bf16 v[32:47], v[100:103], a[44:47], v[32:47]
    s_waitcnt lgkmcnt(5)
    v_mfma_f32_32x32x16_bf16 v[48:63], v[104:107], a[44:47], v[48:63]
    s_waitcnt lgkmcnt(4)
    v_mfma_f32_32x32x16_bf16 v[64:79], v[108:111], a[44:47], v[64:79]
    ds_read_b128 v[96:99], v1 offset:13312
    ds_read_b128 v[100:103], v1 offset:46080
    ds_read_b128 v[104:107], v11 offset:13312
    ds_read_b128 v[108:111], v11 offset:46080
    s_waitcnt vmcnt(37)
    s_waitcnt lgkmcnt(7)
    v_mfma_f32_32x32x16_bf16 v[16:31], v[80:83], a[48:51], v[16:31]
    s_add_u32 m0, s12, 28672
    s_waitcnt lgkmcnt(6)
    v_mfma_f32_32x32x16_bf16 v[32:47], v[84:87], a[48:51], v[32:47]
    s_nop 0
    s_waitcnt lgkmcnt(5)
    v_mfma_f32_32x32x16_bf16 v[48:63], v[88:91], a[48:51], v[48:63]
    buffer_load_dwordx4 v1, s[4:7], s10 offen offset:0 sc1 lds
    s_waitcnt lgkmcnt(4)
    v_mfma_f32_32x32x16_bf16 v[64:79], v[92:95], a[48:51], v[64:79]
    buffer_load_dwordx4 v1, s[4:7], s10 offen offset:1024 sc1 lds
    ds_read_b128 v[80:83], v1 offset:14336
    ds_read_b128 v[84:87], v1 offset:47104
    ds_read_b128 v[88:91], v11 offset:14336
    ds_read_b128 v[92:95], v11 offset:47104
    s_waitcnt lgkmcnt(7)
    v_mfma_f32_32x32x16_bf16 v[16:31], v[96:99], a[52:55], v[16:31]
    buffer_load_dwordx4 v1, s[4:7], s10 offen offset:2048 sc1 lds
    s_waitcnt lgkmcnt(6)
    v_mfma_f32_32x32x16_bf16 v[32:47], v[100:103], a[52:55], v[32:47]
    buffer_load_dwordx4 v1, s[4:7], s10 offen offset:3072 sc1 lds
    s_waitcnt lgkmcnt(5)
    v_mfma_f32_32x32x16_bf16 v[48:63], v[104:107], a[52:55], v[48:63]
    s_add_u32 s10, s10, 4096
    s_waitcnt lgkmcnt(4)
    v_mfma_f32_32x32x16_bf16 v[64:79], v[108:111], a[52:55], v[64:79]
    ds_read_b128 v[96:99], v1 offset:15360
    ds_read_b128 v[100:103], v1 offset:48128
    ds_read_b128 v[104:107], v11 offset:15360
    ds_read_b128 v[108:111], v11 offset:48128
    s_waitcnt lgkmcnt(7)
    v_mfma_f32_32x32x16_bf16 v[16:31], v[80:83], a[56:59], v[16:31]
    s_waitcnt lgkmcnt(6)
    v_mfma_f32_32x32x16_bf16 v[32:47], v[84:87], a[56:59], v[32:47]
    s_waitcnt lgkmcnt(5)
    v_mfma_f32_32x32x16_bf16 v[48:63], v[88:91], a[56:59], v[48:63]
    s_waitcnt lgkmcnt(4)
    v_mfma_f32_32x32x16_bf16 v[64:79], v[92:95], a[56:59], v[64:79]
    s_waitcnt vmcnt(21)
    s_barrier
    ds_read_b128 v[80:83], v1 offset:16384
    ds_read_b128 v[84:87], v1 offset:49152
    ds_read_b128 v[88:91], v11 offset:16384
    ds_read_b128 v[92:95], v11 offset:49152
    s_waitcnt lgkmcnt(7)
    v_mfma_f32_32x32x16_bf16 v[16:31], v[96:99], a[60:63], v[16:31]
    s_waitcnt lgkmcnt(6)
    v_mfma_f32_32x32x16_bf16 v[32:47], v[100:103], a[60:63], v[32:47]
    s_waitcnt lgkmcnt(5)
    v_mfma_f32_32x32x16_bf16 v[48:63], v[104:107], a[60:63], v[48:63]
    s_waitcnt lgkmcnt(4)
    v_mfma_f32_32x32x16_bf16 v[64:79], v[108:111], a[60:63], v[64:79]
    ds_read_b128 v[96:99], v1 offset:17408
    ds_read_b128 v[100:103], v1 offset:50176
    ds_read_b128 v[104:107], v11 offset:17408
    ds_read_b128 v[108:111], v11 offset:50176
    s_waitcnt vmcnt(41)
    s_waitcnt lgkmcnt(7)
    v_mfma_f32_32x32x16_bf16 v[16:31], v[80:83], a[64:67], v[16:31]
    s_waitcnt lgkmcnt(6)
    v_mfma_f32_32x32x16_bf16 v[32:47], v[84:87], a[64:67], v[32:47]
    s_waitcnt lgkmcnt(5)
    v_mfma_f32_32x32x16_bf16 v[48:63], v[88:91], a[64:67], v[48:63]
    s_waitcnt lgkmcnt(4)
    v_mfma_f32_32x32x16_bf16 v[64:79], v[92:95], a[64:67], v[64:79]
    ds_read_b128 v[80:83], v1 offset:18432
    ds_read_b128 v[84:87], v1 offset:51200
    ds_read_b128 v[88:91], v11 offset:18432
    ds_read_b128 v[92:95], v11 offset:51200
    s_waitcnt lgkmcnt(7)
    v_mfma_f32_32x32x16_bf16 v[16:31], v[96:99], a[68:71], v[16:31]
    s_waitcnt lgkmcnt(6)
    v_mfma_f32_32x32x16_bf16 v[32:47], v[100:103], a[68:71], v[32:47]
    s_waitcnt lgkmcnt(5)
    v_mfma_f32_32x32x16_bf16 v[48:63], v[104:107], a[68:71], v[48:63]
    s_waitcnt lgkmcnt(4)
    v_mfma_f32_32x32x16_bf16 v[64:79], v[108:111], a[68:71], v[64:79]
    ds_read_b128 v[96:99], v1 offset:19456
    ds_read_b128 v[100:103], v1 offset:52224
    ds_read_b128 v[104:107], v11 offset:19456
    ds_read_b128 v[108:111], v11 offset:52224
    s_waitcnt lgkmcnt(7)
    v_mfma_f32_32x32x16_bf16 v[16:31], v[80:83], a[72:75], v[16:31]
    s_waitcnt lgkmcnt(6)
    v_mfma_f32_32x32x16_bf16 v[32:47], v[84:87], a[72:75], v[32:47]
    s_waitcnt lgkmcnt(5)
    v_mfma_f32_32x32x16_bf16 v[48:63], v[88:91], a[72:75], v[48:63]
    s_waitcnt lgkmcnt(4)
    v_mfma_f32_32x32x16_bf16 v[64:79], v[92:95], a[72:75], v[64:79]
    s_waitcnt vmcnt(17)
    s_barrier
    ds_read_b128 v[80:83], v1 offset:20480
    ds_read_b128 v[84:87], v1 offset:53248
    ds_read_b128 v[88:91], v11 offset:20480
    ds_read_b128 v[92:95], v11 offset:53248
    s_waitcnt lgkmcnt(7)
    v_mfma_f32_32x32x16_bf16 v[16:31], v[96:99], a[76:79], v[16:31]
    s_waitcnt lgkmcnt(6)
    v_mfma_f32_32x32x16_bf16 v[32:47], v[100:103], a[76:79], v[32:47]
    s_waitcnt lgkmcnt(5)
    v_mfma_f32_32x32x16_bf16 v[48:63], v[104:107], a[76:79], v[48:63]
    s_waitcnt lgkmcnt(4)
    v_mfma_f32_32x32x16_bf16 v[64:79], v[108:111], a[76:79], v[64:79]
    ds_read_b128 v[96:99], v1 offset:21504
    ds_read_b128 v[100:103], v1 offset:54272
    ds_read_b128 v[104:107], v11 offset:21504
    ds_read_b128 v[108:111], v11 offset:54272
    s_waitcnt vmcnt(41)
    s_waitcnt lgkmcnt(7)
    v_mfma_f32_32x32x16_bf16 v[16:31], v[80:83], a[80:83], v[16:31]
    s_waitcnt vmcnt(8)
    v_add_f32 v168, v168, v170
    v_add_f32 v169, v169, v171
    s_waitcnt lgkmcnt(6)
    v_mfma_f32_32x32x16_bf16 v[32:47], v[84:87], a[80:83], v[32:47]
    v_add_f32 v168, v168, v172
    v_add_f32 v169, v169, v173
    v_add_f32 v168, v168, v174
    s_waitcnt lgkmcnt(5)
    v_mfma_f32_32x32x16_bf16 v[48:63], v[88:91], a[80:83], v[48:63]
    v_add_f32 v169, v169, v175
    v_add_f32 v168, v168, v176
    v_add_f32 v169, v169, v177
    s_waitcnt lgkmcnt(4)
    v_mfma_f32_32x32x16_bf16 v[64:79], v[92:95], a[80:83], v[64:79]
    v_add_f32 v168, v168, v178
    v_add_f32 v169, v169, v179
    v_add_f32 v168, v168, v180
    ds_read_b128 v[80:83], v1 offset:22528
    ds_read_b128 v[84:87], v1 offset:55296
    ds_read_b128 v[88:91], v11 offset:22528
    ds_read_b128 v[92:95], v11 offset:55296
    s_waitcnt lgkmcnt(7)
    v_mfma_f32_32x32x16_bf16 v[16:31], v[96:99], a[84:87], v[16:31]
    v_add_f32 v169, v169, v181
    v_add_f32 v168, v168, v182
    v_add_f32 v169, v169, v183
    s_waitcnt lgkmcnt(6)
    v_mfma_f32_32x32x16_bf16 v[32:47], v[100:103], a[84:87], v[32:47]
    v_mov_b32 v170, v168
    s_nop 1
    v_permlane32_swap_b32 v168, v170
    s_waitcnt lgkmcnt(5)
    v_mfma_f32_32x32x16_bf16 v[48:63], v[104:107], a[84:87], v[48:63]
    s_nop 1
    v_add_f32 v168, v168, v170
    s_waitcnt lgkmcnt(4)
    v_mfma_f32_32x32x16_bf16 v[64:79], v[108:111], a[84:87], v[64:79]
    v_mov_b32 v170, v169
    s_nop 1
    ds_read_b128 v[96:99], v1 offset:23552
    ds_read_b128 v[100:103], v1 offset:56320
    ds_read_b128 v[104:107], v11 offset:23552
    ds_read_b128 v[108:111], v11 offset:56320
    s_waitcnt lgkmcnt(7)
    v_mfma_f32_32x32x16_bf16 v[16:31], v[80:83], a[88:91], v[16:31]
    v_permlane32_swap_b32 v169, v170
    s_nop 1
    s_waitcnt lgkmcnt(6)
    v_mfma_f32_32x32x16_bf16 v[32:47], v[84:87], a[88:91], v[32:47]
    v_add_f32 v169, v169, v170
    v_mul_f32 v168, 0x3b000000, v168
    s_waitcnt lgkmcnt(5)
    v_mfma_f32_32x32x16_bf16 v[48:63], v[88:91], a[88:91], v[48:63]
    v_mul_f32 v169, 0x3b000000, v169
    v_fma_f32 v169, -v168, v168, v169
    s_waitcnt lgkmcnt(4)
    v_mfma_f32_32x32x16_bf16 v[64:79], v[92:95], a[88:91], v[64:79]
    v_max_f32 v169, 0, v169
    v_add_f32 v169, 0x3727c5ac, v169
    s_waitcnt vmcnt(4)
    s_barrier
    ds_read_b128 v[80:83], v1 offset:24576
    ds_read_b128 v[84:87], v1 offset:57344
    ds_read_b128 v[88:91], v11 offset:24576
    ds_read_b128 v[92:95], v11 offset:57344
    s_waitcnt lgkmcnt(7)
    v_mfma_f32_32x32x16_bf16 v[16:31], v[96:99], a[92:95], v[16:31]
    v_rsq_f32 v169, v169
    s_nop 0
    s_waitcnt lgkmcnt(6)
    v_mfma_f32_32x32x16_bf16 v[32:47], v[100:103], a[92:95], v[32:47]
    v_mul_f32 v168, v168, v169
    ds_write_b64 v12, v[168:169]
    s_waitcnt lgkmcnt(6)
    v_mfma_f32_32x32x16_bf16 v[48:63], v[104:107], a[92:95], v[48:63]
    s_waitcnt lgkmcnt(5)
    v_mfma_f32_32x32x16_bf16 v[64:79], v[108:111], a[92:95], v[64:79]
    ds_read_b128 v[96:99], v1 offset:25600
    ds_read_b128 v[100:103], v1 offset:58368
    ds_read_b128 v[104:107], v11 offset:25600
    ds_read_b128 v[108:111], v11 offset:58368
    s_waitcnt vmcnt(41)
    s_waitcnt lgkmcnt(8)
    v_mfma_f32_32x32x16_bf16 v[16:31], v[80:83], a[96:99], v[16:31]
    s_waitcnt lgkmcnt(7)
    v_mfma_f32_32x32x16_bf16 v[32:47], v[84:87], a[96:99], v[32:47]
    s_waitcnt lgkmcnt(6)
    v_mfma_f32_32x32x16_bf16 v[48:63], v[88:91], a[96:99], v[48:63]
    s_waitcnt lgkmcnt(5)
    v_mfma_f32_32x32x16_bf16 v[64:79], v[92:95], a[96:99], v[64:79]
    ds_read_b128 v[80:83], v1 offset:26624
    ds_read_b128 v[84:87], v1 offset:59392
    ds_read_b128 v[88:91], v11 offset:26624
    ds_read_b128 v[92:95], v11 offset:59392
    s_waitcnt lgkmcnt(7)
    v_mfma_f32_32x32x16_bf16 v[16:31], v[96:99], a[100:103], v[16:31]
    s_waitcnt lgkmcnt(6)
    v_mfma_f32_32x32x16_bf16 v[32:47], v[100:103], a[100:103], v[32:47]
    s_waitcnt lgkmcnt(5)
    v_mfma_f32_32x32x16_bf16 v[48:63], v[104:107], a[100:103], v[48:63]
    s_waitcnt lgkmcnt(4)
    v_mfma_f32_32x32x16_bf16 v[64:79], v[108:111], a[100:103], v[64:79]
    ds_read_b128 v[96:99], v1 offset:27648
    ds_read_b128 v[100:103], v1 offset:60416
    ds_read_b128 v[104:107], v11 offset:27648
    ds_read_b128 v[108:111], v11 offset:60416
    s_waitcnt lgkmcnt(7)
    v_mfma_f32_32x32x16_bf16 v[16:31], v[80:83], a[104:107], v[16:31]
    s_waitcnt lgkmcnt(6)
    v_mfma_f32_32x32x16_bf16 v[32:47], v[84:87], a[104:107], v[32:47]
    s_waitcnt lgkmcnt(5)
    v_mfma_f32_32x32x16_bf16 v[48:63], v[88:91], a[104:107], v[48:63]
    s_waitcnt lgkmcnt(4)
    v_mfma_f32_32x32x16_bf16 v[64:79], v[92:95], a[104:107], v[64:79]
    s_waitcnt vmcnt(0)
    s_waitcnt lgkmcnt(12)
    s_barrier
    ds_read_b128 v[80:83], v1 offset:28672
    ds_read_b128 v[84:87], v1 offset:61440
    ds_read_b128 v[88:91], v11 offset:28672
    ds_read_b128 v[92:95], v11 offset:61440
    s_waitcnt lgkmcnt(7)
    v_mfma_f32_32x32x16_bf16 v[16:31], v[96:99], a[108:111], v[16:31]
    s_waitcnt lgkmcnt(6)
    v_mfma_f32_32x32x16_bf16 v[32:47], v[100:103], a[108:111], v[32:47]
    s_waitcnt lgkmcnt(5)
    v_mfma_f32_32x32x16_bf16 v[48:63], v[104:107], a[108:111], v[48:63]
    s_waitcnt lgkmcnt(4)
    v_mfma_f32_32x32x16_bf16 v[64:79], v[108:111], a[108:111], v[64:79]
    ds_read_b128 v[96:99], v1 offset:29696
    ds_read_b128 v[100:103], v1 offset:62464
    ds_read_b128 v[104:107], v11 offset:29696
    ds_read_b128 v[108:111], v11 offset:62464
    s_waitcnt vmcnt(41)
    s_waitcnt lgkmcnt(7)
    v_mfma_f32_32x32x16_bf16 v[16:31], v[80:83], a[112:115], v[16:31]
    s_waitcnt lgkmcnt(6)
    v_mfma_f32_32x32x16_bf16 v[32:47], v[84:87], a[112:115], v[32:47]
    s_waitcnt lgkmcnt(5)
    v_mfma_f32_32x32x16_bf16 v[48:63], v[88:91], a[112:115], v[48:63]
    s_waitcnt lgkmcnt(4)
    v_mfma_f32_32x32x16_bf16 v[64:79], v[92:95], a[112:115], v[64:79]
    ds_read_b128 v[80:83], v1 offset:30720
    ds_read_b128 v[84:87], v1 offset:63488
    ds_read_b128 v[88:91], v11 offset:30720
    ds_read_b128 v[92:95], v11 offset:63488
    s_waitcnt lgkmcnt(7)
    v_mfma_f32_32x32x16_bf16 v[16:31], v[96:99], a[116:119], v[16:31]
    s_waitcnt lgkmcnt(6)
    v_mfma_f32_32x32x16_bf16 v[32:47], v[100:103], a[116:119], v[32:47]
    s_waitcnt lgkmcnt(5)
    v_mfma_f32_32x32x16_bf16 v[48:63], v[104:107], a[116:119], v[48:63]
    s_waitcnt lgkmcnt(4)
    v_mfma_f32_32x32x16_bf16 v[64:79], v[108:111], a[116:119], v[64:79]
    ds_read_b128 v[96:99], v1 offset:31744
    ds_read_b128 v[100:103], v1 offset:64512
    ds_read_b128 v[104:107], v11 offset:31744
    ds_read_b128 v[108:111], v11 offset:64512
    s_waitcnt lgkmcnt(7)
    v_mfma_f32_32x32x16_bf16 v[16:31], v[80:83], a[120:123], v[16:31]
    s_waitcnt lgkmcnt(6)
    v_mfma_f32_32x32x16_bf16 v[32:47], v[84:87], a[120:123], v[32:47]
    s_waitcnt lgkmcnt(5)
    v_mfma_f32_32x32x16_bf16 v[48:63], v[88:91], a[120:123], v[48:63]
    s_waitcnt lgkmcnt(4)
    v_mfma_f32_32x32x16_bf16 v[64:79], v[92:95], a[120:123], v[64:79]
    s_waitcnt lgkmcnt(3)
    v_mfma_f32_32x32x16_bf16 v[16:31], v[96:99], a[124:127], v[16:31]
    s_waitcnt lgkmcnt(2)
    v_mfma_f32_32x32x16_bf16 v[32:47], v[100:103], a[124:127], v[32:47]
    s_waitcnt lgkmcnt(1)
    v_mfma_f32_32x32x16_bf16 v[48:63], v[104:107], a[124:127], v[48:63]
    s_waitcnt lgkmcnt(0)
    v_mfma_f32_32x32x16_bf16 v[64:79], v[108:111], a[124:127], v[64:79]
    s_nop 15
    s_nop 3
    ds_read_b128 v[184:187], v7 offset:0
    ds_read_b128 v[188:191], v7 offset:16
    ds_read_b128 v[192:195], v7 offset:64
    ds_read_b128 v[196:199], v7 offset:80
    ds_read_b128 v[200:203], v7 offset:128
    ds_read_b128 v[204:207], v7 offset:144
    ds_read_b128 v[208:211], v7 offset:192
    ds_read_b128 v[212:215], v7 offset:208
    s_waitcnt lgkmcnt(0)
    v_mul_f32 v16, v16, v185
    v_fma_f32 v16, -v184, v128, v16
    v_mul_f32 v17, v17, v187
    v_fma_f32 v17, -v186, v128, v17
    v_mul_f32 v18, v18, v189
    v_fma_f32 v18, -v188, v128, v18
    v_mul_f32 v19, v19, v191
    v_fma_f32 v19, -v190, v128, v19
    v_mul_f32 v20, v20, v193
    v_fma_f32 v20, -v192, v128, v20
    v_mul_f32 v21, v21, v195
    v_fma_f32 v21, -v194, v128, v21
    v_mul_f32 v22, v22, v197
    v_fma_f32 v22, -v196, v128, v22
    v_mul_f32 v23, v23, v199
    v_fma_f32 v23, -v198, v128, v23
    v_mul_f32 v24, v24, v201
    v_fma_f32 v24, -v200, v128, v24
    v_mul_f32 v25, v25, v203
    v_fma_f32 v25, -v202, v128, v25
    v_mul_f32 v26, v26, v205
    v_fma_f32 v26, -v204, v128, v26
    v_mul_f32 v27, v27, v207
    v_fma_f32 v27, -v206, v128, v27
    v_mul_f32 v28, v28, v209
    v_fma_f32 v28, -v208, v128, v28
    v_mul_f32 v29, v29, v211
    v_fma_f32 v29, -v210, v128, v29
    v_mul_f32 v30, v30, v213
    v_fma_f32 v30, -v212, v128, v30
    v_mul_f32 v31, v31, v215
    v_fma_f32 v31, -v214, v128, v31
    v_cvt_pk_bf16_f32 v16, v16, v17
    v_cvt_pk_bf16_f32 v17, v18, v19
    v_cvt_pk_bf16_f32 v18, v20, v21
    v_cvt_pk_bf16_f32 v19, v22, v23
    v_cvt_pk_bf16_f32 v20, v24, v25
    v_cvt_pk_bf16_f32 v21, v26, v27
    v_cvt_pk_bf16_f32 v22, v28, v29
    v_cvt_pk_bf16_f32 v23, v30, v31
    buffer_store_dwordx4 v[16:19], v8, s[4:7], s30 offen offset:0
    buffer_store_dwordx4 v[20:23], v8, s[4:7], s30 offen offset:512
    ds_read_b128 v[184:187], v7 offset:256
    ds_read_b128 v[188:191], v7 offset:272
    ds_read_b128 v[192:195], v7 offset:320
    ds_read_b128 v[196:199], v7 offset:336
    ds_read_b128 v[200:203], v7 offset:384
    ds_read_b128 v[204:207], v7 offset:400
    ds_read_b128 v[208:211], v7 offset:448
    ds_read_b128 v[212:215], v7 offset:464
    s_waitcnt lgkmcnt(0)
    v_mul_f32 v32, v32, v185
    v_fma_f32 v32, -v184, v128, v32
    v_mul_f32 v33, v33, v187
    v_fma_f32 v33, -v186, v128, v33
    v_mul_f32 v34, v34, v189
    v_fma_f32 v34, -v188, v128, v34
    v_mul_f32 v35, v35, v191
    v_fma_f32 v35, -v190, v128, v35
    v_mul_f32 v36, v36, v193
    v_fma_f32 v36, -v192, v128, v36
    v_mul_f32 v37, v37, v195
    v_fma_f32 v37, -v194, v128, v37
    v_mul_f32 v38, v38, v197
    v_fma_f32 v38, -v196, v128, v38
    v_mul_f32 v39, v39, v199
    v_fma_f32 v39, -v198, v128, v39
    v_mul_f32 v40, v40, v201
    v_fma_f32 v40, -v200, v128, v40
    v_mul_f32 v41, v41, v203
    v_fma_f32 v41, -v202, v128, v41
    v_mul_f32 v42, v42, v205
    v_fma_f32 v42, -v204, v128, v42
    v_mul_f32 v43, v43, v207
    v_fma_f32 v43, -v206, v128, v43
    v_mul_f32 v44, v44, v209
    v_fma_f32 v44, -v208, v128, v44
    v_mul_f32 v45, v45, v211
    v_fma_f32 v45, -v210, v128, v45
    v_mul_f32 v46, v46, v213
    v_fma_f32 v46, -v212, v128, v46
    v_mul_f32 v47, v47, v215
    v_fma_f32 v47, -v214, v128, v47
    v_cvt_pk_bf16_f32 v32, v32, v33
    v_cvt_pk_bf16_f32 v33, v34, v35
    v_cvt_pk_bf16_f32 v34, v36, v37
    v_cvt_pk_bf16_f32 v35, v38, v39
    v_cvt_pk_bf16_f32 v36, v40, v41
    v_cvt_pk_bf16_f32 v37, v42, v43
    v_cvt_pk_bf16_f32 v38, v44, v45
    v_cvt_pk_bf16_f32 v39, v46, v47
    buffer_store_dwordx4 v[32:35], v8, s[4:7], s30 offen offset:1024
    buffer_store_dwordx4 v[36:39], v8, s[4:7], s30 offen offset:1536
    ds_read_b128 v[184:187], v7 offset:512
    ds_read_b128 v[188:191], v7 offset:528
    ds_read_b128 v[192:195], v7 offset:576
    ds_read_b128 v[196:199], v7 offset:592
    ds_read_b128 v[200:203], v7 offset:640
    ds_read_b128 v[204:207], v7 offset:656
    ds_read_b128 v[208:211], v7 offset:704
    ds_read_b128 v[212:215], v7 offset:720
    s_waitcnt lgkmcnt(0)
    v_mul_f32 v48, v48, v185
    v_fma_f32 v48, -v184, v128, v48
    v_mul_f32 v49, v49, v187
    v_fma_f32 v49, -v186, v128, v49
    v_mul_f32 v50, v50, v189
    v_fma_f32 v50, -v188, v128, v50
    v_mul_f32 v51, v51, v191
    v_fma_f32 v51, -v190, v128, v51
    v_mul_f32 v52, v52, v193
    v_fma_f32 v52, -v192, v128, v52
    v_mul_f32 v53, v53, v195
    v_fma_f32 v53, -v194, v128, v53
    v_mul_f32 v54, v54, v197
    v_fma_f32 v54, -v196, v128, v54
    v_mul_f32 v55, v55, v199
    v_fma_f32 v55, -v198, v128, v55
    v_mul_f32 v56, v56, v201
    v_fma_f32 v56, -v200, v128, v56
    v_mul_f32 v57, v57, v203
    v_fma_f32 v57, -v202, v128, v57
    v_mul_f32 v58, v58, v205
    v_fma_f32 v58, -v204, v128, v58
    v_mul_f32 v59, v59, v207
    v_fma_f32 v59, -v206, v128, v59
    v_mul_f32 v60, v60, v209
    v_fma_f32 v60, -v208, v128, v60
    v_mul_f32 v61, v61, v211
    v_fma_f32 v61, -v210, v128, v61
    v_mul_f32 v62, v62, v213
    v_fma_f32 v62, -v212, v128, v62
    v_mul_f32 v63, v63, v215
    v_fma_f32 v63, -v214, v128, v63
    v_cvt_pk_bf16_f32 v48, v48, v49
    v_cvt_pk_bf16_f32 v49, v50, v51
    v_cvt_pk_bf16_f32 v50, v52, v53
    v_cvt_pk_bf16_f32 v51, v54, v55
    v_cvt_pk_bf16_f32 v52, v56, v57
    v_cvt_pk_bf16_f32 v53, v58, v59
    v_cvt_pk_bf16_f32 v54, v60, v61
    v_cvt_pk_bf16_f32 v55, v62, v63
    buffer_store_dwordx4 v[48:51], v8, s[4:7], s30 offen offset:2048
    buffer_store_dwordx4 v[52:55], v8, s[4:7], s30 offen offset:2560
    ds_read_b128 v[184:187], v7 offset:768
    ds_read_b128 v[188:191], v7 offset:784
    ds_read_b128 v[192:195], v7 offset:832
    ds_read_b128 v[196:199], v7 offset:848
    ds_read_b128 v[200:203], v7 offset:896
    ds_read_b128 v[204:207], v7 offset:912
    ds_read_b128 v[208:211], v7 offset:960
    ds_read_b128 v[212:215], v7 offset:976
    s_waitcnt lgkmcnt(0)
    v_mul_f32 v64, v64, v185
    v_fma_f32 v64, -v184, v128, v64
    v_mul_f32 v65, v65, v187
    v_fma_f32 v65, -v186, v128, v65
    v_mul_f32 v66, v66, v189
    v_fma_f32 v66, -v188, v128, v66
    v_mul_f32 v67, v67, v191
    v_fma_f32 v67, -v190, v128, v67
    v_mul_f32 v68, v68, v193
    v_fma_f32 v68, -v192, v128, v68
    v_mul_f32 v69, v69, v195
    v_fma_f32 v69, -v194, v128, v69
    v_mul_f32 v70, v70, v197
    v_fma_f32 v70, -v196, v128, v70
    v_mul_f32 v71, v71, v199
    v_fma_f32 v71, -v198, v128, v71
    v_mul_f32 v72, v72, v201
    v_fma_f32 v72, -v200, v128, v72
    v_mul_f32 v73, v73, v203
    v_fma_f32 v73, -v202, v128, v73
    v_mul_f32 v74, v74, v205
    v_fma_f32 v74, -v204, v128, v74
    v_mul_f32 v75, v75, v207
    v_fma_f32 v75, -v206, v128, v75
    v_mul_f32 v76, v76, v209
    v_fma_f32 v76, -v208, v128, v76
    v_mul_f32 v77, v77, v211
    v_fma_f32 v77, -v210, v128, v77
    v_mul_f32 v78, v78, v213
    v_fma_f32 v78, -v212, v128, v78
    v_mul_f32 v79, v79, v215
    v_fma_f32 v79, -v214, v128, v79
    v_cvt_pk_bf16_f32 v64, v64, v65
    v_cvt_pk_bf16_f32 v65, v66, v67
    v_cvt_pk_bf16_f32 v66, v68, v69
    v_cvt_pk_bf16_f32 v67, v70, v71
    v_cvt_pk_bf16_f32 v68, v72, v73
    v_cvt_pk_bf16_f32 v69, v74, v75
    v_cvt_pk_bf16_f32 v70, v76, v77
    v_cvt_pk_bf16_f32 v71, v78, v79
    buffer_store_dwordx4 v[64:67], v8, s[4:7], s30 offen offset:3072
    buffer_store_dwordx4 v[68:71], v8, s[4:7], s30 offen offset:3584
L_chain1_kernel_fin:
L_chain1_kernel_end:
    s_endpgm
.globl chain2_kernel
.p2align 8
.type chain2_kernel,@function
chain2_kernel:
    s_cmp_ge_u32 s2, 256
    s_cbranch_scc1 L_chain2_kernel_end
    s_load_dwordx2 s[4:5], s[0:1], 72
    s_load_dwordx2 s[40:41], s[0:1], 56
    v_and_b32 v2, 63, v0
    v_lshrrev_b32 v3, 6, v0
    v_lshlrev_b32 v1, 4, v2
    v_readfirstlane_b32 s3, v3
    s_mov_b32 s6, 0x10000000
    s_mov_b32 s7, 0x00020000
    s_waitcnt lgkmcnt(0)
    v_and_b32 v4, 31, v2
    v_lshrrev_b32 v5, 5, v2
    s_and_b32 s61, s2, 7
    s_lshr_b32 s62, s2, 3
    s_lshr_b32 s60, s61, 1
    s_lshl_b32 s60, s60, 2
    s_and_b32 s63, s62, 3
    s_add_u32 s60, s60, s63
    s_lshr_b32 s62, s62, 2
    s_and_b32 s61, s61, 1
    s_lshr_b32 s44, s62, 2
    s_lshl_b32 s44, s44, 1
    s_lshl_b32 s45, s60, 2
    s_add_u32 s44, s44, s45
    s_and_b32 s45, s62, 3
    s_lshl_b32 s46, s61, 2
    s_add_u32 s45, s45, s46
    s_lshl_b32 s45, s45, 1
    s_and_b32 s46, s3, 1
    s_mov_b32 s47, 14442496
    s_mov_b32 s48, 1572864
    s_cmp_lt_u32 s3, 2
    s_cselect_b32 s49, s44, s45
    s_cselect_b32 s47, s47, s48
    s_add_u32 s49, s49, s46
    s_mul_i32 s49, s49, 32768
    s_add_u32 s50, s47, s49
    s_add_u32 s51, s50, 4096
    s_lshl_b32 s52, s3, 13
    s_add_u32 s53, s52, 4096
    s_add_u32 m0, s52, 0
    s_nop 0
    buffer_load_dwordx4 v1, s[4:7], s50 offen offset:0 lds
    buffer_load_dwordx4 v1, s[4:7], s50 offen offset:1024 lds
    buffer_load_dwordx4 v1, s[4:7], s50 offen offset:2048 lds
    buffer_load_dwordx4 v1, s[4:7], s50 offen offset:3072 lds
    s_add_u32 m0, s53, 0
    s_nop 0
    buffer_load_dwordx4 v1, s[4:7], s51 offen offset:0 lds
    buffer_load_dwordx4 v1, s[4:7], s51 offen offset:1024 lds
    buffer_load_dwordx4 v1, s[4:7], s51 offen offset:2048 lds
    buffer_load_dwordx4 v1, s[4:7], s51 offen offset:3072 lds
    s_add_u32 s50, s50, 8192
    s_add_u32 s51, s51, 8192
    s_add_u32 m0, s52, 32768
    s_nop 0
    buffer_load_dwordx4 v1, s[4:7], s50 offen offset:0 lds
    buffer_load_dwordx4 v1, s[4:7], s50 offen offset:1024 lds
    buffer_load_dwordx4 v1, s[4:7], s50 offen offset:2048 lds
    buffer_load_dwordx4 v1, s[4:7], s50 offen offset:3072 lds
    s_add_u32 m0, s53, 32768
    s_nop 0
    buffer_load_dwordx4 v1, s[4:7], s51 offen offset:0 lds
    buffer_load_dwordx4 v1, s[4:7], s51 offen offset:1024 lds
    buffer_load_dwordx4 v1, s[4:7], s51 offen offset:2048 lds
    buffer_load_dwordx4 v1, s[4:7], s51 offen offset:3072 lds
    s_add_u32 s50, s50, 8192
    s_add_u32 s51, s51, 8192
    s_add_u32 m0, s52, 65536
    s_nop 0
    buffer_load_dwordx4 v1, s[4:7], s50 offen offset:0 lds
    buffer_load_dwordx4 v1, s[4:7], s50 offen offset:1024 lds
    buffer_load_dwordx4 v1, s[4:7], s50 offen offset:2048 lds
    buffer_load_dwordx4 v1, s[4:7], s50 offen offset:3072 lds
    s_add_u32 m0, s53, 65536
    s_nop 0
    buffer_load_dwordx4 v1, s[4:7], s51 offen offset:0 lds
    buffer_load_dwordx4 v1, s[4:7], s51 offen offset:1024 lds
    buffer_load_dwordx4 v1, s[4:7], s51 offen offset:2048 lds
    buffer_load_dwordx4 v1, s[4:7], s51 offen offset:3072 lds
    s_add_u32 s50, s50, 8192
    s_add_u32 s51, s51, 8192
    s_mul_i32 s70, s61, 7
    s_add_u32 s70, s70, s62
    s_lshl_b32 s70, s70, 2
    s_add_u32 s70, s70, s3
    s_lshl_b32 s70, s70, 15
    s_add_u32 s70, s70, 2097152
    s_lshr_b32 s16, s3, 1
    s_and_b32 s17, s3, 1
    s_add_u32 s18, s16, s44
    s_add_u32 s19, s17, s45
    s_lshl_b32 s20, s18, 5
    s_lshl_b32 s21, s19, 1
    s_add_u32 s20, s20, s21
    s_lshl_b32 s20, s20, 10
    s_add_u32 s21, s20, 25976832
    buffer_load_dwordx4 v[56:59], v1, s[4:7], s21 offen
    buffer_load_dwordx4 v[60:63], v1, s[4:7], s21 offen offset:1024
    s_lshl_b32 s26, s16, 13
    v_add_u32 v10, s26, v1
    s_lshl_b32 s26, s17, 13
    s_add_u32 s26, s26, 16384
    v_add_u32 v11, s26, v1
    v_add_u32 v12, 0x10000, v10
    v_add_u32 v13, 0x10000, v11
    s_waitcnt vmcnt(18)
    s_barrier
    s_add_u32 m0, s52, 98304
    s_nop 0
    buffer_load_dwordx4 v1, s[4:7], s50 offen offset:0 lds
    buffer_load_dwordx4 v1, s[4:7], s50 offen offset:1024 lds
    buffer_load_dwordx4 v1, s[4:7], s50 offen offset:2048 lds
    buffer_load_dwordx4 v1, s[4:7], s50 offen offset:3072 lds
    s_add_u32 m0, s53, 98304
    s_nop 0
    buffer_load_dwordx4 v1, s[4:7], s51 offen offset:0 lds
    buffer_load_dwordx4 v1, s[4:7], s51 offen offset:1024 lds
    buffer_load_dwordx4 v1, s[4:7], s51 offen offset:2048 lds
    buffer_load_dwordx4 v1, s[4:7], s51 offen offset:3072 lds
    s_add_u32 s50, s50, 8192
    s_add_u32 s51, s51, 8192
    ds_read_b128 v[32:35], v10 offset:0
    ds_read_b128 v[36:39], v11 offset:0
    ds_read_b128 v[40:43], v10 offset:1024
    ds_read_b128 v[44:47], v11 offset:1024
    ds_read_b128 v[48:51], v10 offset:2048
    ds_read_b128 v[52:55], v11 offset:2048
    s_waitcnt lgkmcnt(4)
    v_mfma_f32_32x32x16_bf16 v[16:31], v[36:39], v[32:35], 0
    buffer_load_dwordx4 a[0:3], v1, s[4:7], s70 offen offset:0
    buffer_load_dwordx4 a[4:7], v1, s[4:7], s70 offen offset:1024
    ds_read_b128 v[32:35], v10 offset:3072
    ds_read_b128 v[36:39], v11 offset:3072
    s_waitcnt lgkmcnt(4)
    v_mfma_f32_32x32x16_bf16 v[16:31], v[44:47], v[40:43], v[16:31]
    buffer_load_dwordx4 a[8:11], v1, s[4:7], s70 offen offset:2048
    buffer_load_dwordx4 a[12:15], v1, s[4:7], s70 offen offset:3072
    ds_read_b128 v[40:43], v10 offset:4096
    ds_read_b128 v[44:47], v11 offset:4096
    s_waitcnt lgkmcnt(4)
    v_mfma_f32_32x32x16_bf16 v[16:31], v[52:55], v[48:51], v[16:31]
    s_add_u32 s70, s70, 4096
    ds_read_b128 v[48:51], v10 offset:5120
    ds_read_b128 v[52:55], v11 offset:5120
    s_waitcnt lgkmcnt(4)
    v_mfma_f32_32x32x16_bf16 v[16:31], v[36:39], v[32:35], v[16:31]
    buffer_load_dwordx4 a[16:19], v1, s[4:7], s70 offen offset:0
    ds_read_b128 v[32:35], v10 offset:6144
    ds_read_b128 v[36:39], v11 offset:6144
    s_waitcnt lgkmcnt(4)
    v_mfma_f32_32x32x16_bf16 v[16:31], v[44:47], v[40:43], v[16:31]
    buffer_load_dwordx4 a[20:23], v1, s[4:7], s70 offen offset:1024
    ds_read_b128 v[40:43], v10 offset:7168
    ds_read_b128 v[44:47], v11 offset:7168
    s_waitcnt lgkmcnt(4)
    v_mfma_f32_32x32x16_bf16 v[16:31], v[52:55], v[48:51], v[16:31]
    buffer_load_dwordx4 a[24:27], v1, s[4:7], s70 offen offset:2048
    s_waitcnt lgkmcnt(2)
    v_mfma_f32_32x32x16_bf16 v[16:31], v[36:39], v[32:35], v[16:31]
    buffer_load_dwordx4 a[28:31], v1, s[4:7], s70 offen offset:3072
    s_waitcnt lgkmcnt(0)
    v_mfma_f32_32x32x16_bf16 v[16:31], v[44:47], v[40:43], v[16:31]
    s_add_u32 s70, s70, 4096
    s_waitcnt vmcnt(26)
    s_barrier
    ds_read_b128 v[32:35], v10 offset:32768
    ds_read_b128 v[36:39], v11 offset:32768
    ds_read_b128 v[40:43], v10 offset:33792
    ds_read_b128 v[44:47], v11 offset:33792
    ds_read_b128 v[48:51], v10 offset:34816
    ds_read_b128 v[52:55], v11 offset:34816
    s_waitcnt lgkmcnt(4)
    v_mfma_f32_32x32x16_bf16 v[16:31], v[36:39], v[32:35], v[16:31]
    buffer_load_dwordx4 a[32:35], v1, s[4:7], s70 offen offset:0
    buffer_load_dwordx4 a[36:39], v1, s[4:7], s70 offen offset:1024
    ds_read_b128 v[32:35], v10 offset:35840
    ds_read_b128 v[36:39], v11 offset:35840
    s_waitcnt lgkmcnt(4)
    v_mfma_f32_32x32x16_bf16 v[16:31], v[44:47], v[40:43], v[16:31]
    buffer_load_dwordx4 a[40:43], v1, s[4:7], s70 offen offset:2048
    buffer_load_dwordx4 a[44:47], v1, s[4:7], s70 offen offset:3072
    ds_read_b128 v[40:43], v10 offset:36864
    ds_read_b128 v[44:47], v11 offset:36864
    s_waitcnt lgkmcnt(4)
    v_mfma_f32_32x32x16_bf16 v[16:31], v[52:55], v[48:51], v[16:31]
    s_add_u32 s70, s70, 4096
    ds_read_b128 v[48:51], v10 offset:37888
    ds_read_b128 v[52:55], v11 offset:37888
    s_waitcnt lgkmcnt(4)
    v_mfma_f32_32x32x16_bf16 v[16:31], v[36:39], v[32:35], v[16:31]
    buffer_load_dwordx4 a[48:51], v1, s[4:7], s70 offen offset:0
    ds_read_b128 v[32:35], v10 offset:38912
    ds_read_b128 v[36:39], v11 offset:38912
    s_waitcnt lgkmcnt(4)
    v_mfma_f32_32x32x16_bf16 v[16:31], v[44:47], v[40:43], v[16:31]
    buffer_load_dwordx4 a[52:55], v1, s[4:7], s70 offen offset:1024
    ds_read_b128 v[40:43], v10 offset:39936
    ds_read_b128 v[44:47], v11 offset:39936
    s_waitcnt lgkmcnt(4)
    v_mfma_f32_32x32x16_bf16 v[16:31], v[52:55], v[48:51], v[16:31]
    buffer_load_dwordx4 a[56:59], v1, s[4:7], s70 offen offset:2048
    s_waitcnt lgkmcnt(2)
    v_mfma_f32_32x32x16_bf16 v[16:31], v[36:39], v[32:35], v[16:31]
    buffer_load_dwordx4 a[60:63], v1, s[4:7], s70 offen offset:3072
    s_waitcnt lgkmcnt(0)
    v_mfma_f32_32x32x16_bf16 v[16:31], v[44:47], v[40:43], v[16:31]
    s_add_u32 s70, s70, 4096
    s_waitcnt vmcnt(26)
    s_barrier
    ds_read_b128 v[32:35], v12 offset:0
    ds_read_b128 v[36:39], v13 offset:0
    ds_read_b128 v[40:43], v12 offset:1024
    ds_read_b128 v[44:47], v13 offset:1024
    ds_read_b128 v[48:51], v12 offset:2048
    ds_read_b128 v[52:55], v13 offset:2048
    s_waitcnt lgkmcnt(4)
    v_mfma_f32_32x32x16_bf16 v[16:31], v[36:39], v[32:35], v[16:31]
    buffer_load_dwordx4 a[64:67], v1, s[4:7], s70 offen offset:0
    buffer_load_dwordx4 a[68:71], v1, s[4:7], s70 offen offset:1024
    ds_read_b128 v[32:35], v12 offset:3072
    ds_read_b128 v[36:39], v13 offset:3072
    s_waitcnt lgkmcnt(4)
    v_mfma_f32_32x32x16_bf16 v[16:31], v[44:47], v[40:43], v[16:31]
    buffer_load_dwordx4 a[72:75], v1, s[4:7], s70 offen offset:2048
    buffer_load_dwordx4 a[76:79], v1, s[4:7], s70 offen offset:3072
    ds_read_b128 v[40:43], v12 offset:4096
    ds_read_b128 v[44:47], v13 offset:4096
    s_waitcnt lgkmcnt(4)
    v_mfma_f32_32x32x16_bf16 v[16:31], v[52:55], v[48:51], v[16:31]
    s_add_u32 s70, s70, 4096
    ds_read_b128 v[48:51], v12 offset:5120
    ds_read_b128 v[52:55], v13 offset:5120
    s_waitcnt lgkmcnt(4)
    v_mfma_f32_32x32x16_bf16 v[16:31], v[36:39], v[32:35], v[16:31]
    buffer_load_dwordx4 a[80:83], v1, s[4:7], s70 offen offset:0
    ds_read_b128 v[32:35], v12 offset:6144
    ds_read_b128 v[36:39], v13 offset:6144
    s_waitcnt lgkmcnt(4)
    v_mfma_f32_32x32x16_bf16 v[16:31], v[44:47], v[40:43], v[16:31]
    buffer_load_dwordx4 a[84:87], v1, s[4:7], s70 offen offset:1024
    ds_read_b128 v[40:43], v12 offset:7168
    ds_read_b128 v[44:47], v13 offset:7168
    s_waitcnt lgkmcnt(4)
    v_mfma_f32_32x32x16_bf16 v[16:31], v[52:55], v[48:51], v[16:31]
    buffer_load_dwordx4 a[88:91], v1, s[4:7], s70 offen offset:2048
    s_waitcnt lgkmcnt(2)
    v_mfma_f32_32x32x16_bf16 v[16:31], v[36:39], v[32:35], v[16:31]
    buffer_load_dwordx4 a[92:95], v1, s[4:7], s70 offen offset:3072
    s_waitcnt lgkmcnt(0)
    v_mfma_f32_32x32x16_bf16 v[16:31], v[44:47], v[40:43], v[16:31]
    s_add_u32 s70, s70, 4096
    s_waitcnt vmcnt(24)
    s_barrier
    ds_read_b128 v[32:35], v12 offset:32768
    ds_read_b128 v[36:39], v13 offset:32768
    ds_read_b128 v[40:43], v12 offset:33792
    ds_read_b128 v[44:47], v13 offset:33792
    ds_read_b128 v[48:51], v12 offset:34816
    ds_read_b128 v[52:55], v13 offset:34816
    s_waitcnt lgkmcnt(4)
    v_mfma_f32_32x32x16_bf16 v[16:31], v[36:39], v[32:35], v[16:31]
    buffer_load_dwordx4 a[96:99], v1, s[4:7], s70 offen offset:0
    buffer_load_dwordx4 a[100:103], v1, s[4:7], s70 offen offset:1024
    ds_read_b128 v[32:35], v12 offset:35840
    ds_read_b128 v[36:39], v13 offset:35840
    s_waitcnt lgkmcnt(4)
    v_mfma_f32_32x32x16_bf16 v[16:31], v[44:47], v[40:43], v[16:31]
    buffer_load_dwordx4 a[104:107], v1, s[4:7], s70 offen offset:2048
    buffer_load_dwordx4 a[108:111], v1, s[4:7], s70 offen offset:3072
    ds_read_b128 v[40:43], v12 offset:36864
    ds_read_b128 v[44:47], v13 offset:36864
    s_waitcnt lgkmcnt(4)
    v_mfma_f32_32x32x16_bf16 v[16:31], v[52:55], v[48:51], v[16:31]
    s_add_u32 s70, s70, 4096
    ds_read_b128 v[48:51], v12 offset:37888
    ds_read_b128 v[52:55], v13 offset:37888
    s_waitcnt lgkmcnt(4)
    v_mfma_f32_32x32x16_bf16 v[16:31], v[36:39], v[32:35], v[16:31]
    buffer_load_dwordx4 a[112:115], v1, s[4:7], s70 offen offset:0
    ds_read_b128 v[32:35], v12 offset:38912
    ds_read_b128 v[36:39], v13 offset:38912
    s_waitcnt lgkmcnt(4)
    v_mfma_f32_32x32x16_bf16 v[16:31], v[44:47], v[40:43], v[16:31]
    buffer_load_dwordx4 a[116:119], v1, s[4:7], s70 offen offset:1024
    ds_read_b128 v[40:43], v12 offset:39936
    ds_read_b128 v[44:47], v13 offset:39936
    s_waitcnt lgkmcnt(4)
    v_mfma_f32_32x32x16_bf16 v[16:31], v[52:55], v[48:51], v[16:31]
    buffer_load_dwordx4 a[120:123], v1, s[4:7], s70 offen offset:2048
    s_waitcnt lgkmcnt(2)
    v_mfma_f32_32x32x16_bf16 v[16:31], v[36:39], v[32:35], v[16:31]
    buffer_load_dwordx4 a[124:127], v1, s[4:7], s70 offen offset:3072
    s_waitcnt lgkmcnt(0)
    v_mfma_f32_32x32x16_bf16 v[16:31], v[44:47], v[40:43], v[16:31]
    s_add_u32 s70, s70, 4096
    s_nop 15
    s_nop 3
    s_waitcnt vmcnt(40)
    v_lshlrev_b32 v6, 16, v56
    v_and_b32 v7, 0xffff0000, v56
    v_add_f32 v16, v16, v6
    v_add_f32 v17, v17, v7
    v_lshlrev_b32 v6, 16, v57
    v_and_b32 v7, 0xffff0000, v57
    v_add_f32 v18, v18, v6
    v_add_f32 v19, v19, v7
    v_lshlrev_b32 v6, 16, v58
    v_and_b32 v7, 0xffff0000, v58
    v_add_f32 v20, v20, v6
    v_add_f32 v21, v21, v7
    v_lshlrev_b32 v6, 16, v59
    v_and_b32 v7, 0xffff0000, v59
    v_add_f32 v22, v22, v6
    v_add_f32 v23, v23, v7
    v_lshlrev_b32 v6, 16, v60
    v_and_b32 v7, 0xffff0000, v60
    v_add_f32 v24, v24, v6
    v_add_f32 v25, v25, v7
    v_lshlrev_b32 v6, 16, v61
    v_and_b32 v7, 0xffff0000, v61
    v_add_f32 v26, v26, v6
    v_add_f32 v27, v27, v7
    v_lshlrev_b32 v6, 16, v62
    v_and_b32 v7, 0xffff0000, v62
    v_add_f32 v28, v28, v6
    v_add_f32 v29, v29, v7
    v_lshlrev_b32 v6, 16, v63
    v_and_b32 v7, 0xffff0000, v63
    v_add_f32 v30, v30, v6
    v_add_f32 v31, v31, v7
    v_cvt_pk_bf16_f32 v216, v16, v17
    v_cvt_pk_bf16_f32 v217, v18, v19
    v_cvt_pk_bf16_f32 v218, v20, v21
    v_cvt_pk_bf16_f32 v219, v22, v23
    v_cvt_pk_bf16_f32 v220, v24, v25
    v_cvt_pk_bf16_f32 v221, v26, v27
    v_cvt_pk_bf16_f32 v222, v28, v29
    v_cvt_pk_bf16_f32 v223, v30, v31
    s_add_u32 s21, s20, 23879680
    buffer_store_dwordx4 v[216:219], v1, s[4:7], s21 offen sc1
    buffer_store_dwordx4 v[220:223], v1, s[4:7], s21 offen offset:1024 sc1
    v_lshlrev_b32 v6, 16, v216
    v_and_b32 v7, 0xffff0000, v216
    v_add_f32 v64, v6, v7
    v_mul_f32 v65, v6, v6
    v_fmac_f32 v65, v7, v7
    v_lshlrev_b32 v6, 16, v217
    v_and_b32 v7, 0xffff0000, v217
    v_add_f32 v64, v64, v6
    v_add_f32 v64, v64, v7
    v_fmac_f32 v65, v6, v6
    v_fmac_f32 v65, v7, v7
    v_lshlrev_b32 v6, 16, v218
    v_and_b32 v7, 0xffff0000, v218
    v_add_f32 v64, v64, v6
    v_add_f32 v64, v64, v7
    v_fmac_f32 v65, v6, v6
    v_fmac_f32 v65, v7, v7
    v_lshlrev_b32 v6, 16, v219
    v_and_b32 v7, 0xffff0000, v219
    v_add_f32 v64, v64, v6
    v_add_f32 v64, v64, v7
    v_fmac_f32 v65, v6, v6
    v_fmac_f32 v65, v7, v7
    v_lshlrev_b32 v6, 16, v220
    v_and_b32 v7, 0xffff0000, v220
    v_add_f32 v64, v64, v6
    v_add_f32 v64, v64, v7
    v_fmac_f32 v65, v6, v6
    v_fmac_f32 v65, v7, v7
    v_lshlrev_b32 v6, 16, v221
    v_and_b32 v7, 0xffff0000, v221
    v_add_f32 v64, v64, v6
    v_add_f32 v64, v64, v7
    v_fmac_f32 v65, v6, v6
    v_fmac_f32 v65, v7, v7
    v_lshlrev_b32 v6, 16, v222
    v_and_b32 v7, 0xffff0000, v222
    v_add_f32 v64, v64, v6
    v_add_f32 v64, v64, v7
    v_fmac_f32 v65, v6, v6
    v_fmac_f32 v65, v7, v7
    v_lshlrev_b32 v6, 16, v223
    v_and_b32 v7, 0xffff0000, v223
    v_add_f32 v64, v64, v6
    v_add_f32 v64, v64, v7
    v_fmac_f32 v65, v6, v6
    v_fmac_f32 v65, v7, v7
    v_mov_b32 v6, v64
    s_nop 1
    v_permlane32_swap_b32 v64, v6
    s_nop 1
    v_add_f32 v64, v64, v6
    v_mov_b32 v6, v65
    s_nop 1
    v_permlane32_swap_b32 v65, v6
    s_nop 1
    v_add_f32 v65, v65, v6
    v_lshlrev_b32 v6, 4, v4
    s_lshl_b32 s30, s18, 3
    s_lshr_b32 s31, s19, 1
    s_add_u32 s30, s30, s31
    s_lshl_b32 s30, s30, 9
    s_and_b32 s31, s19, 1
    s_lshl_b32 s31, s31, 3
    s_add_u32 s31, s31, s30
    s_add_u32 s31, s31, 28073984
    buffer_store_dwordx2 v[64:65], v6, s[4:7], s31 offen sc1
    s_waitcnt vmcnt(0)
    s_barrier
    s_cmp_lg_u32 s3, 0
    s_cbranch_scc1 L_pub_21
    s_lshl_b32 s64, s60, 7
    s_lshl_b32 s65, s61, 5
    s_add_u32 s64, s64, s65
    s_lshl_b32 s65, s62, 2
    s_add_u32 s64, s64, s65
    s_add_u32 s64, s64, 28598272
    v_mov_b32 v2, 0
    v_mov_b32 v3, 1
    s_mov_b64 exec, 1
    buffer_store_dword v3, v2, s[4:7], s64 offen sc1
    s_mov_b64 exec, -1
L_pub_21:
    s_cmp_ge_u32 s62, 7
    s_cbranch_scc1 L_skipw1_22
    s_lshl_b32 s8, s60, 2
    s_mul_i32 s9, s61, 7
    s_add_u32 s9, s9, s62
    s_lshl_b32 s9, s9, 2
    s_add_u32 s19, s9, s3
    s_add_u32 s10, s8, s3
    s_lshl_b32 s10, s10, 15
    s_add_u32 s10, s10, 23879680
    s_lshl_b32 s12, s3, 15
    s_cmp_lg_u32 s3, 0
    s_cbranch_scc1 L_aw_25
    s_lshl_b32 s64, s60, 7
    s_add_u32 s64, s64, 28598272
    v_lshrrev_b32 v2, 2, v1
    v_and_b32 v2, 60, v2
    s_mov_b32 s66, 0x20000
L_poll_26:
    buffer_load_dword v3, v2, s[4:7], s64 offen sc1
    s_waitcnt vmcnt(0)
    v_cmp_eq_u32 vcc, 1, v3
    s_nop 3
    s_and_b32 s65, vcc_lo, 0xffff
    s_cmp_eq_u32 s65, 0xffff
    s_cbranch_scc1 L_done_27
    s_sub_u32 s66, s66, 1
    s_cmp_lg_u32 s66, 0
    s_cbranch_scc1 L_poll_26
L_done_27:
    s_waitcnt vmcnt(0)
L_aw_25:
    s_barrier
    s_add_u32 m0, s12, 0
    s_nop 0
    buffer_load_dwordx4 v1, s[4:7], s10 offen offset:0 sc1 lds
    buffer_load_dwordx4 v1, s[4:7], s10 offen offset:1024 sc1 lds
    buffer_load_dwordx4 v1, s[4:7], s10 offen offset:2048 sc1 lds
    buffer_load_dwordx4 v1, s[4:7], s10 offen offset:3072 sc1 lds
    s_add_u32 s10, s10, 4096
    s_add_u32 m0, s12, 4096
    s_nop 0
    buffer_load_dwordx4 v1, s[4:7], s10 offen offset:0 sc1 lds
    buffer_load_dwordx4 v1, s[4:7], s10 offen offset:1024 sc1 lds
    buffer_load_dwordx4 v1, s[4:7], s10 offen offset:2048 sc1 lds
    buffer_load_dwordx4 v1, s[4:7], s10 offen offset:3072 sc1 lds
    s_add_u32 s10, s10, 4096
    s_add_u32 m0, s12, 8192
    s_nop 0
    buffer_load_dwordx4 v1, s[4:7], s10 offen offset:0 sc1 lds
    buffer_load_dwordx4 v1, s[4:7], s10 offen offset:1024 sc1 lds
    buffer_load_dwordx4 v1, s[4:7], s10 offen offset:2048 sc1 lds
    buffer_load_dwordx4 v1, s[4:7], s10 offen offset:3072 sc1 lds
    s_add_u32 s10, s10, 4096
    s_add_u32 m0, s12, 12288
    s_nop 0
    buffer_load_dwordx4 v1, s[4:7], s10 offen offset:0 sc1 lds
    buffer_load_dwordx4 v1, s[4:7], s10 offen offset:1024 sc1 lds
    buffer_load_dwordx4 v1, s[4:7], s10 offen offset:2048 sc1 lds
    buffer_load_dwordx4 v1, s[4:7], s10 offen offset:3072 sc1 lds
    s_add_u32 s10, s10, 4096
    v_add_u32 v11, 0x10000, v1
    s_lshl_b32 s26, s3, 8
    v_lshlrev_b32 v12, 3, v4
    v_add_u32 v13, 131072, v12
    v_add_u32 v12, s26, v13
    s_mul_i32 s30, s8, 112
    s_lshl_b32 s31, s19, 1
    s_add_u32 s30, s30, s31
    s_lshl_b32 s30, s30, 10
    s_add_u32 s30, s30, 16539648
    s_mov_b32 s32, 0x3fb8aa3b
    s_mov_b32 s33, 0x3fb8aa3b
    s_mov_b32 s34, 2.0
    s_mov_b32 s35, 2.0
    s_mov_b32 s36, -2.0
    s_mov_b32 s37, -2.0
    s_waitcnt vmcnt(12)
    s_barrier
    ds_read_b128 v[80:83], v1 offset:0
    ds_read_b128 v[84:87], v1 offset:32768
    ds_read_b128 v[88:91], v11 offset:0
    ds_read_b128 v[92:95], v11 offset:32768
    ds_read_b128 v[96:99], v1 offset:1024
    ds_read_b128 v[100:103], v1 offset:33792
    ds_read_b128 v[104:107], v11 offset:1024
    ds_read_b128 v[108:111], v11 offset:33792
    s_waitcnt vmcnt(16)
    s_waitcnt lgkmcnt(7)
    v_mfma_f32_32x32x16_bf16 v[16:31], a[0:3], v[80:83], 0
    s_add_u32 m0, s12, 16384
    s_waitcnt lgkmcnt(6)
    v_mfma_f32_32x32x16_bf16 v[32:47], a[0:3], v[84:87], 0
    s_nop 0
    s_waitcnt lgkmcnt(5)
    v_mfma_f32_32x32x16_bf16 v[48:63], a[0:3], v[88:91], 0
    buffer_load_dwordx4 v1, s[4:7], s10 offen offset:0 sc1 lds
    s_waitcnt lgkmcnt(4)
    v_mfma_f32_32x32x16_bf16 v[64:79], a[0:3], v[92:95], 0
    buffer_load_dwordx4 v1, s[4:7], s10 offen offset:1024 sc1 lds
    ds_read_b128 v[80:83], v1 offset:2048
    ds_read_b128 v[84:87], v1 offset:34816
    ds_read_b128 v[88:91], v11 offset:2048
    ds_read_b128 v[92:95], v11 offset:34816
    s_waitcnt lgkmcnt(7)
    v_mfma_f32_32x32x16_bf16 v[16:31], a[4:7], v[96:99], v[16:31]
    buffer_load_dwordx4 v1, s[4:7], s10 offen offset:2048 sc1 lds
    s_waitcnt lgkmcnt(6)
    v_mfma_f32_32x32x16_bf16 v[32:47], a[4:7], v[100:103], v[32:47]
    buffer_load_dwordx4 v1, s[4:7], s10 offen offset:3072 sc1 lds
    s_waitcnt lgkmcnt(5)
    v_mfma_f32_32x32x16_bf16 v[48:63], a[4:7], v[104:107], v[48:63]
    s_add_u32 s10, s10, 4096
    s_waitcnt lgkmcnt(4)
    v_mfma_f32_32x32x16_bf16 v[64:79], a[4:7], v[108:111], v[64:79]
    ds_read_b128 v[96:99], v1 offset:3072
    ds_read_b128 v[100:103], v1 offset:35840
    ds_read_b128 v[104:107], v11 offset:3072
    ds_read_b128 v[108:111], v11 offset:35840
    s_waitcnt lgkmcnt(7)
    v_mfma_f32_32x32x16_bf16 v[16:31], a[8:11], v[80:83], v[16:31]
    s_waitcnt lgkmcnt(6)
    v_mfma_f32_32x32x16_bf16 v[32:47], a[8:11], v[84:87], v[32:47]
    s_waitcnt lgkmcnt(5)
    v_mfma_f32_32x32x16_bf16 v[48:63], a[8:11], v[88:91], v[48:63]
    s_waitcnt lgkmcnt(4)
    v_mfma_f32_32x32x16_bf16 v[64:79], a[8:11], v[92:95], v[64:79]
    s_waitcnt vmcnt(12)
    s_barrier
    ds_read_b128 v[80:83], v1 offset:4096
    ds_read_b128 v[84:87], v1 offset:36864
    ds_read_b128 v[88:91], v11 offset:4096
    ds_read_b128 v[92:95], v11 offset:36864
    s_waitcnt lgkmcnt(7)
    v_mfma_f32_32x32x16_bf16 v[16:31], a[12:15], v[96:99], v[16:31]
    s_waitcnt lgkmcnt(6)
    v_mfma_f32_32x32x16_bf16 v[32:47], a[12:15], v[100:103], v[32:47]
    s_waitcnt lgkmcnt(5)
    v_mfma_f32_32x32x16_bf16 v[48:63], a[12:15], v[104:107], v[48:63]
    s_waitcnt lgkmcnt(4)
    v_mfma_f32_32x32x16_bf16 v[64:79], a[12:15], v[108:111], v[64:79]
    ds_read_b128 v[96:99], v1 offset:5120
    ds_read_b128 v[100:103], v1 offset:37888
    ds_read_b128 v[104:107], v11 offset:5120
    ds_read_b128 v[108:111], v11 offset:37888
    s_waitcnt vmcnt(20)
    s_waitcnt lgkmcnt(7)
    v_mfma_f32_32x32x16_bf16 v[16:31], a[16:19], v[80:83], v[16:31]
    s_add_u32 m0, s12, 20480
    s_nop 0
    s_waitcnt lgkmcnt(6)
    v_mfma_f32_32x32x16_bf16 v[32:47], a[16:19], v[84:87], v[32:47]
    buffer_load_dwordx4 v1, s[4:7], s10 offen offset:0 sc1 lds
    buffer_load_dwordx4 v1, s[4:7], s10 offen offset:1024 sc1 lds
    s_waitcnt lgkmcnt(5)
    v_mfma_f32_32x32x16_bf16 v[48:63], a[16:19], v[88:91], v[48:63]
    buffer_load_dwordx4 v1, s[4:7], s10 offen offset:2048 sc1 lds
    buffer_load_dwordx4 v1, s[4:7], s10 offen offset:3072 sc1 lds
    s_waitcnt lgkmcnt(4)
    v_mfma_f32_32x32x16_bf16 v[64:79], a[16:19], v[92:95], v[64:79]
    s_add_u32 s10, s10, 4096
    s_add_u32 s21, s8, s3
    ds_read_b128 v[80:83], v1 offset:6144
    ds_read_b128 v[84:87], v1 offset:38912
    ds_read_b128 v[88:91], v11 offset:6144
    ds_read_b128 v[92:95], v11 offset:38912
    s_waitcnt lgkmcnt(7)
    v_mfma_f32_32x32x16_bf16 v[16:31], a[20:23], v[96:99], v[16:31]
    s_lshl_b32 s21, s21, 12
    s_add_u32 s21, s21, 28073984
    s_waitcnt lgkmcnt(6)
    v_mfma_f32_32x32x16_bf16 v[32:47], a[20:23], v[100:103], v[32:47]
    buffer_load_dwordx4 v[168:171], v1, s[4:7], s21 offen offset:0 sc1
    buffer_load_dwordx4 v[172:175], v1, s[4:7], s21 offen offset:1024 sc1
    s_waitcnt lgkmcnt(5)
    v_mfma_f32_32x32x16_bf16 v[48:63], a[20:23], v[104:107], v[48:63]
    buffer_load_dwordx4 v[176:179], v1, s[4:7], s21 offen offset:2048 sc1
    buffer_load_dwordx4 v[180:183], v1, s[4:7], s21 offen offset:3072 sc1
    s_waitcnt lgkmcnt(4)
    v_mfma_f32_32x32x16_bf16 v[64:79], a[20:23], v[108:111], v[64:79]
    v_lshlrev_b32 v14, 6, v5
    s_lshl_b32 s22, s19, 7
    ds_read_b128 v[96:99], v1 offset:7168
    ds_read_b128 v[100:103], v1 offset:39936
    ds_read_b128 v[104:107], v11 offset:7168
    ds_read_b128 v[108:111], v11 offset:39936
    s_waitcnt lgkmcnt(7)
    v_mfma_f32_32x32x16_bf16 v[16:31], a[24:27], v[80:83], v[16:31]
    s_add_u32 s22, s22, 5775360
    buffer_load_dwordx4 v[112:115], v14, s[4:7], s22 offen offset:0
    s_waitcnt lgkmcnt(6)
    v_mfma_f32_32x32x16_bf16 v[32:47], a[24:27], v[84:87], v[32:47]
    buffer_load_dwordx4 v[116:119], v14, s[4:7], s22 offen offset:16
    buffer_load_dwordx4 v[120:123], v14, s[4:7], s22 offen offset:32
    s_waitcnt lgkmcnt(5)
    v_mfma_f32_32x32x16_bf16 v[48:63], a[24:27], v[88:91], v[48:63]
    buffer_load_dwordx4 v[124:127], v14, s[4:7], s22 offen offset:48
    s_lshl_b32 s23, s19, 7
    s_waitcnt lgkmcnt(4)
    v_mfma_f32_32x32x16_bf16 v[64:79], a[24:27], v[92:95], v[64:79]
    s_add_u32 s23, s23, 5783552
    buffer_load_dwordx4 v[128:131], v14, s[4:7], s23 offen offset:0
    s_waitcnt vmcnt(21)
    s_barrier
    ds_read_b128 v[80:83], v1 offset:8192
    ds_read_b128 v[84:87], v1 offset:40960
    ds_read_b128 v[88:91], v11 offset:8192
    ds_read_b128 v[92:95], v11 offset:40960
    s_waitcnt lgkmcnt(7)
    v_mfma_f32_32x32x16_bf16 v[16:31], a[28:31], v[96:99], v[16:31]
    buffer_load_dwordx4 v[132:135], v14, s[4:7], s23 offen offset:16
    buffer_load_dwordx4 v[136:139], v14, s[4:7], s23 offen offset:32
    s_waitcnt lgkmcnt(6)
    v_mfma_f32_32x32x16_bf16 v[32:47], a[28:31], v[100:103], v[32:47]
    buffer_load_dwordx4 v[140:143], v14, s[4:7], s23 offen offset:48
    s_waitcnt lgkmcnt(5)
    v_mfma_f32_32x32x16_bf16 v[48:63], a[28:31], v[104:107], v[48:63]
    s_waitcnt lgkmcnt(4)
    v_mfma_f32_32x32x16_bf16 v[64:79], a[28:31], v[108:111], v[64:79]
    ds_read_b128 v[96:99], v1 offset:9216
    ds_read_b128 v[100:103], v1 offset:41984
    ds_read_b128 v[104:107], v11 offset:9216
    ds_read_b128 v[108:111], v11 offset:41984
    s_waitcnt vmcnt(36)
    s_waitcnt lgkmcnt(7)
    v_mfma_f32_32x32x16_bf16 v[16:31], a[32:35], v[80:83], v[16:31]
    s_add_u32 m0, s12, 24576
    s_waitcnt lgkmcnt(6)
    v_mfma_f32_32x32x16_bf16 v[32:47], a[32:35], v[84:87], v[32:47]
    s_nop 0
    s_waitcnt lgkmcnt(5)
    v_mfma_f32_32x32x16_bf16 v[48:63], a[32:35], v[88:91], v[48:63]
    buffer_load_dwordx4 v1, s[4:7], s10 offen offset:0 sc1 lds
    s_waitcnt lgkmcnt(4)
    v_mfma_f32_32x32x16_bf16 v[64:79], a[32:35], v[92:95], v[64:79]
    buffer_load_dwordx4 v1, s[4:7], s10 offen offset:1024 sc1 lds
    ds_read_b128 v[80:83], v1 offset:10240
    ds_read_b128 v[84:87], v1 offset:43008
    ds_read_b128 v[88:91], v11 offset:10240
    ds_read_b128 v[92:95], v11 offset:43008
    s_waitcnt lgkmcnt(7)
    v_mfma_f32_32x32x16_bf16 v[16:31], a[36:39], v[96:99], v[16:31]
    buffer_load_dwordx4 v1, s[4:7], s10 offen offset:2048 sc1 lds
    s_waitcnt lgkmcnt(6)
    v_mfma_f32_32x32x16_bf16 v[32:47], a[36:39], v[100:103], v[32:47]
    buffer_load_dwordx4 v1, s[4:7], s10 offen offset:3072 sc1 lds
    s_waitcnt lgkmcnt(5)
    v_mfma_f32_32x32x16_bf16 v[48:63], a[36:39], v[104:107], v[48:63]
    s_add_u32 s10, s10, 4096
    s_waitcnt lgkmcnt(4)
    v_mfma_f32_32x32x16_bf16 v[64:79], a[36:39], v[108:111], v[64:79]
    ds_read_b128 v[96:99], v1 offset:11264
    ds_read_b128 v[100:103], v1 offset:44032
    ds_read_b128 v[104:107], v11 offset:11264
    ds_read_b128 v[108:111], v11 offset:44032
    s_waitcnt lgkmcnt(7)
    v_mfma_f32_32x32x16_bf16 v[16:31], a[40:43], v[80:83], v[16:31]
    s_waitcnt lgkmcnt(6)
    v_mfma_f32_32x32x16_bf16 v[32:47], a[40:43], v[84:87], v[32:47]
    s_waitcnt lgkmcnt(5)
    v_mfma_f32_32x32x16_bf16 v[48:63], a[40:43], v[88:91], v[48:63]
    s_waitcnt lgkmcnt(4)
    v_mfma_f32_32x32x16_bf16 v[64:79], a[40:43], v[92:95], v[64:79]
    s_waitcnt vmcnt(24)
    s_barrier
    ds_read_b128 v[80:83], v1 offset:12288
    ds_read_b128 v[84:87], v1 offset:45056
    ds_read_b128 v[88:91], v11 offset:12288
    ds_read_b128 v[92:95], v11 offset:45056
    s_waitcnt lgkmcnt(7)
    v_mfma_f32_32x32x16_bf16 v[16:31], a[44:47], v[96:99], v[16:31]
    s_waitcnt lgkmcnt(6)
    v_mfma_f32_32x32x16_bf16 v[32:47], a[44:47], v[100:103], v[32:47]
    s_waitcnt lgkmcnt(5)
    v_mfma_f32_32x32x16_bf16 v[48:63], a[44:47], v[104:107], v[48:63]
    s_waitcnt lgkmcnt(4)
    v_mfma_f32_32x32x16_bf16 v[64:79], a[44:47], v[108:111], v[64:79]
    ds_read_b128 v[96:99], v1 offset:13312
    ds_read_b128 v[100:103], v1 offset:46080
    ds_read_b128 v[104:107], v11 offset:13312
    ds_read_b128 v[108:111], v11 offset:46080
    s_waitcnt vmcnt(40)
    s_waitcnt lgkmcnt(7)
    v_mfma_f32_32x32x16_bf16 v[16:31], a[48:51], v[80:83], v[16:31]
    s_add_u32 m0, s12, 28672
    s_waitcnt lgkmcnt(6)
    v_mfma_f32_32x32x16_bf16 v[32:47], a[48:51], v[84:87], v[32:47]
    s_nop 0
    s_waitcnt lgkmcnt(5)
    v_mfma_f32_32x32x16_bf16 v[48:63], a[48:51], v[88:91], v[48:63]
    buffer_load_dwordx4 v1, s[4:7], s10 offen offset:0 sc1 lds
    s_waitcnt lgkmcnt(4)
    v_mfma_f32_32x32x16_bf16 v[64:79], a[48:51], v[92:95], v[64:79]
    buffer_load_dwordx4 v1, s[4:7], s10 offen offset:1024 sc1 lds
    ds_read_b128 v[80:83], v1 offset:14336
    ds_read_b128 v[84:87], v1 offset:47104
    ds_read_b128 v[88:91], v11 offset:14336
    ds_read_b128 v[92:95], v11 offset:47104
    s_waitcnt lgkmcnt(7)
    v_mfma_f32_32x32x16_bf16 v[16:31], a[52:55], v[96:99], v[16:31]
    buffer_load_dwordx4 v1, s[4:7], s10 offen offset:2048 sc1 lds
    s_waitcnt lgkmcnt(6)
    v_mfma_f32_32x32x16_bf16 v[32:47], a[52:55], v[100:103], v[32:47]
    buffer_load_dwordx4 v1, s[4:7], s10 offen offset:3072 sc1 lds
    s_waitcnt lgkmcnt(5)
    v_mfma_f32_32x32x16_bf16 v[48:63], a[52:55], v[104:107], v[48:63]
    s_add_u32 s10, s10, 4096
    s_waitcnt lgkmcnt(4)
    v_mfma_f32_32x32x16_bf16 v[64:79], a[52:55], v[108:111], v[64:79]
    ds_read_b128 v[96:99], v1 offset:15360
    ds_read_b128 v[100:103], v1 offset:48128
    ds_read_b128 v[104:107], v11 offset:15360
    ds_read_b128 v[108:111], v11 offset:48128
    s_waitcnt lgkmcnt(7)
    v_mfma_f32_32x32x16_bf16 v[16:31], a[56:59], v[80:83], v[16:31]
    s_waitcnt lgkmcnt(6)
    v_mfma_f32_32x32x16_bf16 v[32:47], a[56:59], v[84:87], v[32:47]
    s_waitcnt lgkmcnt(5)
    v_mfma_f32_32x32x16_bf16 v[48:63], a[56:59], v[88:91], v[48:63]
    s_waitcnt lgkmcnt(4)
    v_mfma_f32_32x32x16_bf16 v[64:79], a[56:59], v[92:95], v[64:79]
    s_waitcnt vmcnt(24)
    s_barrier
    ds_read_b128 v[80:83], v1 offset:16384
    ds_read_b128 v[84:87], v1 offset:49152
    ds_read_b128 v[88:91], v11 offset:16384
    ds_read_b128 v[92:95], v11 offset:49152
    s_waitcnt lgkmcnt(7)
    v_mfma_f32_32x32x16_bf16 v[16:31], a[60:63], v[96:99], v[16:31]
    s_waitcnt lgkmcnt(6)
    v_mfma_f32_32x32x16_bf16 v[32:47], a[60:63], v[100:103], v[32:47]
    s_waitcnt lgkmcnt(5)
    v_mfma_f32_32x32x16_bf16 v[48:63], a[60:63], v[104:107], v[48:63]
    s_waitcnt lgkmcnt(4)
    v_mfma_f32_32x32x16_bf16 v[64:79], a[60:63], v[108:111], v[64:79]
    ds_read_b128 v[96:99], v1 offset:17408
    ds_read_b128 v[100:103], v1 offset:50176
    ds_read_b128 v[104:107], v11 offset:17408
    ds_read_b128 v[108:111], v11 offset:50176
    s_waitcnt vmcnt(44)
    s_waitcnt lgkmcnt(7)
    v_mfma_f32_32x32x16_bf16 v[16:31], a[64:67], v[80:83], v[16:31]
    s_waitcnt lgkmcnt(6)
    v_mfma_f32_32x32x16_bf16 v[32:47], a[64:67], v[84:87], v[32:47]
    s_waitcnt lgkmcnt(5)
    v_mfma_f32_32x32x16_bf16 v[48:63], a[64:67], v[88:91], v[48:63]
    s_waitcnt lgkmcnt(4)
    v_mfma_f32_32x32x16_bf16 v[64:79], a[64:67], v[92:95], v[64:79]
    ds_read_b128 v[80:83], v1 offset:18432
    ds_read_b128 v[84:87], v1 offset:51200
    ds_read_b128 v[88:91], v11 offset:18432
    ds_read_b128 v[92:95], v11 offset:51200
    s_waitcnt lgkmcnt(7)
    v_mfma_f32_32x32x16_bf16 v[16:31], a[68:71], v[96:99], v[16:31]
    s_waitcnt lgkmcnt(6)
    v_mfma_f32_32x32x16_bf16 v[32:47], a[68:71], v[100:103], v[32:47]
    s_waitcnt lgkmcnt(5)
    v_mfma_f32_32x32x16_bf16 v[48:63], a[68:71], v[104:107], v[48:63]
    s_waitcnt lgkmcnt(4)
    v_mfma_f32_32x32x16_bf16 v[64:79], a[68:71], v[108:111], v[64:79]
    ds_read_b128 v[96:99], v1 offset:19456
    ds_read_b128 v[100:103], v1 offset:52224
    ds_read_b128 v[104:107], v11 offset:19456
    ds_read_b128 v[108:111], v11 offset:52224
    s_waitcnt lgkmcnt(7)
    v_mfma_f32_32x32x16_bf16 v[16:31], a[72:75], v[80:83], v[16:31]
    s_waitcnt lgkmcnt(6)
    v_mfma_f32_32x32x16_bf16 v[32:47], a[72:75], v[84:87], v[32:47]
    s_waitcnt lgkmcnt(5)
    v_mfma_f32_32x32x16_bf16 v[48:63], a[72:75], v[88:91], v[48:63]
    s_waitcnt lgkmcnt(4)
    v_mfma_f32_32x32x16_bf16 v[64:79], a[72:75], v[92:95], v[64:79]
    s_waitcnt vmcnt(20)
    s_barrier
    ds_read_b128 v[80:83], v1 offset:20480
    ds_read_b128 v[84:87], v1 offset:53248
    ds_read_b128 v[88:91], v11 offset:20480
    ds_read_b128 v[92:95], v11 offset:53248
    s_waitcnt lgkmcnt(7)
    v_mfma_f32_32x32x16_bf16 v[16:31], a[76:79], v[96:99], v[16:31]
    s_waitcnt lgkmcnt(6)
    v_mfma_f32_32x32x16_bf16 v[32:47], a[76:79], v[100:103], v[32:47]
    s_waitcnt lgkmcnt(5)
    v_mfma_f32_32x32x16_bf16 v[48:63], a[76:79], v[104:107], v[48:63]
    s_waitcnt lgkmcnt(4)
    v_mfma_f32_32x32x16_bf16 v[64:79], a[76:79], v[108:111], v[64:79]
    ds_read_b128 v[96:99], v1 offset:21504
    ds_read_b128 v[100:103], v1 offset:54272
    ds_read_b128 v[104:107], v11 offset:21504
    ds_read_b128 v[108:111], v11 offset:54272
    s_waitcnt vmcnt(44)
    s_waitcnt lgkmcnt(7)
    v_mfma_f32_32x32x16_bf16 v[16:31], a[80:83], v[80:83], v[16:31]
    s_waitcnt vmcnt(8)
    v_add_f32 v168, v168, v170
    v_add_f32 v169, v169, v171
    s_waitcnt lgkmcnt(6)
    v_mfma_f32_32x32x16_bf16 v[32:47], a[80:83], v[84:87], v[32:47]
    v_add_f32 v168, v168, v172
    v_add_f32 v169, v169, v173
    v_add_f32 v168, v168, v174
    s_waitcnt lgkmcnt(5)
    v_mfma_f32_32x32x16_bf16 v[48:63], a[80:83], v[88:91], v[48:63]
    v_add_f32 v169, v169, v175
    v_add_f32 v168, v168, v176
    v_add_f32 v169, v169, v177
    s_waitcnt lgkmcnt(4)
    v_mfma_f32_32x32x16_bf16 v[64:79], a[80:83], v[92:95], v[64:79]
    v_add_f32 v168, v168, v178
    v_add_f32 v169, v169, v179
    v_add_f32 v168, v168, v180
    ds_read_b128 v[80:83], v1 offset:22528
    ds_read_b128 v[84:87], v1 offset:55296
    ds_read_b128 v[88:91], v11 offset:22528
    ds_read_b128 v[92:95], v11 offset:55296
    s_waitcnt lgkmcnt(7)
    v_mfma_f32_32x32x16_bf16 v[16:31], a[84:87], v[96:99], v[16:31]
    v_add_f32 v169, v169, v181
    v_add_f32 v168, v168, v182
    v_add_f32 v169, v169, v183
    s_waitcnt lgkmcnt(6)
    v_mfma_f32_32x32x16_bf16 v[32:47], a[84:87], v[100:103], v[32:47]
    v_mov_b32 v170, v168
    s_nop 1
    v_permlane32_swap_b32 v168, v170
    s_waitcnt lgkmcnt(5)
    v_mfma_f32_32x32x16_bf16 v[48:63], a[84:87], v[104:107], v[48:63]
    s_nop 1
    v_add_f32 v168, v168, v170
    s_waitcnt lgkmcnt(4)
    v_mfma_f32_32x32x16_bf16 v[64:79], a[84:87], v[108:111], v[64:79]
    v_mov_b32 v170, v169
    s_nop 1
    ds_read_b128 v[96:99], v1 offset:23552
    ds_read_b128 v[100:103], v1 offset:56320
    ds_read_b128 v[104:107], v11 offset:23552
    ds_read_b128 v[108:111], v11 offset:56320
    s_waitcnt lgkmcnt(7)
    v_mfma_f32_32x32x16_bf16 v[16:31], a[88:91], v[80:83], v[16:31]
    v_permlane32_swap_b32 v169, v170
    s_nop 1
    s_waitcnt lgkmcnt(6)
    v_mfma_f32_32x32x16_bf16 v[32:47], a[88:91], v[84:87], v[32:47]
    v_add_f32 v169, v169, v170
    v_mul_f32 v168, 0x3b000000, v168
    s_waitcnt lgkmcnt(5)
    v_mfma_f32_32x32x16_bf16 v[48:63], a[88:91], v[88:91], v[48:63]
    v_mul_f32 v169, 0x3b000000, v169
    v_fma_f32 v169, -v168, v168, v169
    s_waitcnt lgkmcnt(4)
    v_mfma_f32_32x32x16_bf16 v[64:79], a[88:91], v[92:95], v[64:79]
    v_max_f32 v169, 0, v169
    v_add_f32 v169, 0x3727c5ac, v169
    s_waitcnt vmcnt(4)
    s_barrier
    ds_read_b128 v[80:83], v1 offset:24576
    ds_read_b128 v[84:87], v1 offset:57344
    ds_read_b128 v[88:91], v11 offset:24576
    ds_read_b128 v[92:95], v11 offset:57344
    s_waitcnt lgkmcnt(7)
    v_mfma_f32_32x32x16_bf16 v[16:31], a[92:95], v[96:99], v[16:31]
    v_rsq_f32 v169, v169
    s_nop 0
    s_waitcnt lgkmcnt(6)
    v_mfma_f32_32x32x16_bf16 v[32:47], a[92:95], v[100:103], v[32:47]
    v_mul_f32 v168, v168, v169
    ds_write_b64 v12, v[168:169]
    s_waitcnt lgkmcnt(6)
    v_mfma_f32_32x32x16_bf16 v[48:63], a[92:95], v[104:107], v[48:63]
    s_waitcnt lgkmcnt(5)
    v_mfma_f32_32x32x16_bf16 v[64:79], a[92:95], v[108:111], v[64:79]
    ds_read_b128 v[96:99], v1 offset:25600
    ds_read_b128 v[100:103], v1 offset:58368
    ds_read_b128 v[104:107], v11 offset:25600
    ds_read_b128 v[108:111], v11 offset:58368
    s_waitcnt vmcnt(44)
    s_waitcnt lgkmcnt(8)
    v_mfma_f32_32x32x16_bf16 v[16:31], a[96:99], v[80:83], v[16:31]
    s_waitcnt lgkmcnt(7)
    v_mfma_f32_32x32x16_bf16 v[32:47], a[96:99], v[84:87], v[32:47]
    s_waitcnt lgkmcnt(6)
    v_mfma_f32_32x32x16_bf16 v[48:63], a[96:99], v[88:91], v[48:63]
    s_waitcnt lgkmcnt(5)
    v_mfma_f32_32x32x16_bf16 v[64:79], a[96:99], v[92:95], v[64:79]
    ds_read_b128 v[80:83], v1 offset:26624
    ds_read_b128 v[84:87], v1 offset:59392
    ds_read_b128 v[88:91], v11 offset:26624
    ds_read_b128 v[92:95], v11 offset:59392
    s_waitcnt lgkmcnt(7)
    v_mfma_f32_32x32x16_bf16 v[16:31], a[100:103], v[96:99], v[16:31]
    s_waitcnt lgkmcnt(6)
    v_mfma_f32_32x32x16_bf16 v[32:47], a[100:103], v[100:103], v[32:47]
    s_waitcnt lgkmcnt(5)
    v_mfma_f32_32x32x16_bf16 v[48:63], a[100:103], v[104:107], v[48:63]
    s_waitcnt lgkmcnt(4)
    v_mfma_f32_32x32x16_bf16 v[64:79], a[100:103], v[108:111], v[64:79]
    ds_read_b128 v[96:99], v1 offset:27648
    ds_read_b128 v[100:103], v1 offset:60416
    ds_read_b128 v[104:107], v11 offset:27648
    ds_read_b128 v[108:111], v11 offset:60416
    s_waitcnt lgkmcnt(7)
    v_mfma_f32_32x32x16_bf16 v[16:31], a[104:107], v[80:83], v[16:31]
    s_waitcnt lgkmcnt(6)
    v_mfma_f32_32x32x16_bf16 v[32:47], a[104:107], v[84:87], v[32:47]
    s_waitcnt lgkmcnt(5)
    v_mfma_f32_32x32x16_bf16 v[48:63], a[104:107], v[88:91], v[48:63]
    s_waitcnt lgkmcnt(4)
    v_mfma_f32_32x32x16_bf16 v[64:79], a[104:107], v[92:95], v[64:79]
    s_waitcnt vmcnt(0)
    s_waitcnt lgkmcnt(12)
    s_barrier
    ds_read_b64 v[144:145], v13 offset:0
    ds_read_b64 v[146:147], v13 offset:256
    ds_read_b64 v[148:149], v13 offset:512
    ds_read_b64 v[150:151], v13 offset:768
    ds_read_b128 v[80:83], v1 offset:28672
    ds_read_b128 v[84:87], v1 offset:61440
    ds_read_b128 v[88:91], v11 offset:28672
    ds_read_b128 v[92:95], v11 offset:61440
    s_waitcnt lgkmcnt(11)
    v_mfma_f32_32x32x16_bf16 v[16:31], a[108:111], v[96:99], v[16:31]
    s_waitcnt lgkmcnt(10)
    v_mfma_f32_32x32x16_bf16 v[32:47], a[108:111], v[100:103], v[32:47]
    s_waitcnt lgkmcnt(9)
    v_mfma_f32_32x32x16_bf16 v[48:63], a[108:111], v[104:107], v[48:63]
    s_waitcnt lgkmcnt(8)
    v_mfma_f32_32x32x16_bf16 v[64:79], a[108:111], v[108:111], v[64:79]
    ds_read_b128 v[96:99], v1 offset:29696
    ds_read_b128 v[100:103], v1 offset:62464
    ds_read_b128 v[104:107], v11 offset:29696
    ds_read_b128 v[108:111], v11 offset:62464
    s_waitcnt vmcnt(44)
    s_waitcnt lgkmcnt(7)
    v_mfma_f32_32x32x16_bf16 v[16:31], a[112:115], v[80:83], v[16:31]
    s_waitcnt lgkmcnt(6)
    v_mfma_f32_32x32x16_bf16 v[32:47], a[112:115], v[84:87], v[32:47]
    s_waitcnt lgkmcnt(5)
    v_mfma_f32_32x32x16_bf16 v[48:63], a[112:115], v[88:91], v[48:63]
    s_waitcnt lgkmcnt(4)
    v_mfma_f32_32x32x16_bf16 v[64:79], a[112:115], v[92:95], v[64:79]
    ds_read_b128 v[80:83], v1 offset:30720
    ds_read_b128 v[84:87], v1 offset:63488
    ds_read_b128 v[88:91], v11 offset:30720
    ds_read_b128 v[92:95], v11 offset:63488
    s_waitcnt lgkmcnt(7)
    v_mfma_f32_32x32x16_bf16 v[16:31], a[116:119], v[96:99], v[16:31]
    s_waitcnt lgkmcnt(6)
    v_mfma_f32_32x32x16_bf16 v[32:47], a[116:119], v[100:103], v[32:47]
    s_waitcnt lgkmcnt(5)
    v_mfma_f32_32x32x16_bf16 v[48:63], a[116:119], v[104:107], v[48:63]
    s_waitcnt lgkmcnt(4)
    v_mfma_f32_32x32x16_bf16 v[64:79], a[116:119], v[108:111], v[64:79]
    ds_read_b128 v[96:99], v1 offset:31744
    ds_read_b128 v[100:103], v1 offset:64512
    ds_read_b128 v[104:107], v11 offset:31744
    ds_read_b128 v[108:111], v11 offset:64512
    s_waitcnt lgkmcnt(7)
    v_mfma_f32_32x32x16_bf16 v[16:31], a[120:123], v[80:83], v[16:31]
    s_waitcnt lgkmcnt(6)
    v_mfma_f32_32x32x16_bf16 v[32:47], a[120:123], v[84:87], v[32:47]
    s_waitcnt lgkmcnt(5)
    v_mfma_f32_32x32x16_bf16 v[48:63], a[120:123], v[88:91], v[48:63]
    s_waitcnt lgkmcnt(4)
    v_mfma_f32_32x32x16_bf16 v[64:79], a[120:123], v[92:95], v[64:79]
    s_waitcnt lgkmcnt(3)
    v_mfma_f32_32x32x16_bf16 v[16:31], a[124:127], v[96:99], v[16:31]
    s_waitcnt lgkmcnt(2)
    v_mfma_f32_32x32x16_bf16 v[32:47], a[124:127], v[100:103], v[32:47]
    s_waitcnt lgkmcnt(1)
    v_mfma_f32_32x32x16_bf16 v[48:63], a[124:127], v[104:107], v[48:63]
    s_waitcnt lgkmcnt(0)
    v_mfma_f32_32x32x16_bf16 v[64:79], a[124:127], v[108:111], v[64:79]
    s_barrier
    s_lshr_b32 s44, s62, 2
    s_lshl_b32 s44, s44, 1
    s_lshl_b32 s45, s60, 2
    s_add_u32 s44, s44, s45
    s_and_b32 s45, s62, 3
    s_lshl_b32 s46, s61, 2
    s_add_u32 s45, s45, s46
    s_lshl_b32 s45, s45, 1
    s_and_b32 s46, s3, 1
    s_mov_b32 s47, 16539648
    s_mov_b32 s48, 3932160
    s_cmp_lt_u32 s3, 2
    s_cselect_b32 s49, s44, s45
    s_cselect_b32 s47, s47, s48
    s_add_u32 s49, s49, s46
    s_mul_i32 s49, s49, 114688
    s_add_u32 s50, s47, s49
    s_add_u32 s51, s50, 4096
    s_lshl_b32 s52, s3, 13
    s_add_u32 s53, s52, 4096
    s_cmp_lt_u32 s3, 2
    s_cbranch_scc1 L_pre_28
    s_add_u32 m0, s52, 0
    s_nop 0
    buffer_load_dwordx4 v1, s[4:7], s50 offen offset:0 sc1 lds
    buffer_load_dwordx4 v1, s[4:7], s50 offen offset:1024 sc1 lds
    buffer_load_dwordx4 v1, s[4:7], s50 offen offset:2048 sc1 lds
    buffer_load_dwordx4 v1, s[4:7], s50 offen offset:3072 sc1 lds
    s_add_u32 m0, s53, 0
    s_nop 0
    buffer_load_dwordx4 v1, s[4:7], s51 offen offset:0 sc1 lds
    buffer_load_dwordx4 v1, s[4:7], s51 offen offset:1024 sc1 lds
    buffer_load_dwordx4 v1, s[4:7], s51 offen offset:2048 sc1 lds
    buffer_load_dwordx4 v1, s[4:7], s51 offen offset:3072 sc1 lds
    s_add_u32 s50, s50, 8192
    s_add_u32 s51, s51, 8192
    s_add_u32 m0, s52, 32768
    s_nop 0
    buffer_load_dwordx4 v1, s[4:7], s50 offen offset:0 sc1 lds
    buffer_load_dwordx4 v1, s[4:7], s50 offen offset:1024 sc1 lds
    buffer_load_dwordx4 v1, s[4:7], s50 offen offset:2048 sc1 lds
    buffer_load_dwordx4 v1, s[4:7], s50 offen offset:3072 sc1 lds
    s_add_u32 m0, s53, 32768
    s_nop 0
    buffer_load_dwordx4 v1, s[4:7], s51 offen offset:0 sc1 lds
    buffer_load_dwordx4 v1, s[4:7], s51 offen offset:1024 sc1 lds
    buffer_load_dwordx4 v1, s[4:7], s51 offen offset:2048 sc1 lds
    buffer_load_dwordx4 v1, s[4:7], s51 offen offset:3072 sc1 lds
    s_add_u32 s50, s50, 8192
    s_add_u32 s51, s51, 8192
    s_add_u32 m0, s52, 65536
    s_nop 0
    buffer_load_dwordx4 v1, s[4:7], s50 offen offset:0 sc1 lds
    buffer_load_dwordx4 v1, s[4:7], s50 offen offset:1024 sc1 lds
    buffer_load_dwordx4 v1, s[4:7], s50 offen offset:2048 sc1 lds
    buffer_load_dwordx4 v1, s[4:7], s50 offen offset:3072 sc1 lds
    s_add_u32 m0, s53, 65536
    s_nop 0
    buffer_load_dwordx4 v1, s[4:7], s51 offen offset:0 sc1 lds
    buffer_load_dwordx4 v1, s[4:7], s51 offen offset:1024 sc1 lds
    buffer_load_dwordx4 v1, s[4:7], s51 offen offset:2048 sc1 lds
    buffer_load_dwordx4 v1, s[4:7], s51 offen offset:3072 sc1 lds
    s_add_u32 s50, s50, 8192
    s_add_u32 s51, s51, 8192
L_pre_28:
    s_nop 15
    s_nop 3
    s_waitcnt lgkmcnt(15)
    v_pk_fma_f32 v[152:153], v[144:145], v[112:113], v[128:129] op_sel:[0,0,0] op_sel_hi:[0,1,1] neg_lo:[1,0,0] neg_hi:[1,0,0]
    v_pk_fma_f32 v[16:17], v[16:17], v[144:145], v[152:153] op_sel:[0,1,0] op_sel_hi:[1,1,1]
    v_pk_mul_f32 v[152:153], v[16:17], s[32:33]
    v_pk_fma_f32 v[156:157], v[144:145], v[114:115], v[130:131] op_sel:[0,0,0] op_sel_hi:[0,1,1] neg_lo:[1,0,0] neg_hi:[1,0,0]
    v_pk_fma_f32 v[18:19], v[18:19], v[144:145], v[156:157] op_sel:[0,1,0] op_sel_hi:[1,1,1]
    v_pk_mul_f32 v[156:157], v[18:19], s[32:33]
    v_pk_fma_f32 v[160:161], v[144:145], v[116:117], v[132:133] op_sel:[0,0,0] op_sel_hi:[0,1,1] neg_lo:[1,0,0] neg_hi:[1,0,0]
    v_pk_fma_f32 v[20:21], v[20:21], v[144:145], v[160:161] op_sel:[0,1,0] op_sel_hi:[1,1,1]
    v_pk_mul_f32 v[160:161], v[20:21], s[32:33]
    v_pk_fma_f32 v[164:165], v[144:145], v[118:119], v[134:135] op_sel:[0,0,0] op_sel_hi:[0,1,1] neg_lo:[1,0,0] neg_hi:[1,0,0]
    v_pk_fma_f32 v[22:23], v[22:23], v[144:145], v[164:165] op_sel:[0,1,0] op_sel_hi:[1,1,1]
    v_pk_mul_f32 v[164:165], v[22:23], s[32:33]
    v_exp_f32 v152, v152
    v_exp_f32 v153, v153
    v_exp_f32 v156, v156
    v_exp_f32 v157, v157
    v_exp_f32 v160, v160
    v_exp_f32 v161, v161
    v_exp_f32 v164, v164
    v_exp_f32 v165, v165
    v_pk_add_f32 v[154:155], v[152:153], s[34:35]
    v_pk_fma_f32 v[152:153], v[152:153], v[154:155], s[34:35]
    v_pk_add_f32 v[158:159], v[156:157], s[34:35]
    v_pk_fma_f32 v[156:157], v[156:157], v[158:159], s[34:35]
    v_pk_add_f32 v[162:163], v[160:161], s[34:35]
    v_pk_fma_f32 v[160:161], v[160:161], v[162:163], s[34:35]
    v_pk_add_f32 v[166:167], v[164:165], s[34:35]
    v_pk_fma_f32 v[164:165], v[164:165], v[166:167], s[34:35]
    v_rcp_f32 v152, v152
    v_rcp_f32 v153, v153
    v_rcp_f32 v156, v156
    v_rcp_f32 v157, v157
    v_rcp_f32 v160, v160
    v_rcp_f32 v161, v161
    v_rcp_f32 v164, v164
    v_rcp_f32 v165, v165
    v_pk_mul_f32 v[152:153], v[16:17], v[152:153]
    v_pk_mul_f32 v[156:157], v[18:19], v[156:157]
    v_pk_mul_f32 v[160:161], v[20:21], v[160:161]
    v_pk_mul_f32 v[164:165], v[22:23], v[164:165]
    v_pk_fma_f32 v[16:17], v[152:153], s[36:37], v[16:17]
    v_pk_fma_f32 v[18:19], v[156:157], s[36:37], v[18:19]
    v_pk_fma_f32 v[20:21], v[160:161], s[36:37], v[20:21]
    v_pk_fma_f32 v[22:23], v[164:165], s[36:37], v[22:23]
    v_pk_fma_f32 v[152:153], v[144:145], v[120:121], v[136:137] op_sel:[0,0,0] op_sel_hi:[0,1,1] neg_lo:[1,0,0] neg_hi:[1,0,0]
    v_pk_fma_f32 v[24:25], v[24:25], v[144:145], v[152:153] op_sel:[0,1,0] op_sel_hi:[1,1,1]
    v_pk_mul_f32 v[152:153], v[24:25], s[32:33]
    v_pk_fma_f32 v[156:157], v[144:145], v[122:123], v[138:139] op_sel:[0,0,0] op_sel_hi:[0,1,1] neg_lo:[1,0,0] neg_hi:[1,0,0]
    v_pk_fma_f32 v[26:27], v[26:27], v[144:145], v[156:157] op_sel:[0,1,0] op_sel_hi:[1,1,1]
    v_pk_mul_f32 v[156:157], v[26:27], s[32:33]
    v_pk_fma_f32 v[160:161], v[144:145], v[124:125], v[140:141] op_sel:[0,0,0] op_sel_hi:[0,1,1] neg_lo:[1,0,0] neg_hi:[1,0,0]
    v_pk_fma_f32 v[28:29], v[28:29], v[144:145], v[160:161] op_sel:[0,1,0] op_sel_hi:[1,1,1]
    v_pk_mul_f32 v[160:161], v[28:29], s[32:33]
    v_pk_fma_f32 v[164:165], v[144:145], v[126:127], v[142:143] op_sel:[0,0,0] op_sel_hi:[0,1,1] neg_lo:[1,0,0] neg_hi:[1,0,0]
    v_pk_fma_f32 v[30:31], v[30:31], v[144:145], v[164:165] op_sel:[0,1,0] op_sel_hi:[1,1,1]
    v_pk_mul_f32 v[164:165], v[30:31], s[32:33]
    v_exp_f32 v152, v152
    v_exp_f32 v153, v153
    v_exp_f32 v156, v156
    v_exp_f32 v157, v157
    v_exp_f32 v160, v160
    v_exp_f32 v161, v161
    v_exp_f32 v164, v164
    v_exp_f32 v165, v165
    v_pk_add_f32 v[154:155], v[152:153], s[34:35]
    v_pk_fma_f32 v[152:153], v[152:153], v[154:155], s[34:35]
    v_pk_add_f32 v[158:159], v[156:157], s[34:35]
    v_pk_fma_f32 v[156:157], v[156:157], v[158:159], s[34:35]
    v_pk_add_f32 v[162:163], v[160:161], s[34:35]
    v_pk_fma_f32 v[160:161], v[160:161], v[162:163], s[34:35]
    v_pk_add_f32 v[166:167], v[164:165], s[34:35]
    v_pk_fma_f32 v[164:165], v[164:165], v[166:167], s[34:35]
    v_rcp_f32 v152, v152
    v_rcp_f32 v153, v153
    v_rcp_f32 v156, v156
    v_rcp_f32 v157, v157
    v_rcp_f32 v160, v160
    v_rcp_f32 v161, v161
    v_rcp_f32 v164, v164
    v_rcp_f32 v165, v165
    v_pk_mul_f32 v[152:153], v[24:25], v[152:153]
    v_pk_mul_f32 v[156:157], v[26:27], v[156:157]
    v_pk_mul_f32 v[160:161], v[28:29], v[160:161]
    v_pk_mul_f32 v[164:165], v[30:31], v[164:165]
    v_pk_fma_f32 v[24:25], v[152:153], s[36:37], v[24:25]
    v_pk_fma_f32 v[26:27], v[156:157], s[36:37], v[26:27]
    v_pk_fma_f32 v[28:29], v[160:161], s[36:37], v[28:29]
    v_pk_fma_f32 v[30:31], v[164:165], s[36:37], v[30:31]
    v_cvt_pk_bf16_f32 v16, v16, v17
    v_cvt_pk_bf16_f32 v17, v18, v19
    v_cvt_pk_bf16_f32 v18, v20, v21
    v_cvt_pk_bf16_f32 v19, v22, v23
    v_cvt_pk_bf16_f32 v20, v24, v25
    v_cvt_pk_bf16_f32 v21, v26, v27
    v_cvt_pk_bf16_f32 v22, v28, v29
    v_cvt_pk_bf16_f32 v23, v30, v31
    buffer_store_dwordx4 v[16:19], v1, s[4:7], s30 offen sc1
    buffer_store_dwordx4 v[20:23], v1, s[4:7], s30 offen offset:1024 sc1
    s_add_u32 s30, s30, 114688
    s_waitcnt lgkmcnt(15)
    v_pk_fma_f32 v[152:153], v[146:147], v[112:113], v[128:129] op_sel:[0,0,0] op_sel_hi:[0,1,1] neg_lo:[1,0,0] neg_hi:[1,0,0]
    v_pk_fma_f32 v[32:33], v[32:33], v[146:147], v[152:153] op_sel:[0,1,0] op_sel_hi:[1,1,1]
    v_pk_mul_f32 v[152:153], v[32:33], s[32:33]
    v_pk_fma_f32 v[156:157], v[146:147], v[114:115], v[130:131] op_sel:[0,0,0] op_sel_hi:[0,1,1] neg_lo:[1,0,0] neg_hi:[1,0,0]
    v_pk_fma_f32 v[34:35], v[34:35], v[146:147], v[156:157] op_sel:[0,1,0] op_sel_hi:[1,1,1]
    v_pk_mul_f32 v[156:157], v[34:35], s[32:33]
    v_pk_fma_f32 v[160:161], v[146:147], v[116:117], v[132:133] op_sel:[0,0,0] op_sel_hi:[0,1,1] neg_lo:[1,0,0] neg_hi:[1,0,0]
    v_pk_fma_f32 v[36:37], v[36:37], v[146:147], v[160:161] op_sel:[0,1,0] op_sel_hi:[1,1,1]
    v_pk_mul_f32 v[160:161], v[36:37], s[32:33]
    v_pk_fma_f32 v[164:165], v[146:147], v[118:119], v[134:135] op_sel:[0,0,0] op_sel_hi:[0,1,1] neg_lo:[1,0,0] neg_hi:[1,0,0]
    v_pk_fma_f32 v[38:39], v[38:39], v[146:147], v[164:165] op_sel:[0,1,0] op_sel_hi:[1,1,1]
    v_pk_mul_f32 v[164:165], v[38:39], s[32:33]
    v_exp_f32 v152, v152
    v_exp_f32 v153, v153
    v_exp_f32 v156, v156
    v_exp_f32 v157, v157
    v_exp_f32 v160, v160
    v_exp_f32 v161, v161
    v_exp_f32 v164, v164
    v_exp_f32 v165, v165
    v_pk_add_f32 v[154:155], v[152:153], s[34:35]
    v_pk_fma_f32 v[152:153], v[152:153], v[154:155], s[34:35]
    v_pk_add_f32 v[158:159], v[156:157], s[34:35]
    v_pk_fma_f32 v[156:157], v[156:157], v[158:159], s[34:35]
    v_pk_add_f32 v[162:163], v[160:161], s[34:35]
    v_pk_fma_f32 v[160:161], v[160:161], v[162:163], s[34:35]
    v_pk_add_f32 v[166:167], v[164:165], s[34:35]
    v_pk_fma_f32 v[164:165], v[164:165], v[166:167], s[34:35]
    v_rcp_f32 v152, v152
    v_rcp_f32 v153, v153
    v_rcp_f32 v156, v156
    v_rcp_f32 v157, v157
    v_rcp_f32 v160, v160
    v_rcp_f32 v161, v161
    v_rcp_f32 v164, v164
    v_rcp_f32 v165, v165
    v_pk_mul_f32 v[152:153], v[32:33], v[152:153]
    v_pk_mul_f32 v[156:157], v[34:35], v[156:157]
    v_pk_mul_f32 v[160:161], v[36:37], v[160:161]
    v_pk_mul_f32 v[164:165], v[38:39], v[164:165]
    v_pk_fma_f32 v[32:33], v[152:153], s[36:37], v[32:33]
    v_pk_fma_f32 v[34:35], v[156:157], s[36:37], v[34:35]
    v_pk_fma_f32 v[36:37], v[160:161], s[36:37], v[36:37]
    v_pk_fma_f32 v[38:39], v[164:165], s[36:37], v[38:39]
    v_pk_fma_f32 v[152:153], v[146:147], v[120:121], v[136:137] op_sel:[0,0,0] op_sel_hi:[0,1,1] neg_lo:[1,0,0] neg_hi:[1,0,0]
    v_pk_fma_f32 v[40:41], v[40:41], v[146:147], v[152:153] op_sel:[0,1,0] op_sel_hi:[1,1,1]
    v_pk_mul_f32 v[152:153], v[40:41], s[32:33]
    v_pk_fma_f32 v[156:157], v[146:147], v[122:123], v[138:139] op_sel:[0,0,0] op_sel_hi:[0,1,1] neg_lo:[1,0,0] neg_hi:[1,0,0]
    v_pk_fma_f32 v[42:43], v[42:43], v[146:147], v[156:157] op_sel:[0,1,0] op_sel_hi:[1,1,1]
    v_pk_mul_f32 v[156:157], v[42:43], s[32:33]
    v_pk_fma_f32 v[160:161], v[146:147], v[124:125], v[140:141] op_sel:[0,0,0] op_sel_hi:[0,1,1] neg_lo:[1,0,0] neg_hi:[1,0,0]
    v_pk_fma_f32 v[44:45], v[44:45], v[146:147], v[160:161] op_sel:[0,1,0] op_sel_hi:[1,1,1]
    v_pk_mul_f32 v[160:161], v[44:45], s[32:33]
    v_pk_fma_f32 v[164:165], v[146:147], v[126:127], v[142:143] op_sel:[0,0,0] op_sel_hi:[0,1,1] neg_lo:[1,0,0] neg_hi:[1,0,0]
    v_pk_fma_f32 v[46:47], v[46:47], v[146:147], v[164:165] op_sel:[0,1,0] op_sel_hi:[1,1,1]
    v_pk_mul_f32 v[164:165], v[46:47], s[32:33]
    v_exp_f32 v152, v152
    v_exp_f32 v153, v153
    v_exp_f32 v156, v156
    v_exp_f32 v157, v157
    v_exp_f32 v160, v160
    v_exp_f32 v161, v161
    v_exp_f32 v164, v164
    v_exp_f32 v165, v165
    v_pk_add_f32 v[154:155], v[152:153], s[34:35]
    v_pk_fma_f32 v[152:153], v[152:153], v[154:155], s[34:35]
    v_pk_add_f32 v[158:159], v[156:157], s[34:35]
    v_pk_fma_f32 v[156:157], v[156:157], v[158:159], s[34:35]
    v_pk_add_f32 v[162:163], v[160:161], s[34:35]
    v_pk_fma_f32 v[160:161], v[160:161], v[162:163], s[34:35]
    v_pk_add_f32 v[166:167], v[164:165], s[34:35]
    v_pk_fma_f32 v[164:165], v[164:165], v[166:167], s[34:35]
    v_rcp_f32 v152, v152
    v_rcp_f32 v153, v153
    v_rcp_f32 v156, v156
    v_rcp_f32 v157, v157
    v_rcp_f32 v160, v160
    v_rcp_f32 v161, v161
    v_rcp_f32 v164, v164
    v_rcp_f32 v165, v165
    v_pk_mul_f32 v[152:153], v[40:41], v[152:153]
    v_pk_mul_f32 v[156:157], v[42:43], v[156:157]
    v_pk_mul_f32 v[160:161], v[44:45], v[160:161]
    v_pk_mul_f32 v[164:165], v[46:47], v[164:165]
    v_pk_fma_f32 v[40:41], v[152:153], s[36:37], v[40:41]
    v_pk_fma_f32 v[42:43], v[156:157], s[36:37], v[42:43]
    v_pk_fma_f32 v[44:45], v[160:161], s[36:37], v[44:45]
    v_pk_fma_f32 v[46:47], v[164:165], s[36:37], v[46:47]
    v_cvt_pk_bf16_f32 v32, v32, v33
    v_cvt_pk_bf16_f32 v33, v34, v35
    v_cvt_pk_bf16_f32 v34, v36, v37
    v_cvt_pk_bf16_f32 v35, v38, v39
    v_cvt_pk_bf16_f32 v36, v40, v41
    v_cvt_pk_bf16_f32 v37, v42, v43
    v_cvt_pk_bf16_f32 v38, v44, v45
    v_cvt_pk_bf16_f32 v39, v46, v47
    buffer_store_dwordx4 v[32:35], v1, s[4:7], s30 offen sc1
    buffer_store_dwordx4 v[36:39], v1, s[4:7], s30 offen offset:1024 sc1
    s_add_u32 s30, s30, 114688
    s_waitcnt lgkmcnt(15)
    v_pk_fma_f32 v[152:153], v[148:149], v[112:113], v[128:129] op_sel:[0,0,0] op_sel_hi:[0,1,1] neg_lo:[1,0,0] neg_hi:[1,0,0]
    v_pk_fma_f32 v[48:49], v[48:49], v[148:149], v[152:153] op_sel:[0,1,0] op_sel_hi:[1,1,1]
    v_pk_mul_f32 v[152:153], v[48:49], s[32:33]
    v_pk_fma_f32 v[156:157], v[148:149], v[114:115], v[130:131] op_sel:[0,0,0] op_sel_hi:[0,1,1] neg_lo:[1,0,0] neg_hi:[1,0,0]
    v_pk_fma_f32 v[50:51], v[50:51], v[148:149], v[156:157] op_sel:[0,1,0] op_sel_hi:[1,1,1]
    v_pk_mul_f32 v[156:157], v[50:51], s[32:33]
    v_pk_fma_f32 v[160:161], v[148:149], v[116:117], v[132:133] op_sel:[0,0,0] op_sel_hi:[0,1,1] neg_lo:[1,0,0] neg_hi:[1,0,0]
    v_pk_fma_f32 v[52:53], v[52:53], v[148:149], v[160:161] op_sel:[0,1,0] op_sel_hi:[1,1,1]
    v_pk_mul_f32 v[160:161], v[52:53], s[32:33]
    v_pk_fma_f32 v[164:165], v[148:149], v[118:119], v[134:135] op_sel:[0,0,0] op_sel_hi:[0,1,1] neg_lo:[1,0,0] neg_hi:[1,0,0]
    v_pk_fma_f32 v[54:55], v[54:55], v[148:149], v[164:165] op_sel:[0,1,0] op_sel_hi:[1,1,1]
    v_pk_mul_f32 v[164:165], v[54:55], s[32:33]
    v_exp_f32 v152, v152
    v_exp_f32 v153, v153
    v_exp_f32 v156, v156
    v_exp_f32 v157, v157
    v_exp_f32 v160, v160
    v_exp_f32 v161, v161
    v_exp_f32 v164, v164
    v_exp_f32 v165, v165
    v_pk_add_f32 v[154:155], v[152:153], s[34:35]
    v_pk_fma_f32 v[152:153], v[152:153], v[154:155], s[34:35]
    v_pk_add_f32 v[158:159], v[156:157], s[34:35]
    v_pk_fma_f32 v[156:157], v[156:157], v[158:159], s[34:35]
    v_pk_add_f32 v[162:163], v[160:161], s[34:35]
    v_pk_fma_f32 v[160:161], v[160:161], v[162:163], s[34:35]
    v_pk_add_f32 v[166:167], v[164:165], s[34:35]
    v_pk_fma_f32 v[164:165], v[164:165], v[166:167], s[34:35]
    v_rcp_f32 v152, v152
    v_rcp_f32 v153, v153
    v_rcp_f32 v156, v156
    v_rcp_f32 v157, v157
    v_rcp_f32 v160, v160
    v_rcp_f32 v161, v161
    v_rcp_f32 v164, v164
    v_rcp_f32 v165, v165
    v_pk_mul_f32 v[152:153], v[48:49], v[152:153]
    v_pk_mul_f32 v[156:157], v[50:51], v[156:157]
    v_pk_mul_f32 v[160:161], v[52:53], v[160:161]
    v_pk_mul_f32 v[164:165], v[54:55], v[164:165]
    v_pk_fma_f32 v[48:49], v[152:153], s[36:37], v[48:49]
    v_pk_fma_f32 v[50:51], v[156:157], s[36:37], v[50:51]
    v_pk_fma_f32 v[52:53], v[160:161], s[36:37], v[52:53]
    v_pk_fma_f32 v[54:55], v[164:165], s[36:37], v[54:55]
    v_pk_fma_f32 v[152:153], v[148:149], v[120:121], v[136:137] op_sel:[0,0,0] op_sel_hi:[0,1,1] neg_lo:[1,0,0] neg_hi:[1,0,0]
    v_pk_fma_f32 v[56:57], v[56:57], v[148:149], v[152:153] op_sel:[0,1,0] op_sel_hi:[1,1,1]
    v_pk_mul_f32 v[152:153], v[56:57], s[32:33]
    v_pk_fma_f32 v[156:157], v[148:149], v[122:123], v[138:139] op_sel:[0,0,0] op_sel_hi:[0,1,1] neg_lo:[1,0,0] neg_hi:[1,0,0]
    v_pk_fma_f32 v[58:59], v[58:59], v[148:149], v[156:157] op_sel:[0,1,0] op_sel_hi:[1,1,1]
    v_pk_mul_f32 v[156:157], v[58:59], s[32:33]
    v_pk_fma_f32 v[160:161], v[148:149], v[124:125], v[140:141] op_sel:[0,0,0] op_sel_hi:[0,1,1] neg_lo:[1,0,0] neg_hi:[1,0,0]
    v_pk_fma_f32 v[60:61], v[60:61], v[148:149], v[160:161] op_sel:[0,1,0] op_sel_hi:[1,1,1]
    v_pk_mul_f32 v[160:161], v[60:61], s[32:33]
    v_pk_fma_f32 v[164:165], v[148:149], v[126:127], v[142:143] op_sel:[0,0,0] op_sel_hi:[0,1,1] neg_lo:[1,0,0] neg_hi:[1,0,0]
    v_pk_fma_f32 v[62:63], v[62:63], v[148:149], v[164:165] op_sel:[0,1,0] op_sel_hi:[1,1,1]
    v_pk_mul_f32 v[164:165], v[62:63], s[32:33]
    v_exp_f32 v152, v152
    v_exp_f32 v153, v153
    v_exp_f32 v156, v156
    v_exp_f32 v157, v157
    v_exp_f32 v160, v160
    v_exp_f32 v161, v161
    v_exp_f32 v164, v164
    v_exp_f32 v165, v165
    v_pk_add_f32 v[154:155], v[152:153], s[34:35]
    v_pk_fma_f32 v[152:153], v[152:153], v[154:155], s[34:35]
    v_pk_add_f32 v[158:159], v[156:157], s[34:35]
    v_pk_fma_f32 v[156:157], v[156:157], v[158:159], s[34:35]
    v_pk_add_f32 v[162:163], v[160:161], s[34:35]
    v_pk_fma_f32 v[160:161], v[160:161], v[162:163], s[34:35]
    v_pk_add_f32 v[166:167], v[164:165], s[34:35]
    v_pk_fma_f32 v[164:165], v[164:165], v[166:167], s[34:35]
    v_rcp_f32 v152, v152
    v_rcp_f32 v153, v153
    v_rcp_f32 v156, v156
    v_rcp_f32 v157, v157
    v_rcp_f32 v160, v160
    v_rcp_f32 v161, v161
    v_rcp_f32 v164, v164
    v_rcp_f32 v165, v165
    v_pk_mul_f32 v[152:153], v[56:57], v[152:153]
    v_pk_mul_f32 v[156:157], v[58:59], v[156:157]
    v_pk_mul_f32 v[160:161], v[60:61], v[160:161]
    v_pk_mul_f32 v[164:165], v[62:63], v[164:165]
    v_pk_fma_f32 v[56:57], v[152:153], s[36:37], v[56:57]
    v_pk_fma_f32 v[58:59], v[156:157], s[36:37], v[58:59]
    v_pk_fma_f32 v[60:61], v[160:161], s[36:37], v[60:61]
    v_pk_fma_f32 v[62:63], v[164:165], s[36:37], v[62:63]
    v_cvt_pk_bf16_f32 v48, v48, v49
    v_cvt_pk_bf16_f32 v49, v50, v51
    v_cvt_pk_bf16_f32 v50, v52, v53
    v_cvt_pk_bf16_f32 v51, v54, v55
    v_cvt_pk_bf16_f32 v52, v56, v57
    v_cvt_pk_bf16_f32 v53, v58, v59
    v_cvt_pk_bf16_f32 v54, v60, v61
    v_cvt_pk_bf16_f32 v55, v62, v63
    buffer_store_dwordx4 v[48:51], v1, s[4:7], s30 offen sc1
    buffer_store_dwordx4 v[52:55], v1, s[4:7], s30 offen offset:1024 sc1
    s_add_u32 s30, s30, 114688
    s_waitcnt lgkmcnt(15)
    v_pk_fma_f32 v[152:153], v[150:151], v[112:113], v[128:129] op_sel:[0,0,0] op_sel_hi:[0,1,1] neg_lo:[1,0,0] neg_hi:[1,0,0]
    v_pk_fma_f32 v[64:65], v[64:65], v[150:151], v[152:153] op_sel:[0,1,0] op_sel_hi:[1,1,1]
    v_pk_mul_f32 v[152:153], v[64:65], s[32:33]
    v_pk_fma_f32 v[156:157], v[150:151], v[114:115], v[130:131] op_sel:[0,0,0] op_sel_hi:[0,1,1] neg_lo:[1,0,0] neg_hi:[1,0,0]
    v_pk_fma_f32 v[66:67], v[66:67], v[150:151], v[156:157] op_sel:[0,1,0] op_sel_hi:[1,1,1]
    v_pk_mul_f32 v[156:157], v[66:67], s[32:33]
    v_pk_fma_f32 v[160:161], v[150:151], v[116:117], v[132:133] op_sel:[0,0,0] op_sel_hi:[0,1,1] neg_lo:[1,0,0] neg_hi:[1,0,0]
    v_pk_fma_f32 v[68:69], v[68:69], v[150:151], v[160:161] op_sel:[0,1,0] op_sel_hi:[1,1,1]
    v_pk_mul_f32 v[160:161], v[68:69], s[32:33]
    v_pk_fma_f32 v[164:165], v[150:151], v[118:119], v[134:135] op_sel:[0,0,0] op_sel_hi:[0,1,1] neg_lo:[1,0,0] neg_hi:[1,0,0]
    v_pk_fma_f32 v[70:71], v[70:71], v[150:151], v[164:165] op_sel:[0,1,0] op_sel_hi:[1,1,1]
    v_pk_mul_f32 v[164:165], v[70:71], s[32:33]
    v_exp_f32 v152, v152
    v_exp_f32 v153, v153
    v_exp_f32 v156, v156
    v_exp_f32 v157, v157
    v_exp_f32 v160, v160
    v_exp_f32 v161, v161
    v_exp_f32 v164, v164
    v_exp_f32 v165, v165
    v_pk_add_f32 v[154:155], v[152:153], s[34:35]
    v_pk_fma_f32 v[152:153], v[152:153], v[154:155], s[34:35]
    v_pk_add_f32 v[158:159], v[156:157], s[34:35]
    v_pk_fma_f32 v[156:157], v[156:157], v[158:159], s[34:35]
    v_pk_add_f32 v[162:163], v[160:161], s[34:35]
    v_pk_fma_f32 v[160:161], v[160:161], v[162:163], s[34:35]
    v_pk_add_f32 v[166:167], v[164:165], s[34:35]
    v_pk_fma_f32 v[164:165], v[164:165], v[166:167], s[34:35]
    v_rcp_f32 v152, v152
    v_rcp_f32 v153, v153
    v_rcp_f32 v156, v156
    v_rcp_f32 v157, v157
    v_rcp_f32 v160, v160
    v_rcp_f32 v161, v161
    v_rcp_f32 v164, v164
    v_rcp_f32 v165, v165
    v_pk_mul_f32 v[152:153], v[64:65], v[152:153]
    v_pk_mul_f32 v[156:157], v[66:67], v[156:157]
    v_pk_mul_f32 v[160:161], v[68:69], v[160:161]
    v_pk_mul_f32 v[164:165], v[70:71], v[164:165]
    v_pk_fma_f32 v[64:65], v[152:153], s[36:37], v[64:65]
    v_pk_fma_f32 v[66:67], v[156:157], s[36:37], v[66:67]
    v_pk_fma_f32 v[68:69], v[160:161], s[36:37], v[68:69]
    v_pk_fma_f32 v[70:71], v[164:165], s[36:37], v[70:71]
    v_pk_fma_f32 v[152:153], v[150:151], v[120:121], v[136:137] op_sel:[0,0,0] op_sel_hi:[0,1,1] neg_lo:[1,0,0] neg_hi:[1,0,0]
    v_pk_fma_f32 v[72:73], v[72:73], v[150:151], v[152:153] op_sel:[0,1,0] op_sel_hi:[1,1,1]
    v_pk_mul_f32 v[152:153], v[72:73], s[32:33]
    v_pk_fma_f32 v[156:157], v[150:151], v[122:123], v[138:139] op_sel:[0,0,0] op_sel_hi:[0,1,1] neg_lo:[1,0,0] neg_hi:[1,0,0]
    v_pk_fma_f32 v[74:75], v[74:75], v[150:151], v[156:157] op_sel:[0,1,0] op_sel_hi:[1,1,1]
    v_pk_mul_f32 v[156:157], v[74:75], s[32:33]
    v_pk_fma_f32 v[160:161], v[150:151], v[124:125], v[140:141] op_sel:[0,0,0] op_sel_hi:[0,1,1] neg_lo:[1,0,0] neg_hi:[1,0,0]
    v_pk_fma_f32 v[76:77], v[76:77], v[150:151], v[160:161] op_sel:[0,1,0] op_sel_hi:[1,1,1]
    v_pk_mul_f32 v[160:161], v[76:77], s[32:33]
    v_pk_fma_f32 v[164:165], v[150:151], v[126:127], v[142:143] op_sel:[0,0,0] op_sel_hi:[0,1,1] neg_lo:[1,0,0] neg_hi:[1,0,0]
    v_pk_fma_f32 v[78:79], v[78:79], v[150:151], v[164:165] op_sel:[0,1,0] op_sel_hi:[1,1,1]
    v_pk_mul_f32 v[164:165], v[78:79], s[32:33]
    v_exp_f32 v152, v152
    v_exp_f32 v153, v153
    v_exp_f32 v156, v156
    v_exp_f32 v157, v157
    v_exp_f32 v160, v160
    v_exp_f32 v161, v161
    v_exp_f32 v164, v164
    v_exp_f32 v165, v165
    v_pk_add_f32 v[154:155], v[152:153], s[34:35]
    v_pk_fma_f32 v[152:153], v[152:153], v[154:155], s[34:35]
    v_pk_add_f32 v[158:159], v[156:157], s[34:35]
    v_pk_fma_f32 v[156:157], v[156:157], v[158:159], s[34:35]
    v_pk_add_f32 v[162:163], v[160:161], s[34:35]
    v_pk_fma_f32 v[160:161], v[160:161], v[162:163], s[34:35]
    v_pk_add_f32 v[166:167], v[164:165], s[34:35]
    v_pk_fma_f32 v[164:165], v[164:165], v[166:167], s[34:35]
    v_rcp_f32 v152, v152
    v_rcp_f32 v153, v153
    v_rcp_f32 v156, v156
    v_rcp_f32 v157, v157
    v_rcp_f32 v160, v160
    v_rcp_f32 v161, v161
    v_rcp_f32 v164, v164
    v_rcp_f32 v165, v165
    v_pk_mul_f32 v[152:153], v[72:73], v[152:153]
    v_pk_mul_f32 v[156:157], v[74:75], v[156:157]
    v_pk_mul_f32 v[160:161], v[76:77], v[160:161]
    v_pk_mul_f32 v[164:165], v[78:79], v[164:165]
    v_pk_fma_f32 v[72:73], v[152:153], s[36:37], v[72:73]
    v_pk_fma_f32 v[74:75], v[156:157], s[36:37], v[74:75]
    v_pk_fma_f32 v[76:77], v[160:161], s[36:37], v[76:77]
    v_pk_fma_f32 v[78:79], v[164:165], s[36:37], v[78:79]
    v_cvt_pk_bf16_f32 v64, v64, v65
    v_cvt_pk_bf16_f32 v65, v66, v67
    v_cvt_pk_bf16_f32 v66, v68, v69
    v_cvt_pk_bf16_f32 v67, v70, v71
    v_cvt_pk_bf16_f32 v68, v72, v73
    v_cvt_pk_bf16_f32 v69, v74, v75
    v_cvt_pk_bf16_f32 v70, v76, v77
    v_cvt_pk_bf16_f32 v71, v78, v79
    buffer_store_dwordx4 v[64:67], v1, s[4:7], s30 offen sc1
    buffer_store_dwordx4 v[68:71], v1, s[4:7], s30 offen offset:1024 sc1
    s_add_u32 s30, s30, 114688
    s_waitcnt vmcnt(0)
    s_barrier
    s_cmp_lg_u32 s3, 0
    s_cbranch_scc1 L_pub_29
    s_lshl_b32 s64, s60, 7
    s_lshl_b32 s65, s61, 5
    s_add_u32 s64, s64, s65
    s_lshl_b32 s65, s62, 2
    s_add_u32 s64, s64, s65
    s_add_u32 s64, s64, 28600320
    v_mov_b32 v2, 0
    v_mov_b32 v3, 1
    s_mov_b64 exec, 1
    buffer_store_dword v3, v2, s[4:7], s64 offen sc1
    s_mov_b64 exec, -1
L_pub_29:
    s_branch L_joinw1_23
L_skipw1_22:
    s_lshr_b32 s44, s62, 2
    s_lshl_b32 s44, s44, 1
    s_lshl_b32 s45, s60, 2
    s_add_u32 s44, s44, s45
    s_and_b32 s45, s62, 3
    s_lshl_b32 s46, s61, 2
    s_add_u32 s45, s45, s46
    s_lshl_b32 s45, s45, 1
    s_and_b32 s46, s3, 1
    s_mov_b32 s47, 16539648
    s_mov_b32 s48, 3932160
    s_cmp_lt_u32 s3, 2
    s_cselect_b32 s49, s44, s45
    s_cselect_b32 s47, s47, s48
    s_add_u32 s49, s49, s46
    s_mul_i32 s49, s49, 114688
    s_add_u32 s50, s47, s49
    s_add_u32 s51, s50, 4096
    s_lshl_b32 s52, s3, 13
    s_add_u32 s53, s52, 4096
    s_cmp_lt_u32 s3, 2
    s_cbranch_scc1 L_pre_30
    s_add_u32 m0, s52, 0
    s_nop 0
    buffer_load_dwordx4 v1, s[4:7], s50 offen offset:0 sc1 lds
    buffer_load_dwordx4 v1, s[4:7], s50 offen offset:1024 sc1 lds
    buffer_load_dwordx4 v1, s[4:7], s50 offen offset:2048 sc1 lds
    buffer_load_dwordx4 v1, s[4:7], s50 offen offset:3072 sc1 lds
    s_add_u32 m0, s53, 0
    s_nop 0
    buffer_load_dwordx4 v1, s[4:7], s51 offen offset:0 sc1 lds
    buffer_load_dwordx4 v1, s[4:7], s51 offen offset:1024 sc1 lds
    buffer_load_dwordx4 v1, s[4:7], s51 offen offset:2048 sc1 lds
    buffer_load_dwordx4 v1, s[4:7], s51 offen offset:3072 sc1 lds
    s_add_u32 s50, s50, 8192
    s_add_u32 s51, s51, 8192
    s_add_u32 m0, s52, 32768
    s_nop 0
    buffer_load_dwordx4 v1, s[4:7], s50 offen offset:0 sc1 lds
    buffer_load_dwordx4 v1, s[4:7], s50 offen offset:1024 sc1 lds
    buffer_load_dwordx4 v1, s[4:7], s50 offen offset:2048 sc1 lds
    buffer_load_dwordx4 v1, s[4:7], s50 offen offset:3072 sc1 lds
    s_add_u32 m0, s53, 32768
    s_nop 0
    buffer_load_dwordx4 v1, s[4:7], s51 offen offset:0 sc1 lds
    buffer_load_dwordx4 v1, s[4:7], s51 offen offset:1024 sc1 lds
    buffer_load_dwordx4 v1, s[4:7], s51 offen offset:2048 sc1 lds
    buffer_load_dwordx4 v1, s[4:7], s51 offen offset:3072 sc1 lds
    s_add_u32 s50, s50, 8192
    s_add_u32 s51, s51, 8192
    s_add_u32 m0, s52, 65536
    s_nop 0
    buffer_load_dwordx4 v1, s[4:7], s50 offen offset:0 sc1 lds
    buffer_load_dwordx4 v1, s[4:7], s50 offen offset:1024 sc1 lds
    buffer_load_dwordx4 v1, s[4:7], s50 offen offset:2048 sc1 lds
    buffer_load_dwordx4 v1, s[4:7], s50 offen offset:3072 sc1 lds
    s_add_u32 m0, s53, 65536
    s_nop 0
    buffer_load_dwordx4 v1, s[4:7], s51 offen offset:0 sc1 lds
    buffer_load_dwordx4 v1, s[4:7], s51 offen offset:1024 sc1 lds
    buffer_load_dwordx4 v1, s[4:7], s51 offen offset:2048 sc1 lds
    buffer_load_dwordx4 v1, s[4:7], s51 offen offset:3072 sc1 lds
    s_add_u32 s50, s50, 8192
    s_add_u32 s51, s51, 8192
L_pre_30:
L_joinw1_23:
    s_cmp_lg_u32 s3, 0
    s_cbranch_scc1 L_aw_31
    s_lshl_b32 s64, s60, 7
    s_add_u32 s64, s64, 28600320
    v_lshrrev_b32 v2, 2, v1
    v_and_b32 v2, 60, v2
    s_mov_b32 s66, 0x20000
L_poll_32:
    buffer_load_dword v3, v2, s[4:7], s64 offen sc1
    s_waitcnt vmcnt(0)
    v_cmp_eq_u32 vcc, 1, v3
    s_nop 3
    s_and_b32 s65, vcc_lo, 0x7f7f
    s_cmp_eq_u32 s65, 0x7f7f
    s_cbranch_scc1 L_done_33
    s_sub_u32 s66, s66, 1
    s_cmp_lg_u32 s66, 0
    s_cbranch_scc1 L_poll_32
L_done_33:
    s_waitcnt vmcnt(0)
L_aw_31:
    s_barrier
    s_cmp_ge_u32 s3, 2
    s_cbranch_scc1 L_pre_34
    s_add_u32 m0, s52, 0
    s_nop 0
    buffer_load_dwordx4 v1, s[4:7], s50 offen offset:0 sc1 lds
    buffer_load_dwordx4 v1, s[4:7], s50 offen offset:1024 sc1 lds
    buffer_load_dwordx4 v1, s[4:7], s50 offen offset:2048 sc1 lds
    buffer_load_dwordx4 v1, s[4:7], s50 offen offset:3072 sc1 lds
    s_add_u32 m0, s53, 0
    s_nop 0
    buffer_load_dwordx4 v1, s[4:7], s51 offen offset:0 sc1 lds
    buffer_load_dwordx4 v1, s[4:7], s51 offen offset:1024 sc1 lds
    buffer_load_dwordx4 v1, s[4:7], s51 offen offset:2048 sc1 lds
    buffer_load_dwordx4 v1, s[4:7], s51 offen offset:3072 sc1 lds
    s_add_u32 s50, s50, 8192
    s_add_u32 s51, s51, 8192
    s_add_u32 m0, s52, 32768
    s_nop 0
    buffer_load_dwordx4 v1, s[4:7], s50 offen offset:0 sc1 lds
    buffer_load_dwordx4 v1, s[4:7], s50 offen offset:1024 sc1 lds
    buffer_load_dwordx4 v1, s[4:7], s50 offen offset:2048 sc1 lds
    buffer_load_dwordx4 v1, s[4:7], s50 offen offset:3072 sc1 lds
    s_add_u32 m0, s53, 32768
    s_nop 0
    buffer_load_dwordx4 v1, s[4:7], s51 offen offset:0 sc1 lds
    buffer_load_dwordx4 v1, s[4:7], s51 offen offset:1024 sc1 lds
    buffer_load_dwordx4 v1, s[4:7], s51 offen offset:2048 sc1 lds
    buffer_load_dwordx4 v1, s[4:7], s51 offen offset:3072 sc1 lds
    s_add_u32 s50, s50, 8192
    s_add_u32 s51, s51, 8192
    s_add_u32 m0, s52, 65536
    s_nop 0
    buffer_load_dwordx4 v1, s[4:7], s50 offen offset:0 sc1 lds
    buffer_load_dwordx4 v1, s[4:7], s50 offen offset:1024 sc1 lds
    buffer_load_dwordx4 v1, s[4:7], s50 offen offset:2048 sc1 lds
    buffer_load_dwordx4 v1, s[4:7], s50 offen offset:3072 sc1 lds
    s_add_u32 m0, s53, 65536
    s_nop 0
    buffer_load_dwordx4 v1, s[4:7], s51 offen offset:0 sc1 lds
    buffer_load_dwordx4 v1, s[4:7], s51 offen offset:1024 sc1 lds
    buffer_load_dwordx4 v1, s[4:7], s51 offen offset:2048 sc1 lds
    buffer_load_dwordx4 v1, s[4:7], s51 offen offset:3072 sc1 lds
    s_add_u32 s50, s50, 8192
    s_add_u32 s51, s51, 8192
L_pre_34:
    s_lshr_b32 s16, s3, 1
    s_and_b32 s17, s3, 1
    s_add_u32 s18, s16, s44
    s_add_u32 s19, s17, s45
    s_lshl_b32 s20, s18, 5
    s_lshl_b32 s21, s19, 1
    s_add_u32 s20, s20, s21
    s_lshl_b32 s20, s20, 10
    s_lshl_b32 s26, s16, 13
    v_add_u32 v10, s26, v1
    s_lshl_b32 s26, s17, 13
    s_add_u32 s26, s26, 16384
    v_add_u32 v11, s26, v1
    v_add_u32 v12, 0x10000, v10
    v_add_u32 v13, 0x10000, v11
    s_waitcnt vmcnt(16)
    s_barrier
    s_add_u32 m0, s52, 98304
    s_nop 0
    buffer_load_dwordx4 v1, s[4:7], s50 offen offset:0 sc1 lds
    buffer_load_dwordx4 v1, s[4:7], s50 offen offset:1024 sc1 lds
    buffer_load_dwordx4 v1, s[4:7], s50 offen offset:2048 sc1 lds
    buffer_load_dwordx4 v1, s[4:7], s50 offen offset:3072 sc1 lds
    s_add_u32 m0, s53, 98304
    s_nop 0
    buffer_load_dwordx4 v1, s[4:7], s51 offen offset:0 sc1 lds
    buffer_load_dwordx4 v1, s[4:7], s51 offen offset:1024 sc1 lds
    buffer_load_dwordx4 v1, s[4:7], s51 offen offset:2048 sc1 lds
    buffer_load_dwordx4 v1, s[4:7], s51 offen offset:3072 sc1 lds
    s_add_u32 s50, s50, 8192
    s_add_u32 s51, s51, 8192
    ds_read_b128 v[32:35], v10 offset:0
    ds_read_b128 v[36:39], v11 offset:0
    ds_read_b128 v[40:43], v10 offset:1024
    ds_read_b128 v[44:47], v11 offset:1024
    ds_read_b128 v[48:51], v10 offset:2048
    ds_read_b128 v[52:55], v11 offset:2048
    s_waitcnt lgkmcnt(4)
    v_mfma_f32_32x32x16_bf16 v[16:31], v[36:39], v[32:35], 0
    ds_read_b128 v[32:35], v10 offset:3072
    ds_read_b128 v[36:39], v11 offset:3072
    s_waitcnt lgkmcnt(4)
    v_mfma_f32_32x32x16_bf16 v[16:31], v[44:47], v[40:43], v[16:31]
    ds_read_b128 v[40:43], v10 offset:4096
    ds_read_b128 v[44:47], v11 offset:4096
    s_waitcnt lgkmcnt(4)
    v_mfma_f32_32x32x16_bf16 v[16:31], v[52:55], v[48:51], v[16:31]
    ds_read_b128 v[48:51], v10 offset:5120
    ds_read_b128 v[52:55], v11 offset:5120
    s_waitcnt lgkmcnt(4)
    v_mfma_f32_32x32x16_bf16 v[16:31], v[36:39], v[32:35], v[16:31]
    ds_read_b128 v[32:35], v10 offset:6144
    ds_read_b128 v[36:39], v11 offset:6144
    s_waitcnt lgkmcnt(4)
    v_mfma_f32_32x32x16_bf16 v[16:31], v[44:47], v[40:43], v[16:31]
    ds_read_b128 v[40:43], v10 offset:7168
    ds_read_b128 v[44:47], v11 offset:7168
    s_waitcnt lgkmcnt(4)
    v_mfma_f32_32x32x16_bf16 v[16:31], v[52:55], v[48:51], v[16:31]
    s_waitcnt lgkmcnt(2)
    v_mfma_f32_32x32x16_bf16 v[16:31], v[36:39], v[32:35], v[16:31]
    s_waitcnt lgkmcnt(0)
    v_mfma_f32_32x32x16_bf16 v[16:31], v[44:47], v[40:43], v[16:31]
    s_waitcnt vmcnt(16)
    s_barrier
    s_add_u32 m0, s52, 0
    s_nop 0
    buffer_load_dwordx4 v1, s[4:7], s50 offen offset:0 sc1 lds
    buffer_load_dwordx4 v1, s[4:7], s50 offen offset:1024 sc1 lds
    buffer_load_dwordx4 v1, s[4:7], s50 offen offset:2048 sc1 lds
    buffer_load_dwordx4 v1, s[4:7], s50 offen offset:3072 sc1 lds
    s_add_u32 m0, s53, 0
    s_nop 0
    buffer_load_dwordx4 v1, s[4:7], s51 offen offset:0 sc1 lds
    buffer_load_dwordx4 v1, s[4:7], s51 offen offset:1024 sc1 lds
    buffer_load_dwordx4 v1, s[4:7], s51 offen offset:2048 sc1 lds
    buffer_load_dwordx4 v1, s[4:7], s51 offen offset:3072 sc1 lds
    s_add_u32 s50, s50, 8192
    s_add_u32 s51, s51, 8192
    ds_read_b128 v[32:35], v10 offset:32768
    ds_read_b128 v[36:39], v11 offset:32768
    ds_read_b128 v[40:43], v10 offset:33792
    ds_read_b128 v[44:47], v11 offset:33792
    ds_read_b128 v[48:51], v10 offset:34816
    ds_read_b128 v[52:55], v11 offset:34816
    s_waitcnt lgkmcnt(4)
    v_mfma_f32_32x32x16_bf16 v[16:31], v[36:39], v[32:35], v[16:31]
    ds_read_b128 v[32:35], v10 offset:35840
    ds_read_b128 v[36:39], v11 offset:35840
    s_waitcnt lgkmcnt(4)
    v_mfma_f32_32x32x16_bf16 v[16:31], v[44:47], v[40:43], v[16:31]
    ds_read_b128 v[40:43], v10 offset:36864
    ds_read_b128 v[44:47], v11 offset:36864
    s_waitcnt lgkmcnt(4)
    v_mfma_f32_32x32x16_bf16 v[16:31], v[52:55], v[48:51], v[16:31]
    ds_read_b128 v[48:51], v10 offset:37888
    ds_read_b128 v[52:55], v11 offset:37888
    s_waitcnt lgkmcnt(4)
    v_mfma_f32_32x32x16_bf16 v[16:31], v[36:39], v[32:35], v[16:31]
    ds_read_b128 v[32:35], v10 offset:38912
    ds_read_b128 v[36:39], v11 offset:38912
    s_waitcnt lgkmcnt(4)
    v_mfma_f32_32x32x16_bf16 v[16:31], v[44:47], v[40:43], v[16:31]
    ds_read_b128 v[40:43], v10 offset:39936
    ds_read_b128 v[44:47], v11 offset:39936
    s_waitcnt lgkmcnt(4)
    v_mfma_f32_32x32x16_bf16 v[16:31], v[52:55], v[48:51], v[16:31]
    s_waitcnt lgkmcnt(2)
    v_mfma_f32_32x32x16_bf16 v[16:31], v[36:39], v[32:35], v[16:31]
    s_waitcnt lgkmcnt(0)
    v_mfma_f32_32x32x16_bf16 v[16:31], v[44:47], v[40:43], v[16:31]
    s_waitcnt vmcnt(16)
    s_barrier
    s_add_u32 m0, s52, 32768
    s_nop 0
    buffer_load_dwordx4 v1, s[4:7], s50 offen offset:0 sc1 lds
    buffer_load_dwordx4 v1, s[4:7], s50 offen offset:1024 sc1 lds
    buffer_load_dwordx4 v1, s[4:7], s50 offen offset:2048 sc1 lds
    buffer_load_dwordx4 v1, s[4:7], s50 offen offset:3072 sc1 lds
    s_add_u32 m0, s53, 32768
    s_nop 0
    buffer_load_dwordx4 v1, s[4:7], s51 offen offset:0 sc1 lds
    buffer_load_dwordx4 v1, s[4:7], s51 offen offset:1024 sc1 lds
    buffer_load_dwordx4 v1, s[4:7], s51 offen offset:2048 sc1 lds
    buffer_load_dwordx4 v1, s[4:7], s51 offen offset:3072 sc1 lds
    s_add_u32 s50, s50, 8192
    s_add_u32 s51, s51, 8192
    ds_read_b128 v[32:35], v12 offset:0
    ds_read_b128 v[36:39], v13 offset:0
    ds_read_b128 v[40:43], v12 offset:1024
    ds_read_b128 v[44:47], v13 offset:1024
    ds_read_b128 v[48:51], v12 offset:2048
    ds_read_b128 v[52:55], v13 offset:2048
    s_waitcnt lgkmcnt(4)
    v_mfma_f32_32x32x16_bf16 v[16:31], v[36:39], v[32:35], v[16:31]
    ds_read_b128 v[32:35], v12 offset:3072
    ds_read_b128 v[36:39], v13 offset:3072
    s_waitcnt lgkmcnt(4)
    v_mfma_f32_32x32x16_bf16 v[16:31], v[44:47], v[40:43], v[16:31]
    ds_read_b128 v[40:43], v12 offset:4096
    ds_read_b128 v[44:47], v13 offset:4096
    s_waitcnt lgkmcnt(4)
    v_mfma_f32_32x32x16_bf16 v[16:31], v[52:55], v[48:51], v[16:31]
    ds_read_b128 v[48:51], v12 offset:5120
    ds_read_b128 v[52:55], v13 offset:5120
    s_waitcnt lgkmcnt(4)
    v_mfma_f32_32x32x16_bf16 v[16:31], v[36:39], v[32:35], v[16:31]
    ds_read_b128 v[32:35], v12 offset:6144
    ds_read_b128 v[36:39], v13 offset:6144
    s_waitcnt lgkmcnt(4)
    v_mfma_f32_32x32x16_bf16 v[16:31], v[44:47], v[40:43], v[16:31]
    ds_read_b128 v[40:43], v12 offset:7168
    ds_read_b128 v[44:47], v13 offset:7168
    s_waitcnt lgkmcnt(4)
    v_mfma_f32_32x32x16_bf16 v[16:31], v[52:55], v[48:51], v[16:31]
    s_waitcnt lgkmcnt(2)
    v_mfma_f32_32x32x16_bf16 v[16:31], v[36:39], v[32:35], v[16:31]
    s_waitcnt lgkmcnt(0)
    v_mfma_f32_32x32x16_bf16 v[16:31], v[44:47], v[40:43], v[16:31]
    s_waitcnt vmcnt(16)
    s_barrier
    s_add_u32 m0, s52, 65536
    s_nop 0
    buffer_load_dwordx4 v1, s[4:7], s50 offen offset:0 sc1 lds
    buffer_load_dwordx4 v1, s[4:7], s50 offen offset:1024 sc1 lds
    buffer_load_dwordx4 v1, s[4:7], s50 offen offset:2048 sc1 lds
    buffer_load_dwordx4 v1, s[4:7], s50 offen offset:3072 sc1 lds
    s_add_u32 m0, s53, 65536
    s_nop 0
    buffer_load_dwordx4 v1, s[4:7], s51 offen offset:0 sc1 lds
    buffer_load_dwordx4 v1, s[4:7], s51 offen offset:1024 sc1 lds
    buffer_load_dwordx4 v1, s[4:7], s51 offen offset:2048 sc1 lds
    buffer_load_dwordx4 v1, s[4:7], s51 offen offset:3072 sc1 lds
    s_add_u32 s50, s50, 8192
    s_add_u32 s51, s51, 8192
    ds_read_b128 v[32:35], v12 offset:32768
    ds_read_b128 v[36:39], v13 offset:32768
    ds_read_b128 v[40:43], v12 offset:33792
    ds_read_b128 v[44:47], v13 offset:33792
    ds_read_b128 v[48:51], v12 offset:34816
    ds_read_b128 v[52:55], v13 offset:34816
    s_waitcnt lgkmcnt(4)
    v_mfma_f32_32x32x16_bf16 v[16:31], v[36:39], v[32:35], v[16:31]
    ds_read_b128 v[32:35], v12 offset:35840
    ds_read_b128 v[36:39], v13 offset:35840
    s_waitcnt lgkmcnt(4)
    v_mfma_f32_32x32x16_bf16 v[16:31], v[44:47], v[40:43], v[16:31]
    ds_read_b128 v[40:43], v12 offset:36864
    ds_read_b128 v[44:47], v13 offset:36864
    s_waitcnt lgkmcnt(4)
    v_mfma_f32_32x32x16_bf16 v[16:31], v[52:55], v[48:51], v[16:31]
    ds_read_b128 v[48:51], v12 offset:37888
    ds_read_b128 v[52:55], v13 offset:37888
    s_waitcnt lgkmcnt(4)
    v_mfma_f32_32x32x16_bf16 v[16:31], v[36:39], v[32:35], v[16:31]
    ds_read_b128 v[32:35], v12 offset:38912
    ds_read_b128 v[36:39], v13 offset:38912
    s_waitcnt lgkmcnt(4)
    v_mfma_f32_32x32x16_bf16 v[16:31], v[44:47], v[40:43], v[16:31]
    ds_read_b128 v[40:43], v12 offset:39936
    ds_read_b128 v[44:47], v13 offset:39936
    s_waitcnt lgkmcnt(4)
    v_mfma_f32_32x32x16_bf16 v[16:31], v[52:55], v[48:51], v[16:31]
    s_waitcnt lgkmcnt(2)
    v_mfma_f32_32x32x16_bf16 v[16:31], v[36:39], v[32:35], v[16:31]
    s_waitcnt lgkmcnt(0)
    v_mfma_f32_32x32x16_bf16 v[16:31], v[44:47], v[40:43], v[16:31]
    s_waitcnt vmcnt(16)
    s_barrier
    s_add_u32 m0, s52, 98304
    s_nop 0
    buffer_load_dwordx4 v1, s[4:7], s50 offen offset:0 sc1 lds
    buffer_load_dwordx4 v1, s[4:7], s50 offen offset:1024 sc1 lds
    buffer_load_dwordx4 v1, s[4:7], s50 offen offset:2048 sc1 lds
    buffer_load_dwordx4 v1, s[4:7], s50 offen offset:3072 sc1 lds
    s_add_u32 m0, s53, 98304
    s_nop 0
    buffer_load_dwordx4 v1, s[4:7], s51 offen offset:0 sc1 lds
    buffer_load_dwordx4 v1, s[4:7], s51 offen offset:1024 sc1 lds
    buffer_load_dwordx4 v1, s[4:7], s51 offen offset:2048 sc1 lds
    buffer_load_dwordx4 v1, s[4:7], s51 offen offset:3072 sc1 lds
    s_add_u32 s50, s50, 8192
    s_add_u32 s51, s51, 8192
    ds_read_b128 v[32:35], v10 offset:0
    ds_read_b128 v[36:39], v11 offset:0
    ds_read_b128 v[40:43], v10 offset:1024
    ds_read_b128 v[44:47], v11 offset:1024
    ds_read_b128 v[48:51], v10 offset:2048
    ds_read_b128 v[52:55], v11 offset:2048
    s_waitcnt lgkmcnt(4)
    v_mfma_f32_32x32x16_bf16 v[16:31], v[36:39], v[32:35], v[16:31]
    ds_read_b128 v[32:35], v10 offset:3072
    ds_read_b128 v[36:39], v11 offset:3072
    s_waitcnt lgkmcnt(4)
    v_mfma_f32_32x32x16_bf16 v[16:31], v[44:47], v[40:43], v[16:31]
    ds_read_b128 v[40:43], v10 offset:4096
    ds_read_b128 v[44:47], v11 offset:4096
    s_waitcnt lgkmcnt(4)
    v_mfma_f32_32x32x16_bf16 v[16:31], v[52:55], v[48:51], v[16:31]
    ds_read_b128 v[48:51], v10 offset:5120
    ds_read_b128 v[52:55], v11 offset:5120
    s_waitcnt lgkmcnt(4)
    v_mfma_f32_32x32x16_bf16 v[16:31], v[36:39], v[32:35], v[16:31]
    ds_read_b128 v[32:35], v10 offset:6144
    ds_read_b128 v[36:39], v11 offset:6144
    s_waitcnt lgkmcnt(4)
    v_mfma_f32_32x32x16_bf16 v[16:31], v[44:47], v[40:43], v[16:31]
    ds_read_b128 v[40:43], v10 offset:7168
    ds_read_b128 v[44:47], v11 offset:7168
    s_waitcnt lgkmcnt(4)
    v_mfma_f32_32x32x16_bf16 v[16:31], v[52:55], v[48:51], v[16:31]
    s_waitcnt lgkmcnt(2)
    v_mfma_f32_32x32x16_bf16 v[16:31], v[36:39], v[32:35], v[16:31]
    s_waitcnt lgkmcnt(0)
    v_mfma_f32_32x32x16_bf16 v[16:31], v[44:47], v[40:43], v[16:31]
    s_waitcnt vmcnt(16)
    s_barrier
    s_add_u32 m0, s52, 0
    s_nop 0
    buffer_load_dwordx4 v1, s[4:7], s50 offen offset:0 sc1 lds
    buffer_load_dwordx4 v1, s[4:7], s50 offen offset:1024 sc1 lds
    buffer_load_dwordx4 v1, s[4:7], s50 offen offset:2048 sc1 lds
    buffer_load_dwordx4 v1, s[4:7], s50 offen offset:3072 sc1 lds
    s_add_u32 m0, s53, 0
    s_nop 0
    buffer_load_dwordx4 v1, s[4:7], s51 offen offset:0 sc1 lds
    buffer_load_dwordx4 v1, s[4:7], s51 offen offset:1024 sc1 lds
    buffer_load_dwordx4 v1, s[4:7], s51 offen offset:2048 sc1 lds
    buffer_load_dwordx4 v1, s[4:7], s51 offen offset:3072 sc1 lds
    s_add_u32 s50, s50, 8192
    s_add_u32 s51, s51, 8192
    ds_read_b128 v[32:35], v10 offset:32768
    ds_read_b128 v[36:39], v11 offset:32768
    ds_read_b128 v[40:43], v10 offset:33792
    ds_read_b128 v[44:47], v11 offset:33792
    ds_read_b128 v[48:51], v10 offset:34816
    ds_read_b128 v[52:55], v11 offset:34816
    s_waitcnt lgkmcnt(4)
    v_mfma_f32_32x32x16_bf16 v[16:31], v[36:39], v[32:35], v[16:31]
    ds_read_b128 v[32:35], v10 offset:35840
    ds_read_b128 v[36:39], v11 offset:35840
    s_waitcnt lgkmcnt(4)
    v_mfma_f32_32x32x16_bf16 v[16:31], v[44:47], v[40:43], v[16:31]
    ds_read_b128 v[40:43], v10 offset:36864
    ds_read_b128 v[44:47], v11 offset:36864
    s_waitcnt lgkmcnt(4)
    v_mfma_f32_32x32x16_bf16 v[16:31], v[52:55], v[48:51], v[16:31]
    ds_read_b128 v[48:51], v10 offset:37888
    ds_read_b128 v[52:55], v11 offset:37888
    s_waitcnt lgkmcnt(4)
    v_mfma_f32_32x32x16_bf16 v[16:31], v[36:39], v[32:35], v[16:31]
    ds_read_b128 v[32:35], v10 offset:38912
    ds_read_b128 v[36:39], v11 offset:38912
    s_waitcnt lgkmcnt(4)
    v_mfma_f32_32x32x16_bf16 v[16:31], v[44:47], v[40:43], v[16:31]
    ds_read_b128 v[40:43], v10 offset:39936
    ds_read_b128 v[44:47], v11 offset:39936
    s_waitcnt lgkmcnt(4)
    v_mfma_f32_32x32x16_bf16 v[16:31], v[52:55], v[48:51], v[16:31]
    s_waitcnt lgkmcnt(2)
    v_mfma_f32_32x32x16_bf16 v[16:31], v[36:39], v[32:35], v[16:31]
    s_waitcnt lgkmcnt(0)
    v_mfma_f32_32x32x16_bf16 v[16:31], v[44:47], v[40:43], v[16:31]
    s_waitcnt vmcnt(16)
    s_barrier
    s_add_u32 m0, s52, 32768
    s_nop 0
    buffer_load_dwordx4 v1, s[4:7], s50 offen offset:0 sc1 lds
    buffer_load_dwordx4 v1, s[4:7], s50 offen offset:1024 sc1 lds
    buffer_load_dwordx4 v1, s[4:7], s50 offen offset:2048 sc1 lds
    buffer_load_dwordx4 v1, s[4:7], s50 offen offset:3072 sc1 lds
    s_add_u32 m0, s53, 32768
    s_nop 0
    buffer_load_dwordx4 v1, s[4:7], s51 offen offset:0 sc1 lds
    buffer_load_dwordx4 v1, s[4:7], s51 offen offset:1024 sc1 lds
    buffer_load_dwordx4 v1, s[4:7], s51 offen offset:2048 sc1 lds
    buffer_load_dwordx4 v1, s[4:7], s51 offen offset:3072 sc1 lds
    s_add_u32 s50, s50, 8192
    s_add_u32 s51, s51, 8192
    ds_read_b128 v[32:35], v12 offset:0
    ds_read_b128 v[36:39], v13 offset:0
    ds_read_b128 v[40:43], v12 offset:1024
    ds_read_b128 v[44:47], v13 offset:1024
    ds_read_b128 v[48:51], v12 offset:2048
    ds_read_b128 v[52:55], v13 offset:2048
    s_waitcnt lgkmcnt(4)
    v_mfma_f32_32x32x16_bf16 v[16:31], v[36:39], v[32:35], v[16:31]
    ds_read_b128 v[32:35], v12 offset:3072
    ds_read_b128 v[36:39], v13 offset:3072
    s_waitcnt lgkmcnt(4)
    v_mfma_f32_32x32x16_bf16 v[16:31], v[44:47], v[40:43], v[16:31]
    ds_read_b128 v[40:43], v12 offset:4096
    ds_read_b128 v[44:47], v13 offset:4096
    s_waitcnt lgkmcnt(4)
    v_mfma_f32_32x32x16_bf16 v[16:31], v[52:55], v[48:51], v[16:31]
    ds_read_b128 v[48:51], v12 offset:5120
    ds_read_b128 v[52:55], v13 offset:5120
    s_waitcnt lgkmcnt(4)
    v_mfma_f32_32x32x16_bf16 v[16:31], v[36:39], v[32:35], v[16:31]
    ds_read_b128 v[32:35], v12 offset:6144
    ds_read_b128 v[36:39], v13 offset:6144
    s_waitcnt lgkmcnt(4)
    v_mfma_f32_32x32x16_bf16 v[16:31], v[44:47], v[40:43], v[16:31]
    ds_read_b128 v[40:43], v12 offset:7168
    ds_read_b128 v[44:47], v13 offset:7168
    s_waitcnt lgkmcnt(4)
    v_mfma_f32_32x32x16_bf16 v[16:31], v[52:55], v[48:51], v[16:31]
    s_waitcnt lgkmcnt(2)
    v_mfma_f32_32x32x16_bf16 v[16:31], v[36:39], v[32:35], v[16:31]
    s_waitcnt lgkmcnt(0)
    v_mfma_f32_32x32x16_bf16 v[16:31], v[44:47], v[40:43], v[16:31]
    s_waitcnt vmcnt(16)
    s_barrier
    s_add_u32 m0, s52, 65536
    s_nop 0
    buffer_load_dwordx4 v1, s[4:7], s50 offen offset:0 sc1 lds
    buffer_load_dwordx4 v1, s[4:7], s50 offen offset:1024 sc1 lds
    buffer_load_dwordx4 v1, s[4:7], s50 offen offset:2048 sc1 lds
    buffer_load_dwordx4 v1, s[4:7], s50 offen offset:3072 sc1 lds
    s_add_u32 m0, s53, 65536
    s_nop 0
    buffer_load_dwordx4 v1, s[4:7], s51 offen offset:0 sc1 lds
    buffer_load_dwordx4 v1, s[4:7], s51 offen offset:1024 sc1 lds
    buffer_load_dwordx4 v1, s[4:7], s51 offen offset:2048 sc1 lds
    buffer_load_dwordx4 v1, s[4:7], s51 offen offset:3072 sc1 lds
    s_add_u32 s50, s50, 8192
    s_add_u32 s51, s51, 8192
    ds_read_b128 v[32:35], v12 offset:32768
    ds_read_b128 v[36:39], v13 offset:32768
    ds_read_b128 v[40:43], v12 offset:33792
    ds_read_b128 v[44:47], v13 offset:33792
    ds_read_b128 v[48:51], v12 offset:34816
    ds_read_b128 v[52:55], v13 offset:34816
    s_waitcnt lgkmcnt(4)
    v_mfma_f32_32x32x16_bf16 v[16:31], v[36:39], v[32:35], v[16:31]
    ds_read_b128 v[32:35], v12 offset:35840
    ds_read_b128 v[36:39], v13 offset:35840
    s_waitcnt lgkmcnt(4)
    v_mfma_f32_32x32x16_bf16 v[16:31], v[44:47], v[40:43], v[16:31]
    ds_read_b128 v[40:43], v12 offset:36864
    ds_read_b128 v[44:47], v13 offset:36864
    s_waitcnt lgkmcnt(4)
    v_mfma_f32_32x32x16_bf16 v[16:31], v[52:55], v[48:51], v[16:31]
    ds_read_b128 v[48:51], v12 offset:37888
    ds_read_b128 v[52:55], v13 offset:37888
    s_waitcnt lgkmcnt(4)
    v_mfma_f32_32x32x16_bf16 v[16:31], v[36:39], v[32:35], v[16:31]
    ds_read_b128 v[32:35], v12 offset:38912
    ds_read_b128 v[36:39], v13 offset:38912
    s_waitcnt lgkmcnt(4)
    v_mfma_f32_32x32x16_bf16 v[16:31], v[44:47], v[40:43], v[16:31]
    ds_read_b128 v[40:43], v12 offset:39936
    ds_read_b128 v[44:47], v13 offset:39936
    s_waitcnt lgkmcnt(4)
    v_mfma_f32_32x32x16_bf16 v[16:31], v[52:55], v[48:51], v[16:31]
    s_waitcnt lgkmcnt(2)
    v_mfma_f32_32x32x16_bf16 v[16:31], v[36:39], v[32:35], v[16:31]
    s_waitcnt lgkmcnt(0)
    v_mfma_f32_32x32x16_bf16 v[16:31], v[44:47], v[40:43], v[16:31]
    s_waitcnt vmcnt(16)
    s_barrier
    s_add_u32 m0, s52, 98304
    s_nop 0
    buffer_load_dwordx4 v1, s[4:7], s50 offen offset:0 sc1 lds
    buffer_load_dwordx4 v1, s[4:7], s50 offen offset:1024 sc1 lds
    buffer_load_dwordx4 v1, s[4:7], s50 offen offset:2048 sc1 lds
    buffer_load_dwordx4 v1, s[4:7], s50 offen offset:3072 sc1 lds
    s_add_u32 m0, s53, 98304
    s_nop 0
    buffer_load_dwordx4 v1, s[4:7], s51 offen offset:0 sc1 lds
    buffer_load_dwordx4 v1, s[4:7], s51 offen offset:1024 sc1 lds
    buffer_load_dwordx4 v1, s[4:7], s51 offen offset:2048 sc1 lds
    buffer_load_dwordx4 v1, s[4:7], s51 offen offset:3072 sc1 lds
    s_add_u32 s50, s50, 8192
    s_add_u32 s51, s51, 8192
    ds_read_b128 v[32:35], v10 offset:0
    ds_read_b128 v[36:39], v11 offset:0
    ds_read_b128 v[40:43], v10 offset:1024
    ds_read_b128 v[44:47], v11 offset:1024
    ds_read_b128 v[48:51], v10 offset:2048
    ds_read_b128 v[52:55], v11 offset:2048
    s_waitcnt lgkmcnt(4)
    v_mfma_f32_32x32x16_bf16 v[16:31], v[36:39], v[32:35], v[16:31]
    ds_read_b128 v[32:35], v10 offset:3072
    ds_read_b128 v[36:39], v11 offset:3072
    s_waitcnt lgkmcnt(4)
    v_mfma_f32_32x32x16_bf16 v[16:31], v[44:47], v[40:43], v[16:31]
    ds_read_b128 v[40:43], v10 offset:4096
    ds_read_b128 v[44:47], v11 offset:4096
    s_waitcnt lgkmcnt(4)
    v_mfma_f32_32x32x16_bf16 v[16:31], v[52:55], v[48:51], v[16:31]
    ds_read_b128 v[48:51], v10 offset:5120
    ds_read_b128 v[52:55], v11 offset:5120
    s_waitcnt lgkmcnt(4)
    v_mfma_f32_32x32x16_bf16 v[16:31], v[36:39], v[32:35], v[16:31]
    ds_read_b128 v[32:35], v10 offset:6144
    ds_read_b128 v[36:39], v11 offset:6144
    s_waitcnt lgkmcnt(4)
    v_mfma_f32_32x32x16_bf16 v[16:31], v[44:47], v[40:43], v[16:31]
    ds_read_b128 v[40:43], v10 offset:7168
    ds_read_b128 v[44:47], v11 offset:7168
    s_waitcnt lgkmcnt(4)
    v_mfma_f32_32x32x16_bf16 v[16:31], v[52:55], v[48:51], v[16:31]
    s_waitcnt lgkmcnt(2)
    v_mfma_f32_32x32x16_bf16 v[16:31], v[36:39], v[32:35], v[16:31]
    s_waitcnt lgkmcnt(0)
    v_mfma_f32_32x32x16_bf16 v[16:31], v[44:47], v[40:43], v[16:31]
    s_waitcnt vmcnt(16)
    s_barrier
    s_add_u32 m0, s52, 0
    s_nop 0
    buffer_load_dwordx4 v1, s[4:7], s50 offen offset:0 sc1 lds
    buffer_load_dwordx4 v1, s[4:7], s50 offen offset:1024 sc1 lds
    buffer_load_dwordx4 v1, s[4:7], s50 offen offset:2048 sc1 lds
    buffer_load_dwordx4 v1, s[4:7], s50 offen offset:3072 sc1 lds
    s_add_u32 m0, s53, 0
    s_nop 0
    buffer_load_dwordx4 v1, s[4:7], s51 offen offset:0 sc1 lds
    buffer_load_dwordx4 v1, s[4:7], s51 offen offset:1024 sc1 lds
    buffer_load_dwordx4 v1, s[4:7], s51 offen offset:2048 sc1 lds
    buffer_load_dwordx4 v1, s[4:7], s51 offen offset:3072 sc1 lds
    s_add_u32 s50, s50, 8192
    s_add_u32 s51, s51, 8192
    ds_read_b128 v[32:35], v10 offset:32768
    ds_read_b128 v[36:39], v11 offset:32768
    ds_read_b128 v[40:43], v10 offset:33792
    ds_read_b128 v[44:47], v11 offset:33792
    ds_read_b128 v[48:51], v10 offset:34816
    ds_read_b128 v[52:55], v11 offset:34816
    s_waitcnt lgkmcnt(4)
    v_mfma_f32_32x32x16_bf16 v[16:31], v[36:39], v[32:35], v[16:31]
    ds_read_b128 v[32:35], v10 offset:35840
    ds_read_b128 v[36:39], v11 offset:35840
    s_waitcnt lgkmcnt(4)
    v_mfma_f32_32x32x16_bf16 v[16:31], v[44:47], v[40:43], v[16:31]
    ds_read_b128 v[40:43], v10 offset:36864
    ds_read_b128 v[44:47], v11 offset:36864
    s_waitcnt lgkmcnt(4)
    v_mfma_f32_32x32x16_bf16 v[16:31], v[52:55], v[48:51], v[16:31]
    ds_read_b128 v[48:51], v10 offset:37888
    ds_read_b128 v[52:55], v11 offset:37888
    s_waitcnt lgkmcnt(4)
    v_mfma_f32_32x32x16_bf16 v[16:31], v[36:39], v[32:35], v[16:31]
    ds_read_b128 v[32:35], v10 offset:38912
    ds_read_b128 v[36:39], v11 offset:38912
    s_waitcnt lgkmcnt(4)
    v_mfma_f32_32x32x16_bf16 v[16:31], v[44:47], v[40:43], v[16:31]
    ds_read_b128 v[40:43], v10 offset:39936
    ds_read_b128 v[44:47], v11 offset:39936
    s_waitcnt lgkmcnt(4)
    v_mfma_f32_32x32x16_bf16 v[16:31], v[52:55], v[48:51], v[16:31]
    s_waitcnt lgkmcnt(2)
    v_mfma_f32_32x32x16_bf16 v[16:31], v[36:39], v[32:35], v[16:31]
    s_waitcnt lgkmcnt(0)
    v_mfma_f32_32x32x16_bf16 v[16:31], v[44:47], v[40:43], v[16:31]
    s_waitcnt vmcnt(16)
    s_barrier
    s_add_u32 m0, s52, 32768
    s_nop 0
    buffer_load_dwordx4 v1, s[4:7], s50 offen offset:0 sc1 lds
    buffer_load_dwordx4 v1, s[4:7], s50 offen offset:1024 sc1 lds
    buffer_load_dwordx4 v1, s[4:7], s50 offen offset:2048 sc1 lds
    buffer_load_dwordx4 v1, s[4:7], s50 offen offset:3072 sc1 lds
    s_add_u32 m0, s53, 32768
    s_nop 0
    buffer_load_dwordx4 v1, s[4:7], s51 offen offset:0 sc1 lds
    buffer_load_dwordx4 v1, s[4:7], s51 offen offset:1024 sc1 lds
    buffer_load_dwordx4 v1, s[4:7], s51 offen offset:2048 sc1 lds
    buffer_load_dwordx4 v1, s[4:7], s51 offen offset:3072 sc1 lds
    s_add_u32 s50, s50, 8192
    s_add_u32 s51, s51, 8192
    ds_read_b128 v[32:35], v12 offset:0
    ds_read_b128 v[36:39], v13 offset:0
    ds_read_b128 v[40:43], v12 offset:1024
    ds_read_b128 v[44:47], v13 offset:1024
    ds_read_b128 v[48:51], v12 offset:2048
    ds_read_b128 v[52:55], v13 offset:2048
    s_waitcnt lgkmcnt(4)
    v_mfma_f32_32x32x16_bf16 v[16:31], v[36:39], v[32:35], v[16:31]
    ds_read_b128 v[32:35], v12 offset:3072
    ds_read_b128 v[36:39], v13 offset:3072
    s_waitcnt lgkmcnt(4)
    v_mfma_f32_32x32x16_bf16 v[16:31], v[44:47], v[40:43], v[16:31]
    ds_read_b128 v[40:43], v12 offset:4096
    ds_read_b128 v[44:47], v13 offset:4096
    s_waitcnt lgkmcnt(4)
    v_mfma_f32_32x32x16_bf16 v[16:31], v[52:55], v[48:51], v[16:31]
    ds_read_b128 v[48:51], v12 offset:5120
    ds_read_b128 v[52:55], v13 offset:5120
    s_waitcnt lgkmcnt(4)
    v_mfma_f32_32x32x16_bf16 v[16:31], v[36:39], v[32:35], v[16:31]
    ds_read_b128 v[32:35], v12 offset:6144
    ds_read_b128 v[36:39], v13 offset:6144
    s_waitcnt lgkmcnt(4)
    v_mfma_f32_32x32x16_bf16 v[16:31], v[44:47], v[40:43], v[16:31]
    ds_read_b128 v[40:43], v12 offset:7168
    ds_read_b128 v[44:47], v13 offset:7168
    s_waitcnt lgkmcnt(4)
    v_mfma_f32_32x32x16_bf16 v[16:31], v[52:55], v[48:51], v[16:31]
    s_waitcnt lgkmcnt(2)
    v_mfma_f32_32x32x16_bf16 v[16:31], v[36:39], v[32:35], v[16:31]
    s_waitcnt lgkmcnt(0)
    v_mfma_f32_32x32x16_bf16 v[16:31], v[44:47], v[40:43], v[16:31]
    s_waitcnt vmcnt(16)
    s_barrier
    ds_read_b128 v[32:35], v12 offset:32768
    ds_read_b128 v[36:39], v13 offset:32768
    ds_read_b128 v[40:43], v12 offset:33792
    ds_read_b128 v[44:47], v13 offset:33792
    ds_read_b128 v[48:51], v12 offset:34816
    ds_read_b128 v[52:55], v13 offset:34816
    s_waitcnt lgkmcnt(4)
    v_mfma_f32_32x32x16_bf16 v[16:31], v[36:39], v[32:35], v[16:31]
    ds_read_b128 v[32:35], v12 offset:35840
    ds_read_b128 v[36:39], v13 offset:35840
    s_waitcnt lgkmcnt(4)
    v_mfma_f32_32x32x16_bf16 v[16:31], v[44:47], v[40:43], v[16:31]
    ds_read_b128 v[40:43], v12 offset:36864
    ds_read_b128 v[44:47], v13 offset:36864
    s_waitcnt lgkmcnt(4)
    v_mfma_f32_32x32x16_bf16 v[16:31], v[52:55], v[48:51], v[16:31]
    ds_read_b128 v[48:51], v12 offset:37888
    ds_read_b128 v[52:55], v13 offset:37888
    s_waitcnt lgkmcnt(4)
    v_mfma_f32_32x32x16_bf16 v[16:31], v[36:39], v[32:35], v[16:31]
    ds_read_b128 v[32:35], v12 offset:38912
    ds_read_b128 v[36:39], v13 offset:38912
    s_waitcnt lgkmcnt(4)
    v_mfma_f32_32x32x16_bf16 v[16:31], v[44:47], v[40:43], v[16:31]
    ds_read_b128 v[40:43], v12 offset:39936
    ds_read_b128 v[44:47], v13 offset:39936
    s_waitcnt lgkmcnt(4)
    v_mfma_f32_32x32x16_bf16 v[16:31], v[52:55], v[48:51], v[16:31]
    s_waitcnt lgkmcnt(2)
    v_mfma_f32_32x32x16_bf16 v[16:31], v[36:39], v[32:35], v[16:31]
    s_waitcnt lgkmcnt(0)
    v_mfma_f32_32x32x16_bf16 v[16:31], v[44:47], v[40:43], v[16:31]
    s_waitcnt vmcnt(8)
    s_barrier
    ds_read_b128 v[32:35], v10 offset:0
    ds_read_b128 v[36:39], v11 offset:0
    ds_read_b128 v[40:43], v10 offset:1024
    ds_read_b128 v[44:47], v11 offset:1024
    ds_read_b128 v[48:51], v10 offset:2048
    ds_read_b128 v[52:55], v11 offset:2048
    s_waitcnt lgkmcnt(4)
    v_mfma_f32_32x32x16_bf16 v[16:31], v[36:39], v[32:35], v[16:31]
    ds_read_b128 v[32:35], v10 offset:3072
    ds_read_b128 v[36:39], v11 offset:3072
    s_waitcnt lgkmcnt(4)
    v_mfma_f32_32x32x16_bf16 v[16:31], v[44:47], v[40:43], v[16:31]
    ds_read_b128 v[40:43], v10 offset:4096
    ds_read_b128 v[44:47], v11 offset:4096
    s_waitcnt lgkmcnt(4)
    v_mfma_f32_32x32x16_bf16 v[16:31], v[52:55], v[48:51], v[16:31]
    ds_read_b128 v[48:51], v10 offset:5120
    ds_read_b128 v[52:55], v11 offset:5120
    s_waitcnt lgkmcnt(4)
    v_mfma_f32_32x32x16_bf16 v[16:31], v[36:39], v[32:35], v[16:31]
    ds_read_b128 v[32:35], v10 offset:6144
    ds_read_b128 v[36:39], v11 offset:6144
    s_waitcnt lgkmcnt(4)
    v_mfma_f32_32x32x16_bf16 v[16:31], v[44:47], v[40:43], v[16:31]
    ds_read_b128 v[40:43], v10 offset:7168
    ds_read_b128 v[44:47], v11 offset:7168
    s_waitcnt lgkmcnt(4)
    v_mfma_f32_32x32x16_bf16 v[16:31], v[52:55], v[48:51], v[16:31]
    s_waitcnt lgkmcnt(2)
    v_mfma_f32_32x32x16_bf16 v[16:31], v[36:39], v[32:35], v[16:31]
    s_waitcnt lgkmcnt(0)
    v_mfma_f32_32x32x16_bf16 v[16:31], v[44:47], v[40:43], v[16:31]
    s_waitcnt vmcnt(0)
    s_barrier
    ds_read_b128 v[32:35], v10 offset:32768
    ds_read_b128 v[36:39], v11 offset:32768
    ds_read_b128 v[40:43], v10 offset:33792
    ds_read_b128 v[44:47], v11 offset:33792
    ds_read_b128 v[48:51], v10 offset:34816
    ds_read_b128 v[52:55], v11 offset:34816
    s_waitcnt lgkmcnt(4)
    v_mfma_f32_32x32x16_bf16 v[16:31], v[36:39], v[32:35], v[16:31]
    ds_read_b128 v[32:35], v10 offset:35840
    ds_read_b128 v[36:39], v11 offset:35840
    s_waitcnt lgkmcnt(4)
    v_mfma_f32_32x32x16_bf16 v[16:31], v[44:47], v[40:43], v[16:31]
    ds_read_b128 v[40:43], v10 offset:36864
    ds_read_b128 v[44:47], v11 offset:36864
    s_waitcnt lgkmcnt(4)
    v_mfma_f32_32x32x16_bf16 v[16:31], v[52:55], v[48:51], v[16:31]
    ds_read_b128 v[48:51], v10 offset:37888
    ds_read_b128 v[52:55], v11 offset:37888
    s_waitcnt lgkmcnt(4)
    v_mfma_f32_32x32x16_bf16 v[16:31], v[36:39], v[32:35], v[16:31]
    ds_read_b128 v[32:35], v10 offset:38912
    ds_read_b128 v[36:39], v11 offset:38912
    s_waitcnt lgkmcnt(4)
    v_mfma_f32_32x32x16_bf16 v[16:31], v[44:47], v[40:43], v[16:31]
    ds_read_b128 v[40:43], v10 offset:39936
    ds_read_b128 v[44:47], v11 offset:39936
    s_waitcnt lgkmcnt(4)
    v_mfma_f32_32x32x16_bf16 v[16:31], v[52:55], v[48:51], v[16:31]
    s_waitcnt lgkmcnt(2)
    v_mfma_f32_32x32x16_bf16 v[16:31], v[36:39], v[32:35], v[16:31]
    s_waitcnt lgkmcnt(0)
    v_mfma_f32_32x32x16_bf16 v[16:31], v[44:47], v[40:43], v[16:31]
    s_nop 15
    s_nop 3
    v_lshlrev_b32 v6, 16, v216
    v_and_b32 v7, 0xffff0000, v216
    v_add_f32 v16, v16, v6
    v_add_f32 v17, v17, v7
    v_lshlrev_b32 v6, 16, v217
    v_and_b32 v7, 0xffff0000, v217
    v_add_f32 v18, v18, v6
    v_add_f32 v19, v19, v7
    v_lshlrev_b32 v6, 16, v218
    v_and_b32 v7, 0xffff0000, v218
    v_add_f32 v20, v20, v6
    v_add_f32 v21, v21, v7
    v_lshlrev_b32 v6, 16, v219
    v_and_b32 v7, 0xffff0000, v219
    v_add_f32 v22, v22, v6
    v_add_f32 v23, v23, v7
    v_lshlrev_b32 v6, 16, v220
    v_and_b32 v7, 0xffff0000, v220
    v_add_f32 v24, v24, v6
    v_add_f32 v25, v25, v7
    v_lshlrev_b32 v6, 16, v221
    v_and_b32 v7, 0xffff0000, v221
    v_add_f32 v26, v26, v6
    v_add_f32 v27, v27, v7
    v_lshlrev_b32 v6, 16, v222
    v_and_b32 v7, 0xffff0000, v222
    v_add_f32 v28, v28, v6
    v_add_f32 v29, v29, v7
    v_lshlrev_b32 v6, 16, v223
    v_and_b32 v7, 0xffff0000, v223
    v_add_f32 v30, v30, v6
    v_add_f32 v31, v31, v7
    v_cvt_pk_bf16_f32 v216, v16, v17
    v_cvt_pk_bf16_f32 v217, v18, v19
    v_cvt_pk_bf16_f32 v218, v20, v21
    v_cvt_pk_bf16_f32 v219, v22, v23
    v_cvt_pk_bf16_f32 v220, v24, v25
    v_cvt_pk_bf16_f32 v221, v26, v27
    v_cvt_pk_bf16_f32 v222, v28, v29
    v_cvt_pk_bf16_f32 v223, v30, v31
    s_mov_b32 s42, 2097152
    s_mov_b32 s43, 0x00020000
    s_lshl_b32 s30, s18, 5
    v_add_u32 v6, s30, v4
    v_lshlrev_b32 v6, 10, v6
    v_lshl_add_u32 v6, v5, 3, v6
    s_lshl_b32 s31, s19, 6
    buffer_store_dwordx2 v[216:217], v6, s[40:43], s31 offen offset:0
    buffer_store_dwordx2 v[218:219], v6, s[40:43], s31 offen offset:16
    buffer_store_dwordx2 v[220:221], v6, s[40:43], s31 offen offset:32
    buffer_store_dwordx2 v[222:223], v6, s[40:43], s31 offen offset:48
L_chain2_kernel_fin:
L_chain2_kernel_end:
    s_endpgm
.section .rodata,"a"
.p2align 6
.amdhsa_kernel prep_kernel
  .amdhsa_next_free_vgpr 128
  .amdhsa_next_free_sgpr 100
  .amdhsa_accum_offset 128
  .amdhsa_group_segment_fixed_size 0
  .amdhsa_kernarg_size 80
  .amdhsa_user_sgpr_count 2
  .amdhsa_user_sgpr_kernarg_segment_ptr 1
  .amdhsa_system_sgpr_workgroup_id_x 1
.end_amdhsa_kernel
.p2align 6
.amdhsa_kernel qkv_kernel
  .amdhsa_next_free_vgpr 352
  .amdhsa_next_free_sgpr 100
  .amdhsa_accum_offset 224
  .amdhsa_group_segment_fixed_size 0
  .amdhsa_kernarg_size 80
  .amdhsa_user_sgpr_count 2
  .amdhsa_user_sgpr_kernarg_segment_ptr 1
  .amdhsa_system_sgpr_workgroup_id_x 1
.end_amdhsa_kernel
.p2align 6
.amdhsa_kernel attn_kernel
  .amdhsa_next_free_vgpr 112
  .amdhsa_next_free_sgpr 100
  .amdhsa_accum_offset 112
  .amdhsa_group_segment_fixed_size 0
  .amdhsa_kernarg_size 80
  .amdhsa_user_sgpr_count 2
  .amdhsa_user_sgpr_kernarg_segment_ptr 1
  .amdhsa_system_sgpr_workgroup_id_x 1
.end_amdhsa_kernel
.p2align 6
.amdhsa_kernel chain1_kernel
  .amdhsa_next_free_vgpr 352
  .amdhsa_next_free_sgpr 100
  .amdhsa_accum_offset 224
  .amdhsa_group_segment_fixed_size 0
  .amdhsa_kernarg_size 80
  .amdhsa_user_sgpr_count 2
  .amdhsa_user_sgpr_kernarg_segment_ptr 1
  .amdhsa_system_sgpr_workgroup_id_x 1
.end_amdhsa_kernel
.p2align 6
.amdhsa_kernel chain2_kernel
  .amdhsa_next_free_vgpr 352
  .amdhsa_next_free_sgpr 100
  .amdhsa_accum_offset 224
  .amdhsa_group_segment_fixed_size 0
  .amdhsa_kernarg_size 80
  .amdhsa_user_sgpr_count 2
  .amdhsa_user_sgpr_kernarg_segment_ptr 1
  .amdhsa_system_sgpr_workgroup_id_x 1
.end_amdhsa_kernel
```
